```python
import torch

def _softmax(x, axis=-1):
    return torch.softmax(x, dim=axis)
def _gelu(x):
    return torch.nn.functional.gelu(x, approximate="tanh")
def _silu(x):
    return torch.nn.functional.silu(x)
def _sigmoid(x):
    return torch.sigmoid(x)
def _layernorm(x, axis=-1, eps=1e-5):
    m = x.mean(dim=axis, keepdim=True)
    v = x.var(dim=axis, keepdim=True, unbiased=False)
    return (x - m) / torch.sqrt(v + eps)
def _scatter_add(tgt, idx, src, axis=0):
    return tgt.clone().index_add_(axis, idx, src)
def _segment_sum(src, seg, n):
    out = torch.zeros((n,) + src.shape[1:], dtype=src.dtype)
    return out.index_add_(0, seg, src)
def _pad(x, pw):
    flat = tuple(v for pair in reversed(pw) for v in pair)
    return torch.nn.functional.pad(x, flat)

kernel_name = 'concat_heads__gqa_block_cached__mha_block_cached__near_ridge'

def setup_inputs():

    _w = (lambda a: (lambda t: t.to(torch.bfloat16) if t.is_floating_point() else t)(torch.as_tensor(a)))
    def _A_setup():
        B, Sq, D = 8, 144, 576
        Hq, Hkv, Sk, Dh = 32, 16, 1024, 128
        assert Hq % Hkv == 0, (Hq, Hkv)
        return {
            "x": _w((lambda *s: torch.randn(*s, dtype=torch.bfloat16) * 0.8)(B, Sq, D)),
            "k_cache": _w((lambda *s: torch.randn(*s, dtype=torch.bfloat16) * 0.8)(B, Hkv, Sk, Dh)),
            "v_cache": _w((lambda *s: torch.randn(*s, dtype=torch.bfloat16) * 0.05)(B, Hkv, Sk, Dh)),
            "wq": _w((lambda *s: torch.randn(*s, dtype=torch.bfloat16) * 0.8)(D, Hq * Dh) * (D ** -0.5)),
            "wo": _w((lambda *s: torch.randn(*s, dtype=torch.bfloat16) * 0.05)(Hq * Dh, D) * ((Hq * Dh) ** -0.5)),
        }
    _A_in = _A_setup()

    def _B_setup():
        B, Sq, D = 8, 144, 576
        H, Sk, Dh = 32, 1024, 128
        return {
            "x": _w((lambda *s: torch.randn(*s, dtype=torch.bfloat16) * 0.8)(B, Sq, D)),
            "k_cache": _w((lambda *s: torch.randn(*s, dtype=torch.bfloat16) * 0.8)(B, H, Sk, Dh)),
            "v_cache": _w((lambda *s: torch.randn(*s, dtype=torch.bfloat16) * 0.05)(B, H, Sk, Dh)),
            "wq": _w((lambda *s: torch.randn(*s, dtype=torch.bfloat16) * 0.8)(D, H * Dh) * (D ** -0.5)),
            "wo": _w((lambda *s: torch.randn(*s, dtype=torch.bfloat16) * 0.05)(H * Dh, D) * ((H * Dh) ** -0.5)),
        }
    _B_in = _B_setup()

    return {
        "A_x": _A_in["x"],
        "A_k_cache": _A_in["k_cache"],
        "A_v_cache": _A_in["v_cache"],
        "A_wq": _A_in["wq"],
        "A_wo": _A_in["wo"],
        "B_x": _B_in["x"],
        "B_k_cache": _B_in["k_cache"],
        "B_v_cache": _B_in["v_cache"],
        "B_wq": _B_in["wq"],
        "B_wo": _B_in["wo"],
    }

def reference(A_x, A_k_cache, A_v_cache, A_wq, A_wo, B_x, B_k_cache, B_v_cache, B_wq, B_wo):
    def _A_ref(x, k_cache, v_cache, wq, wo):
        B, Sq, D = x.shape
        Hq, Dh = 32, 128
        Hkv = k_cache.shape[1]
        rep = Hq // Hkv
        q = (lambda x, *d: x.permute(*d))((x @ wq).reshape(B, Sq, Hq, Dh), 0, 2, 1, 3)
        k = (lambda x, n, axis: torch.repeat_interleave(x, n, dim=axis))(k_cache, rep, axis=1)
        v = (lambda x, n, axis: torch.repeat_interleave(x, n, dim=axis))(v_cache, rep, axis=1)
        scores = torch.einsum("bhqd,bhkd->bhqk", q, k) * (Dh ** -0.5)
        p = _softmax(scores, axis=-1)
        o = torch.einsum("bhqk,bhkd->bhqd", p, v)
        return (lambda x, *d: x.permute(*d))(o, 0, 2, 1, 3).reshape(B, Sq, Hq * Dh) @ wo

    def _B_ref(x, k_cache, v_cache, wq, wo):
        B, Sq, D = x.shape
        H, Dh = 32, 128
        q = (lambda x, *d: x.permute(*d))((x @ wq).reshape(B, Sq, H, Dh), 0, 2, 1, 3)
        scores = torch.einsum("bhqd,bhkd->bhqk", q, k_cache) * (Dh ** -0.5)
        p = _softmax(scores, axis=-1)
        o = torch.einsum("bhqk,bhkd->bhqd", p, v_cache)
        return (lambda x, *d: x.permute(*d))(o, 0, 2, 1, 3).reshape(B, Sq, H * Dh) @ wo

    a = _A_ref(A_x, A_k_cache, A_v_cache, A_wq, A_wo)
    b = _B_ref(B_x, B_k_cache, B_v_cache, B_wq, B_wo)
    return torch.concatenate([a, b], axis=-1)
```

```asm
; @launch kernel=concat_heads__gqa_block_cached__mha_block_cached__near_ridge_kernel grid=(256,1,1) block=(256,1,1) lds=163840
; @launch kernel=reduce_heads_kernel grid=(720,1,1) block=(256,1,1) lds=0
.amdgcn_target "amdgcn-amd-amdhsa--gfx950"
.text
.globl concat_heads__gqa_block_cached__mha_block_cached__near_ridge_kernel
.p2align 8
.type concat_heads__gqa_block_cached__mha_block_cached__near_ridge_kernel,@function
concat_heads__gqa_block_cached__mha_block_cached__near_ridge_kernel:
s_cmp_lt_u32 s2, 256
s_cbranch_scc1 L_go
s_endpgm
L_go:
s_load_dwordx16 s[16:31], s[0:1], 0
s_load_dwordx8 s[32:39], s[0:1], 64
s_load_dwordx2 s[40:41], s[0:1], 96
v_lshrrev_b32 v1, 6, v0
v_and_b32 v251, 63, v0
v_readfirstlane_b32 s3, v1
s_and_b32 s8, s2, 7
s_lshr_b32 s9, s2, 3
s_lshr_b32 s6, s9, 2
s_bfe_u32 s10, s9, 0x10001
s_lshl_b32 s7, s8, 1
s_add_u32 s7, s7, s10
s_lshr_b32 s4, s3, 1
s_and_b32 s5, s3, 1
s_and_b32 s69, s9, 1
s_mul_i32 s15, s4, s69
s_waitcnt lgkmcnt(0)
s_cmp_eq_u32 s69, 1
s_cselect_b64 s[16:17], s[26:27], s[16:17]
s_cselect_b64 s[18:19], s[28:29], s[18:19]
s_cselect_b64 s[20:21], s[30:31], s[20:21]
s_cselect_b64 s[22:23], s[32:33], s[22:23]
s_cselect_b64 s[24:25], s[34:35], s[24:25]
LB_start:
s_mul_i32 s8, s6, 165888
s_add_u32 s44, s16, s8
s_addc_u32 s45, s17, 0
s_and_b32 s45, s45, 0xffff
s_mov_b32 s46, 165888
s_mov_b32 s47, 0x20000
s_lshl_b32 s8, s7, 9
s_sub_u32 s9, 4718592, s8
s_add_u32 s48, s22, s8
s_addc_u32 s49, s23, 0
s_sub_u32 s48, s48, 3072
s_subb_u32 s49, s49, 0
s_and_b32 s49, s49, 0xffff
s_add_u32 s50, s9, 3072
s_mov_b32 s51, 0x20000
s_lshl_b32 s78, s3, 11
s_lshl_b32 s79, s3, 12
s_add_u32 s79, s79, 9216
s_lshl_b32 s8, s3, 4
s_mov_b64 s[80:81], 0xffff
s_lshl_b64 s[80:81], s[80:81], s8
v_lshrrev_b32 v235, 4, v251
v_bfe_u32 v233, v251, 2, 2
v_and_b32 v234, 3, v251
v_and_b32 v236, 15, v251
v_and_b32 v255, 7, v251
v_lshrrev_b32 v252, 3, v251
v_and_b32 v253, 1, v235
s_lshl_b32 s8, s5, 1
v_or_b32 v253, s8, v253
v_lshlrev_b32 v253, 1, v253
v_xor_b32 v253, v253, v255
v_lshlrev_b32 v253, 4, v253
v_lshl_add_u32 v253, v252, 13, v253
s_lshl_b32 s8, s3, 16
v_add_u32 v253, s8, v253
v_add_u32 v241, 3072, v253
v_add_u32 v242, 2176, v253
v_add_u32 v243, 1280, v253
v_add_u32 v244, 384, v253
v_and_b32 v253, 1, v235
v_lshlrev_b32 v253, 1, v253
v_xor_b32 v253, v253, v235
v_xor_b32 v253, v253, v234
v_lshlrev_b32 v253, 4, v253
v_lshrrev_b32 v254, 2, v251
v_mul_u32_u24 v254, 1152, v254
v_add_u32 v253, v253, v254
v_add_u32 v240, 147456, v253
s_mul_i32 s8, s3, 36864
v_add_u32 v238, s8, v253
v_add_u32 v239, 17408, v238
s_add_u32 m0, s78, 111616
s_mov_b32 s42, 0
s_mov_b32 s43, 0
buffer_load_dwordx4 v238, s[44:47], s42 offen lds
buffer_load_dwordx4 v239, s[44:47], s42 offen offset:1024 lds
s_mov_b32 m0, 119808
s_mov_b64 exec, s[80:81]
buffer_load_dwordx4 v240, s[44:47], s42 offen lds
s_add_u32 m0, s79, 111616
s_mov_b64 exec, -1
buffer_load_dwordx4 v241, s[48:51], s43 offen lds
buffer_load_dwordx4 v242, s[48:51], s43 offen offset:1024 lds
buffer_load_dwordx4 v243, s[48:51], s43 offen offset:2048 lds
buffer_load_dwordx4 v244, s[48:51], s43 offen offset:3072 lds
s_add_u32 m0, s78, 137216
s_add_u32 s42, s42, 64
s_add_u32 s43, s43, 262144
buffer_load_dwordx4 v238, s[44:47], s42 offen lds
buffer_load_dwordx4 v239, s[44:47], s42 offen offset:1024 lds
s_mov_b32 m0, 145408
s_mov_b64 exec, s[80:81]
buffer_load_dwordx4 v240, s[44:47], s42 offen lds
s_add_u32 m0, s79, 137216
s_mov_b64 exec, -1
buffer_load_dwordx4 v241, s[48:51], s43 offen lds
buffer_load_dwordx4 v242, s[48:51], s43 offen offset:1024 lds
buffer_load_dwordx4 v243, s[48:51], s43 offen offset:2048 lds
buffer_load_dwordx4 v244, s[48:51], s43 offen offset:3072 lds
s_add_u32 m0, s78, 34816
s_add_u32 s42, s42, 64
s_add_u32 s43, s43, 262144
buffer_load_dwordx4 v238, s[44:47], s42 offen lds
buffer_load_dwordx4 v239, s[44:47], s42 offen offset:1024 lds
s_mov_b32 m0, 43008
s_mov_b64 exec, s[80:81]
buffer_load_dwordx4 v240, s[44:47], s42 offen lds
s_add_u32 m0, s79, 34816
s_mov_b64 exec, -1
buffer_load_dwordx4 v241, s[48:51], s43 offen lds
buffer_load_dwordx4 v242, s[48:51], s43 offen offset:1024 lds
buffer_load_dwordx4 v243, s[48:51], s43 offen offset:2048 lds
buffer_load_dwordx4 v244, s[48:51], s43 offen offset:3072 lds
s_lshl_b32 s8, s6, 4
s_add_u32 s8, s8, s7
s_mul_i32 s8, s8, 36864
s_mul_i32 s9, s3, 9216
s_add_u32 s8, s8, s9
s_add_u32 s52, s22, s8
s_addc_u32 s53, s23, 0
s_and_b32 s53, s53, 0xffff
s_mov_b32 s54, 9216
s_mov_b32 s55, 0x20000
s_mov_b32 s68, s8
v_lshlrev_b32 v237, 4, v251
s_mov_b32 s8, 0
buffer_load_dwordx4 v[212:215], v237, s[52:55], s8 offen
buffer_load_dwordx4 v[212:215], v237, s[52:55], s8 offen offset:1024
buffer_load_dwordx4 v[212:215], v237, s[52:55], s8 offen offset:2048
buffer_load_dwordx4 v[212:215], v237, s[52:55], s8 offen offset:3072
s_mov_b32 s8, 4096
buffer_load_dwordx4 v[212:215], v237, s[52:55], s8 offen
buffer_load_dwordx4 v[212:215], v237, s[52:55], s8 offen offset:1024
buffer_load_dwordx4 v[212:215], v237, s[52:55], s8 offen offset:2048
buffer_load_dwordx4 v[212:215], v237, s[52:55], s8 offen offset:3072
s_mov_b32 s8, 8192
buffer_load_dwordx4 v[212:215], v237, s[52:55], s8 offen
s_mul_i32 s74, s6, 3
s_mul_i32 s8, s7, 1
s_add_u32 s74, s74, s8
s_lshl_b32 s8, s69, 3
s_add_u32 s74, s74, s8
s_and_b32 s74, s74, 15
s_lshl_b32 s74, s74, 14
s_lshl_b32 s8, s6, 4
s_add_u32 s8, s8, s7
s_lshl_b32 s8, s8, s69
s_add_u32 s8, s8, s15
s_lshl_b32 s8, s8, 18
s_add_u32 s52, s18, s8
s_addc_u32 s53, s19, 0
s_sub_u32 s52, s52, 192
s_subb_u32 s53, s53, 0
s_and_b32 s53, s53, 0xffff
s_mov_b32 s54, 262336
s_mov_b32 s55, 0x20000
s_add_u32 s56, s20, s8
s_addc_u32 s57, s21, 0
s_sub_u32 s56, s56, 1024
s_subb_u32 s57, s57, 0
s_and_b32 s57, s57, 0xffff
s_mov_b32 s58, 263168
s_mov_b32 s59, 0x20000
s_cmp_lg_u32 s4, s15
s_cselect_b32 s54, 0, s54
s_cselect_b32 s58, 0, s58
s_mul_i32 s76, s4, 8704
s_mul_i32 s8, s5, 4352
s_add_u32 s76, s76, s8
s_lshl_b32 s77, s3, 12
s_lshl_b32 s8, s5, 12
v_xor_b32 v253, v235, v236
v_lshlrev_b32 v253, 4, v253
v_lshl_add_u32 v253, v235, 8, v253
v_add_u32 v253, s8, v253
v_add_u32 v245, 192, v253
v_add_u32 v246, 128, v253
v_add_u32 v247, 64, v253
v_add_u32 v248, 0, v253
v_lshlrev_b32 v254, 1, v235
v_xor_b32 v254, v254, v255
v_lshlrev_b32 v254, 4, v254
v_lshl_add_u32 v253, v252, 8, v254
v_add_u32 v253, s8, v253
v_add_u32 v249, 1024, v253
v_add_u32 v250, 128, v253
s_add_u32 s9, s74, 0
s_and_b32 s9, s9, 0x3ffff
s_add_u32 m0, s76, 0
s_nop 0
buffer_load_dwordx4 v245, s[52:55], s9 offen nt lds
buffer_load_dwordx4 v246, s[52:55], s9 offen offset:1088 nt lds
buffer_load_dwordx4 v247, s[52:55], s9 offen offset:2176 nt lds
buffer_load_dwordx4 v248, s[52:55], s9 offen offset:3264 nt lds
s_add_u32 s9, s74, 8192
s_and_b32 s9, s9, 0x3ffff
s_add_u32 m0, s76, 17408
s_nop 0
buffer_load_dwordx4 v245, s[52:55], s9 offen nt lds
buffer_load_dwordx4 v246, s[52:55], s9 offen offset:1088 nt lds
buffer_load_dwordx4 v247, s[52:55], s9 offen offset:2176 nt lds
buffer_load_dwordx4 v248, s[52:55], s9 offen offset:3264 nt lds
s_add_u32 s9, s74, 0
s_and_b32 s9, s9, 0x3ffff
s_add_u32 m0, s77, 69632
s_nop 0
buffer_load_dwordx4 v249, s[56:59], s9 offen nt lds
buffer_load_dwordx4 v250, s[56:59], s9 offen offset:1024 nt lds
buffer_load_dwordx4 v249, s[56:59], s9 offen offset:2048 nt lds
buffer_load_dwordx4 v250, s[56:59], s9 offen offset:3072 nt lds
v_lshl_add_u32 v216, v251, 4, s8
v_mul_u32_u24 v253, 1152, v252
v_add_u32 v253, v253, v254
s_mul_i32 s8, s3, 9216
v_add_u32 v253, s8, v253
v_add_u32 v218, 2048, v253
v_add_u32 v219, 1152, v253
v_add_u32 v220, 256, v253
s_mul_i32 s8, s7, 294912
s_add_u32 s60, s24, s8
s_addc_u32 s61, s25, 0
s_sub_u32 s60, s60, 2048
s_subb_u32 s61, s61, 0
s_and_b32 s61, s61, 0xffff
s_mov_b32 s62, 296960
s_mov_b32 s63, 0x20000
s_lshl_b32 s8, s6, 4
s_add_u32 s8, s8, s7
s_lshl_b32 s9, s69, 7
s_add_u32 s8, s8, s9
s_lshr_b32 s9, s8, 4
s_mul_i32 s9, s9, 2654208
s_add_u32 s64, s40, s9
s_addc_u32 s65, s41, 0
s_and_b32 s65, s65, 0xffff
s_mov_b32 s66, 2654208
s_mov_b32 s67, 0x20000
s_add_u32 s32, s24, s68
s_addc_u32 s33, s25, 0
s_and_b32 s33, s33, 0xffff
s_mov_b32 s34, 9216
s_mov_b32 s35, 0x20000
s_mul_i32 s82, s3, 3072
s_mov_b32 s75, 0x45000000
s_mov_b32 s83, 0x3e0293ee
v_and_b32 v252, 1, v233
v_lshlrev_b32 v252, 1, v252
v_xor_b32 v252, v252, v233
v_xor_b32 v252, v252, v235
v_lshlrev_b32 v252, 4, v252
v_lshl_add_u32 v252, v236, 6, v252
s_lshl_b32 s8, s5, 12
s_add_u32 s8, s8, 111616
v_add_u32 v200, s8, v252
v_add_u32 v201, 119808, v252
v_lshlrev_b32 v252, 12, v235
v_lshl_add_u32 v252, v233, 7, v252
v_lshl_add_u32 v252, v234, 3, v252
v_and_b32 v253, 1, v235
v_lshlrev_b32 v253, 1, v253
v_lshrrev_b32 v254, 1, v233
v_or_b32 v253, v253, v254
s_xor_b32 s9, s5, 0
s_lshl_b32 s8, s4, 1
s_add_u32 s8, s8, s9
s_lshl_b32 s8, s8, 10
s_add_u32 s8, s8, 120832
v_add_u32 v255, s8, v252
v_xor_b32 v254, 0, v253
v_lshl_add_u32 v202, v254, 5, v255
v_xor_b32 v254, 1, v253
v_lshl_add_u32 v203, v254, 5, v255
v_xor_b32 v254, 2, v253
v_lshl_add_u32 v204, v254, 5, v255
v_xor_b32 v254, 3, v253
v_lshl_add_u32 v205, v254, 5, v255
s_xor_b32 s9, s5, 1
s_lshl_b32 s8, s4, 1
s_add_u32 s8, s8, s9
s_lshl_b32 s8, s8, 10
s_add_u32 s8, s8, 120832
v_add_u32 v255, s8, v252
v_xor_b32 v254, 0, v253
v_lshl_add_u32 v206, v254, 5, v255
v_xor_b32 v254, 1, v253
v_lshl_add_u32 v207, v254, 5, v255
v_xor_b32 v254, 2, v253
v_lshl_add_u32 v208, v254, 5, v255
v_xor_b32 v254, 3, v253
v_lshl_add_u32 v209, v254, 5, v255
v_accvgpr_write_b32 a0, 0
v_accvgpr_write_b32 a1, 0
v_accvgpr_write_b32 a2, 0
v_accvgpr_write_b32 a3, 0
v_accvgpr_write_b32 a4, 0
v_accvgpr_write_b32 a5, 0
v_accvgpr_write_b32 a6, 0
v_accvgpr_write_b32 a7, 0
v_accvgpr_write_b32 a8, 0
v_accvgpr_write_b32 a9, 0
v_accvgpr_write_b32 a10, 0
v_accvgpr_write_b32 a11, 0
v_accvgpr_write_b32 a12, 0
v_accvgpr_write_b32 a13, 0
v_accvgpr_write_b32 a14, 0
v_accvgpr_write_b32 a15, 0
v_accvgpr_write_b32 a16, 0
v_accvgpr_write_b32 a17, 0
v_accvgpr_write_b32 a18, 0
v_accvgpr_write_b32 a19, 0
v_accvgpr_write_b32 a20, 0
v_accvgpr_write_b32 a21, 0
v_accvgpr_write_b32 a22, 0
v_accvgpr_write_b32 a23, 0
v_accvgpr_write_b32 a24, 0
v_accvgpr_write_b32 a25, 0
v_accvgpr_write_b32 a26, 0
v_accvgpr_write_b32 a27, 0
v_accvgpr_write_b32 a28, 0
v_accvgpr_write_b32 a29, 0
v_accvgpr_write_b32 a30, 0
v_accvgpr_write_b32 a31, 0
v_accvgpr_write_b32 a32, 0
v_accvgpr_write_b32 a33, 0
v_accvgpr_write_b32 a34, 0
v_accvgpr_write_b32 a35, 0
v_accvgpr_write_b32 a36, 0
v_accvgpr_write_b32 a37, 0
v_accvgpr_write_b32 a38, 0
v_accvgpr_write_b32 a39, 0
v_accvgpr_write_b32 a40, 0
v_accvgpr_write_b32 a41, 0
v_accvgpr_write_b32 a42, 0
v_accvgpr_write_b32 a43, 0
v_accvgpr_write_b32 a44, 0
v_accvgpr_write_b32 a45, 0
v_accvgpr_write_b32 a46, 0
v_accvgpr_write_b32 a47, 0
v_accvgpr_write_b32 a48, 0
v_accvgpr_write_b32 a49, 0
v_accvgpr_write_b32 a50, 0
v_accvgpr_write_b32 a51, 0
v_accvgpr_write_b32 a52, 0
v_accvgpr_write_b32 a53, 0
v_accvgpr_write_b32 a54, 0
v_accvgpr_write_b32 a55, 0
v_accvgpr_write_b32 a56, 0
v_accvgpr_write_b32 a57, 0
v_accvgpr_write_b32 a58, 0
v_accvgpr_write_b32 a59, 0
v_accvgpr_write_b32 a60, 0
v_accvgpr_write_b32 a61, 0
v_accvgpr_write_b32 a62, 0
v_accvgpr_write_b32 a63, 0
v_accvgpr_write_b32 a64, 0
v_accvgpr_write_b32 a65, 0
v_accvgpr_write_b32 a66, 0
v_accvgpr_write_b32 a67, 0
v_accvgpr_write_b32 a68, 0
v_accvgpr_write_b32 a69, 0
v_accvgpr_write_b32 a70, 0
v_accvgpr_write_b32 a71, 0
v_accvgpr_write_b32 a72, 0
v_accvgpr_write_b32 a73, 0
v_accvgpr_write_b32 a74, 0
v_accvgpr_write_b32 a75, 0
v_accvgpr_write_b32 a76, 0
v_accvgpr_write_b32 a77, 0
v_accvgpr_write_b32 a78, 0
v_accvgpr_write_b32 a79, 0
v_accvgpr_write_b32 a80, 0
v_accvgpr_write_b32 a81, 0
v_accvgpr_write_b32 a82, 0
v_accvgpr_write_b32 a83, 0
v_accvgpr_write_b32 a84, 0
v_accvgpr_write_b32 a85, 0
v_accvgpr_write_b32 a86, 0
v_accvgpr_write_b32 a87, 0
v_accvgpr_write_b32 a88, 0
v_accvgpr_write_b32 a89, 0
v_accvgpr_write_b32 a90, 0
v_accvgpr_write_b32 a91, 0
v_accvgpr_write_b32 a92, 0
v_accvgpr_write_b32 a93, 0
v_accvgpr_write_b32 a94, 0
v_accvgpr_write_b32 a95, 0
v_accvgpr_write_b32 a96, 0
v_accvgpr_write_b32 a97, 0
v_accvgpr_write_b32 a98, 0
v_accvgpr_write_b32 a99, 0
v_accvgpr_write_b32 a100, 0
v_accvgpr_write_b32 a101, 0
v_accvgpr_write_b32 a102, 0
v_accvgpr_write_b32 a103, 0
v_accvgpr_write_b32 a104, 0
v_accvgpr_write_b32 a105, 0
v_accvgpr_write_b32 a106, 0
v_accvgpr_write_b32 a107, 0
v_accvgpr_write_b32 a108, 0
v_accvgpr_write_b32 a109, 0
v_accvgpr_write_b32 a110, 0
v_accvgpr_write_b32 a111, 0
v_accvgpr_write_b32 a112, 0
v_accvgpr_write_b32 a113, 0
v_accvgpr_write_b32 a114, 0
v_accvgpr_write_b32 a115, 0
v_accvgpr_write_b32 a116, 0
v_accvgpr_write_b32 a117, 0
v_accvgpr_write_b32 a118, 0
v_accvgpr_write_b32 a119, 0
v_accvgpr_write_b32 a120, 0
v_accvgpr_write_b32 a121, 0
v_accvgpr_write_b32 a122, 0
v_accvgpr_write_b32 a123, 0
v_accvgpr_write_b32 a124, 0
v_accvgpr_write_b32 a125, 0
v_accvgpr_write_b32 a126, 0
v_accvgpr_write_b32 a127, 0
v_accvgpr_write_b32 a128, 0
v_accvgpr_write_b32 a129, 0
v_accvgpr_write_b32 a130, 0
v_accvgpr_write_b32 a131, 0
v_accvgpr_write_b32 a132, 0
v_accvgpr_write_b32 a133, 0
v_accvgpr_write_b32 a134, 0
v_accvgpr_write_b32 a135, 0
v_accvgpr_write_b32 a136, 0
v_accvgpr_write_b32 a137, 0
v_accvgpr_write_b32 a138, 0
v_accvgpr_write_b32 a139, 0
v_accvgpr_write_b32 a140, 0
v_accvgpr_write_b32 a141, 0
v_accvgpr_write_b32 a142, 0
v_accvgpr_write_b32 a143, 0
v_accvgpr_write_b32 a144, 0
v_accvgpr_write_b32 a145, 0
v_accvgpr_write_b32 a146, 0
v_accvgpr_write_b32 a147, 0
v_accvgpr_write_b32 a148, 0
v_accvgpr_write_b32 a149, 0
v_accvgpr_write_b32 a150, 0
v_accvgpr_write_b32 a151, 0
v_accvgpr_write_b32 a152, 0
v_accvgpr_write_b32 a153, 0
v_accvgpr_write_b32 a154, 0
v_accvgpr_write_b32 a155, 0
v_accvgpr_write_b32 a156, 0
v_accvgpr_write_b32 a157, 0
v_accvgpr_write_b32 a158, 0
v_accvgpr_write_b32 a159, 0
s_waitcnt vmcnt(35)
s_barrier
ds_read_b64_tr_b16 v[144:145], v202
ds_read_b64_tr_b16 v[146:147], v202 offset:512
ds_read_b64_tr_b16 v[148:149], v203
ds_read_b64_tr_b16 v[150:151], v203 offset:512
ds_read_b64_tr_b16 v[152:153], v204
ds_read_b64_tr_b16 v[154:155], v204 offset:512
ds_read_b128 v[160:163], v200
s_waitcnt lgkmcnt(0)
ds_read_b128 v[164:167], v200 offset:1024
ds_read_b128 v[168:171], v200 offset:2048
ds_read_b128 v[172:175], v200 offset:3072
ds_read_b128 v[176:179], v201
v_mfma_f32_16x16x32_bf16 v[0:3], v[144:147], v[160:163], 0
s_waitcnt lgkmcnt(3)
ds_read_b64_tr_b16 v[156:157], v205
ds_read_b64_tr_b16 v[158:159], v205 offset:512
v_mfma_f32_16x16x32_bf16 v[4:7], v[144:147], v[164:167], 0
s_waitcnt lgkmcnt(4)
v_add_u32 v200, 25600, v200
v_add_u32 v202, 25600, v202
v_mfma_f32_16x16x32_bf16 v[8:11], v[144:147], v[168:171], 0
s_waitcnt lgkmcnt(3)
v_add_u32 v201, 25600, v201
v_add_u32 v203, 25600, v203
v_mfma_f32_16x16x32_bf16 v[12:15], v[144:147], v[172:175], 0
s_waitcnt lgkmcnt(2)
v_add_u32 v204, 25600, v204
v_add_u32 v205, 25600, v205
v_mfma_f32_16x16x32_bf16 v[128:131], v[144:147], v[176:179], 0
ds_read_b64_tr_b16 v[144:145], v206
ds_read_b64_tr_b16 v[146:147], v206 offset:512
v_mfma_f32_16x16x32_bf16 v[16:19], v[148:151], v[160:163], 0
v_add_u32 v206, 25600, v206
v_mfma_f32_16x16x32_bf16 v[20:23], v[148:151], v[164:167], 0
v_mfma_f32_16x16x32_bf16 v[24:27], v[148:151], v[168:171], 0
v_mfma_f32_16x16x32_bf16 v[28:31], v[148:151], v[172:175], 0
v_mfma_f32_16x16x32_bf16 v[132:135], v[148:151], v[176:179], 0
ds_read_b64_tr_b16 v[148:149], v207
ds_read_b64_tr_b16 v[150:151], v207 offset:512
v_mfma_f32_16x16x32_bf16 v[32:35], v[152:155], v[160:163], 0
v_add_u32 v207, 25600, v207
v_mfma_f32_16x16x32_bf16 v[36:39], v[152:155], v[164:167], 0
v_mfma_f32_16x16x32_bf16 v[40:43], v[152:155], v[168:171], 0
v_mfma_f32_16x16x32_bf16 v[44:47], v[152:155], v[172:175], 0
v_mfma_f32_16x16x32_bf16 v[136:139], v[152:155], v[176:179], 0
s_waitcnt lgkmcnt(2)
ds_read_b64_tr_b16 v[152:153], v208
ds_read_b64_tr_b16 v[154:155], v208 offset:512
v_mfma_f32_16x16x32_bf16 v[48:51], v[156:159], v[160:163], 0
v_add_u32 v208, 25600, v208
v_mfma_f32_16x16x32_bf16 v[52:55], v[156:159], v[164:167], 0
v_mfma_f32_16x16x32_bf16 v[56:59], v[156:159], v[168:171], 0
v_mfma_f32_16x16x32_bf16 v[60:63], v[156:159], v[172:175], 0
v_mfma_f32_16x16x32_bf16 v[140:143], v[156:159], v[176:179], 0
ds_read_b64_tr_b16 v[156:157], v209
s_waitcnt vmcnt(28)
s_barrier
v_mfma_f32_16x16x32_bf16 v[64:67], v[144:147], v[160:163], 0
s_add_u32 m0, s78, 86016
s_add_u32 s42, s42, 64
s_add_u32 s43, s43, 262144
buffer_load_dwordx4 v238, s[44:47], s42 offen lds
v_mfma_f32_16x16x32_bf16 v[68:71], v[144:147], v[164:167], 0
ds_read_b64_tr_b16 v[158:159], v209 offset:512
v_add_u32 v209, 25600, v209
v_mfma_f32_16x16x32_bf16 v[72:75], v[144:147], v[168:171], 0
ds_read_b128 v[180:183], v200
v_mfma_f32_16x16x32_bf16 v[76:79], v[144:147], v[172:175], 0
s_waitcnt lgkmcnt(2)
ds_read_b64_tr_b16 v[144:145], v202
ds_read_b64_tr_b16 v[146:147], v202 offset:512
v_mfma_f32_16x16x32_bf16 v[80:83], v[148:151], v[160:163], 0
ds_read_b128 v[184:187], v200 offset:1024
buffer_load_dwordx4 v239, s[44:47], s42 offen offset:1024 lds
v_mfma_f32_16x16x32_bf16 v[84:87], v[148:151], v[164:167], 0
ds_read_b128 v[188:191], v200 offset:2048
v_add_u32 v202, 4294864896, v202
v_mfma_f32_16x16x32_bf16 v[88:91], v[148:151], v[168:171], 0
ds_read_b128 v[192:195], v200 offset:3072
v_add_u32 v200, 4294864896, v200
v_mfma_f32_16x16x32_bf16 v[92:95], v[148:151], v[172:175], 0
ds_read_b128 v[196:199], v201
v_add_u32 v201, 4294864896, v201
v_mfma_f32_16x16x32_bf16 v[96:99], v[152:155], v[160:163], 0
ds_read_b64_tr_b16 v[148:149], v203
ds_read_b64_tr_b16 v[150:151], v203 offset:512
v_mfma_f32_16x16x32_bf16 v[100:103], v[152:155], v[164:167], 0
s_mov_b32 m0, 94208
s_mov_b64 exec, s[80:81]
buffer_load_dwordx4 v240, s[44:47], s42 offen lds
s_add_u32 m0, s79, 86016
s_mov_b64 exec, -1
v_add_u32 v203, 4294864896, v203
v_mfma_f32_16x16x32_bf16 v[104:107], v[152:155], v[168:171], 0
v_mfma_f32_16x16x32_bf16 v[108:111], v[152:155], v[172:175], 0
s_waitcnt lgkmcnt(2)
ds_read_b64_tr_b16 v[152:153], v204
ds_read_b64_tr_b16 v[154:155], v204 offset:512
v_mfma_f32_16x16x32_bf16 v[112:115], v[156:159], v[160:163], 0
v_add_u32 v204, 4294864896, v204
v_mfma_f32_16x16x32_bf16 v[116:119], v[156:159], v[164:167], 0
buffer_load_dwordx4 v241, s[48:51], s43 offen lds
v_mfma_f32_16x16x32_bf16 v[120:123], v[156:159], v[168:171], 0
v_mfma_f32_16x16x32_bf16 v[124:127], v[156:159], v[172:175], 0
ds_read_b64_tr_b16 v[156:157], v205
ds_read_b64_tr_b16 v[158:159], v205 offset:512
v_mfma_f32_16x16x32_bf16 v[0:3], v[144:147], v[180:183], v[0:3]
v_add_u32 v205, 4294864896, v205
v_mfma_f32_16x16x32_bf16 v[4:7], v[144:147], v[184:187], v[4:7]
v_mfma_f32_16x16x32_bf16 v[8:11], v[144:147], v[188:191], v[8:11]
buffer_load_dwordx4 v242, s[48:51], s43 offen offset:1024 lds
v_mfma_f32_16x16x32_bf16 v[12:15], v[144:147], v[192:195], v[12:15]
v_mfma_f32_16x16x32_bf16 v[128:131], v[144:147], v[196:199], v[128:131]
s_waitcnt lgkmcnt(2)
ds_read_b64_tr_b16 v[144:145], v206
ds_read_b64_tr_b16 v[146:147], v206 offset:512
v_mfma_f32_16x16x32_bf16 v[16:19], v[148:151], v[180:183], v[16:19]
v_add_u32 v206, 4294864896, v206
v_mfma_f32_16x16x32_bf16 v[20:23], v[148:151], v[184:187], v[20:23]
buffer_load_dwordx4 v243, s[48:51], s43 offen offset:2048 lds
v_mfma_f32_16x16x32_bf16 v[24:27], v[148:151], v[188:191], v[24:27]
v_mfma_f32_16x16x32_bf16 v[28:31], v[148:151], v[192:195], v[28:31]
v_mfma_f32_16x16x32_bf16 v[132:135], v[148:151], v[196:199], v[132:135]
ds_read_b64_tr_b16 v[148:149], v207
ds_read_b64_tr_b16 v[150:151], v207 offset:512
v_mfma_f32_16x16x32_bf16 v[32:35], v[152:155], v[180:183], v[32:35]
v_add_u32 v207, 4294864896, v207
v_mfma_f32_16x16x32_bf16 v[36:39], v[152:155], v[184:187], v[36:39]
buffer_load_dwordx4 v244, s[48:51], s43 offen offset:3072 lds
v_mfma_f32_16x16x32_bf16 v[40:43], v[152:155], v[188:191], v[40:43]
v_mfma_f32_16x16x32_bf16 v[44:47], v[152:155], v[192:195], v[44:47]
v_mfma_f32_16x16x32_bf16 v[136:139], v[152:155], v[196:199], v[136:139]
s_waitcnt lgkmcnt(2)
ds_read_b64_tr_b16 v[152:153], v208
ds_read_b64_tr_b16 v[154:155], v208 offset:512
v_mfma_f32_16x16x32_bf16 v[48:51], v[156:159], v[180:183], v[48:51]
v_add_u32 v208, 4294864896, v208
v_mfma_f32_16x16x32_bf16 v[52:55], v[156:159], v[184:187], v[52:55]
v_mfma_f32_16x16x32_bf16 v[56:59], v[156:159], v[188:191], v[56:59]
v_mfma_f32_16x16x32_bf16 v[60:63], v[156:159], v[192:195], v[60:63]
v_mfma_f32_16x16x32_bf16 v[140:143], v[156:159], v[196:199], v[140:143]
ds_read_b64_tr_b16 v[156:157], v209
s_waitcnt vmcnt(28)
s_barrier
v_mfma_f32_16x16x32_bf16 v[64:67], v[144:147], v[180:183], v[64:67]
s_add_u32 m0, s78, 111616
s_add_u32 s42, s42, 64
s_add_u32 s43, s43, 262144
buffer_load_dwordx4 v238, s[44:47], s42 offen lds
v_mfma_f32_16x16x32_bf16 v[68:71], v[144:147], v[184:187], v[68:71]
ds_read_b64_tr_b16 v[158:159], v209 offset:512
v_add_u32 v209, 4294864896, v209
v_mfma_f32_16x16x32_bf16 v[72:75], v[144:147], v[188:191], v[72:75]
ds_read_b128 v[160:163], v200
v_mfma_f32_16x16x32_bf16 v[76:79], v[144:147], v[192:195], v[76:79]
s_waitcnt lgkmcnt(2)
ds_read_b64_tr_b16 v[144:145], v202
ds_read_b64_tr_b16 v[146:147], v202 offset:512
v_mfma_f32_16x16x32_bf16 v[80:83], v[148:151], v[180:183], v[80:83]
ds_read_b128 v[164:167], v200 offset:1024
buffer_load_dwordx4 v239, s[44:47], s42 offen offset:1024 lds
v_mfma_f32_16x16x32_bf16 v[84:87], v[148:151], v[184:187], v[84:87]
ds_read_b128 v[168:171], v200 offset:2048
v_add_u32 v202, 51200, v202
v_mfma_f32_16x16x32_bf16 v[88:91], v[148:151], v[188:191], v[88:91]
ds_read_b128 v[172:175], v200 offset:3072
v_add_u32 v200, 51200, v200
v_mfma_f32_16x16x32_bf16 v[92:95], v[148:151], v[192:195], v[92:95]
ds_read_b128 v[176:179], v201
v_add_u32 v201, 51200, v201
v_mfma_f32_16x16x32_bf16 v[96:99], v[152:155], v[180:183], v[96:99]
ds_read_b64_tr_b16 v[148:149], v203
ds_read_b64_tr_b16 v[150:151], v203 offset:512
v_mfma_f32_16x16x32_bf16 v[100:103], v[152:155], v[184:187], v[100:103]
s_mov_b32 m0, 119808
s_mov_b64 exec, s[80:81]
buffer_load_dwordx4 v240, s[44:47], s42 offen lds
s_add_u32 m0, s79, 111616
s_mov_b64 exec, -1
v_add_u32 v203, 51200, v203
v_mfma_f32_16x16x32_bf16 v[104:107], v[152:155], v[188:191], v[104:107]
v_mfma_f32_16x16x32_bf16 v[108:111], v[152:155], v[192:195], v[108:111]
s_waitcnt lgkmcnt(2)
ds_read_b64_tr_b16 v[152:153], v204
ds_read_b64_tr_b16 v[154:155], v204 offset:512
v_mfma_f32_16x16x32_bf16 v[112:115], v[156:159], v[180:183], v[112:115]
v_add_u32 v204, 51200, v204
v_mfma_f32_16x16x32_bf16 v[116:119], v[156:159], v[184:187], v[116:119]
buffer_load_dwordx4 v241, s[48:51], s43 offen lds
v_mfma_f32_16x16x32_bf16 v[120:123], v[156:159], v[188:191], v[120:123]
v_mfma_f32_16x16x32_bf16 v[124:127], v[156:159], v[192:195], v[124:127]
ds_read_b64_tr_b16 v[156:157], v205
ds_read_b64_tr_b16 v[158:159], v205 offset:512
v_mfma_f32_16x16x32_bf16 v[0:3], v[144:147], v[160:163], v[0:3]
v_add_u32 v205, 51200, v205
s_mov_b32 s72, 3
LB_qloop:
v_mfma_f32_16x16x32_bf16 v[4:7], v[144:147], v[164:167], v[4:7]
v_mfma_f32_16x16x32_bf16 v[8:11], v[144:147], v[168:171], v[8:11]
buffer_load_dwordx4 v242, s[48:51], s43 offen offset:1024 lds
v_mfma_f32_16x16x32_bf16 v[12:15], v[144:147], v[172:175], v[12:15]
v_mfma_f32_16x16x32_bf16 v[128:131], v[144:147], v[176:179], v[128:131]
s_waitcnt lgkmcnt(2)
ds_read_b64_tr_b16 v[144:145], v206
ds_read_b64_tr_b16 v[146:147], v206 offset:512
v_mfma_f32_16x16x32_bf16 v[16:19], v[148:151], v[160:163], v[16:19]
v_add_u32 v206, 51200, v206
v_mfma_f32_16x16x32_bf16 v[20:23], v[148:151], v[164:167], v[20:23]
buffer_load_dwordx4 v243, s[48:51], s43 offen offset:2048 lds
v_mfma_f32_16x16x32_bf16 v[24:27], v[148:151], v[168:171], v[24:27]
v_mfma_f32_16x16x32_bf16 v[28:31], v[148:151], v[172:175], v[28:31]
v_mfma_f32_16x16x32_bf16 v[132:135], v[148:151], v[176:179], v[132:135]
ds_read_b64_tr_b16 v[148:149], v207
ds_read_b64_tr_b16 v[150:151], v207 offset:512
v_mfma_f32_16x16x32_bf16 v[32:35], v[152:155], v[160:163], v[32:35]
v_add_u32 v207, 51200, v207
v_mfma_f32_16x16x32_bf16 v[36:39], v[152:155], v[164:167], v[36:39]
buffer_load_dwordx4 v244, s[48:51], s43 offen offset:3072 lds
v_mfma_f32_16x16x32_bf16 v[40:43], v[152:155], v[168:171], v[40:43]
v_mfma_f32_16x16x32_bf16 v[44:47], v[152:155], v[172:175], v[44:47]
v_mfma_f32_16x16x32_bf16 v[136:139], v[152:155], v[176:179], v[136:139]
s_waitcnt lgkmcnt(2)
ds_read_b64_tr_b16 v[152:153], v208
ds_read_b64_tr_b16 v[154:155], v208 offset:512
v_mfma_f32_16x16x32_bf16 v[48:51], v[156:159], v[160:163], v[48:51]
v_add_u32 v208, 51200, v208
v_mfma_f32_16x16x32_bf16 v[52:55], v[156:159], v[164:167], v[52:55]
v_mfma_f32_16x16x32_bf16 v[56:59], v[156:159], v[168:171], v[56:59]
v_mfma_f32_16x16x32_bf16 v[60:63], v[156:159], v[172:175], v[60:63]
v_mfma_f32_16x16x32_bf16 v[140:143], v[156:159], v[176:179], v[140:143]
ds_read_b64_tr_b16 v[156:157], v209
s_waitcnt vmcnt(7)
s_barrier
v_mfma_f32_16x16x32_bf16 v[64:67], v[144:147], v[160:163], v[64:67]
s_add_u32 m0, s78, 137216
s_add_u32 s42, s42, 64
s_add_u32 s43, s43, 262144
buffer_load_dwordx4 v238, s[44:47], s42 offen lds
v_mfma_f32_16x16x32_bf16 v[68:71], v[144:147], v[164:167], v[68:71]
ds_read_b64_tr_b16 v[158:159], v209 offset:512
v_add_u32 v209, 51200, v209
v_mfma_f32_16x16x32_bf16 v[72:75], v[144:147], v[168:171], v[72:75]
ds_read_b128 v[180:183], v200
v_mfma_f32_16x16x32_bf16 v[76:79], v[144:147], v[172:175], v[76:79]
s_waitcnt lgkmcnt(2)
ds_read_b64_tr_b16 v[144:145], v202
ds_read_b64_tr_b16 v[146:147], v202 offset:512
v_mfma_f32_16x16x32_bf16 v[80:83], v[148:151], v[160:163], v[80:83]
ds_read_b128 v[184:187], v200 offset:1024
buffer_load_dwordx4 v239, s[44:47], s42 offen offset:1024 lds
v_mfma_f32_16x16x32_bf16 v[84:87], v[148:151], v[164:167], v[84:87]
ds_read_b128 v[188:191], v200 offset:2048
v_add_u32 v202, 25600, v202
v_mfma_f32_16x16x32_bf16 v[88:91], v[148:151], v[168:171], v[88:91]
ds_read_b128 v[192:195], v200 offset:3072
v_add_u32 v200, 25600, v200
v_mfma_f32_16x16x32_bf16 v[92:95], v[148:151], v[172:175], v[92:95]
ds_read_b128 v[196:199], v201
v_add_u32 v201, 25600, v201
v_mfma_f32_16x16x32_bf16 v[96:99], v[152:155], v[160:163], v[96:99]
ds_read_b64_tr_b16 v[148:149], v203
ds_read_b64_tr_b16 v[150:151], v203 offset:512
v_mfma_f32_16x16x32_bf16 v[100:103], v[152:155], v[164:167], v[100:103]
s_mov_b32 m0, 145408
s_mov_b64 exec, s[80:81]
buffer_load_dwordx4 v240, s[44:47], s42 offen lds
s_add_u32 m0, s79, 137216
s_mov_b64 exec, -1
v_add_u32 v203, 25600, v203
v_mfma_f32_16x16x32_bf16 v[104:107], v[152:155], v[168:171], v[104:107]
v_mfma_f32_16x16x32_bf16 v[108:111], v[152:155], v[172:175], v[108:111]
s_waitcnt lgkmcnt(2)
ds_read_b64_tr_b16 v[152:153], v204
ds_read_b64_tr_b16 v[154:155], v204 offset:512
v_mfma_f32_16x16x32_bf16 v[112:115], v[156:159], v[160:163], v[112:115]
v_add_u32 v204, 25600, v204
v_mfma_f32_16x16x32_bf16 v[116:119], v[156:159], v[164:167], v[116:119]
buffer_load_dwordx4 v241, s[48:51], s43 offen lds
v_mfma_f32_16x16x32_bf16 v[120:123], v[156:159], v[168:171], v[120:123]
v_mfma_f32_16x16x32_bf16 v[124:127], v[156:159], v[172:175], v[124:127]
ds_read_b64_tr_b16 v[156:157], v205
ds_read_b64_tr_b16 v[158:159], v205 offset:512
v_mfma_f32_16x16x32_bf16 v[0:3], v[144:147], v[180:183], v[0:3]
v_add_u32 v205, 25600, v205
v_mfma_f32_16x16x32_bf16 v[4:7], v[144:147], v[184:187], v[4:7]
v_mfma_f32_16x16x32_bf16 v[8:11], v[144:147], v[188:191], v[8:11]
buffer_load_dwordx4 v242, s[48:51], s43 offen offset:1024 lds
v_mfma_f32_16x16x32_bf16 v[12:15], v[144:147], v[192:195], v[12:15]
v_mfma_f32_16x16x32_bf16 v[128:131], v[144:147], v[196:199], v[128:131]
s_waitcnt lgkmcnt(2)
ds_read_b64_tr_b16 v[144:145], v206
ds_read_b64_tr_b16 v[146:147], v206 offset:512
v_mfma_f32_16x16x32_bf16 v[16:19], v[148:151], v[180:183], v[16:19]
v_add_u32 v206, 25600, v206
v_mfma_f32_16x16x32_bf16 v[20:23], v[148:151], v[184:187], v[20:23]
buffer_load_dwordx4 v243, s[48:51], s43 offen offset:2048 lds
v_mfma_f32_16x16x32_bf16 v[24:27], v[148:151], v[188:191], v[24:27]
v_mfma_f32_16x16x32_bf16 v[28:31], v[148:151], v[192:195], v[28:31]
v_mfma_f32_16x16x32_bf16 v[132:135], v[148:151], v[196:199], v[132:135]
ds_read_b64_tr_b16 v[148:149], v207
ds_read_b64_tr_b16 v[150:151], v207 offset:512
v_mfma_f32_16x16x32_bf16 v[32:35], v[152:155], v[180:183], v[32:35]
v_add_u32 v207, 25600, v207
v_mfma_f32_16x16x32_bf16 v[36:39], v[152:155], v[184:187], v[36:39]
buffer_load_dwordx4 v244, s[48:51], s43 offen offset:3072 lds
v_mfma_f32_16x16x32_bf16 v[40:43], v[152:155], v[188:191], v[40:43]
v_mfma_f32_16x16x32_bf16 v[44:47], v[152:155], v[192:195], v[44:47]
v_mfma_f32_16x16x32_bf16 v[136:139], v[152:155], v[196:199], v[136:139]
s_waitcnt lgkmcnt(2)
ds_read_b64_tr_b16 v[152:153], v208
ds_read_b64_tr_b16 v[154:155], v208 offset:512
v_mfma_f32_16x16x32_bf16 v[48:51], v[156:159], v[180:183], v[48:51]
v_add_u32 v208, 25600, v208
v_mfma_f32_16x16x32_bf16 v[52:55], v[156:159], v[184:187], v[52:55]
v_mfma_f32_16x16x32_bf16 v[56:59], v[156:159], v[188:191], v[56:59]
v_mfma_f32_16x16x32_bf16 v[60:63], v[156:159], v[192:195], v[60:63]
v_mfma_f32_16x16x32_bf16 v[140:143], v[156:159], v[196:199], v[140:143]
ds_read_b64_tr_b16 v[156:157], v209
s_waitcnt vmcnt(7)
s_barrier
v_mfma_f32_16x16x32_bf16 v[64:67], v[144:147], v[180:183], v[64:67]
s_add_u32 m0, s78, 34816
s_add_u32 s42, s42, 64
s_add_u32 s43, s43, 262144
buffer_load_dwordx4 v238, s[44:47], s42 offen lds
v_mfma_f32_16x16x32_bf16 v[68:71], v[144:147], v[184:187], v[68:71]
ds_read_b64_tr_b16 v[158:159], v209 offset:512
v_add_u32 v209, 25600, v209
v_mfma_f32_16x16x32_bf16 v[72:75], v[144:147], v[188:191], v[72:75]
ds_read_b128 v[160:163], v200
v_mfma_f32_16x16x32_bf16 v[76:79], v[144:147], v[192:195], v[76:79]
s_waitcnt lgkmcnt(2)
ds_read_b64_tr_b16 v[144:145], v202
ds_read_b64_tr_b16 v[146:147], v202 offset:512
v_mfma_f32_16x16x32_bf16 v[80:83], v[148:151], v[180:183], v[80:83]
ds_read_b128 v[164:167], v200 offset:1024
buffer_load_dwordx4 v239, s[44:47], s42 offen offset:1024 lds
v_mfma_f32_16x16x32_bf16 v[84:87], v[148:151], v[184:187], v[84:87]
ds_read_b128 v[168:171], v200 offset:2048
v_add_u32 v202, 25600, v202
v_mfma_f32_16x16x32_bf16 v[88:91], v[148:151], v[188:191], v[88:91]
ds_read_b128 v[172:175], v200 offset:3072
v_add_u32 v200, 25600, v200
v_mfma_f32_16x16x32_bf16 v[92:95], v[148:151], v[192:195], v[92:95]
ds_read_b128 v[176:179], v201
v_add_u32 v201, 25600, v201
v_mfma_f32_16x16x32_bf16 v[96:99], v[152:155], v[180:183], v[96:99]
ds_read_b64_tr_b16 v[148:149], v203
ds_read_b64_tr_b16 v[150:151], v203 offset:512
v_mfma_f32_16x16x32_bf16 v[100:103], v[152:155], v[184:187], v[100:103]
s_mov_b32 m0, 43008
s_mov_b64 exec, s[80:81]
buffer_load_dwordx4 v240, s[44:47], s42 offen lds
s_add_u32 m0, s79, 34816
s_mov_b64 exec, -1
v_add_u32 v203, 25600, v203
v_mfma_f32_16x16x32_bf16 v[104:107], v[152:155], v[188:191], v[104:107]
v_mfma_f32_16x16x32_bf16 v[108:111], v[152:155], v[192:195], v[108:111]
s_waitcnt lgkmcnt(2)
ds_read_b64_tr_b16 v[152:153], v204
ds_read_b64_tr_b16 v[154:155], v204 offset:512
v_mfma_f32_16x16x32_bf16 v[112:115], v[156:159], v[180:183], v[112:115]
v_add_u32 v204, 25600, v204
v_mfma_f32_16x16x32_bf16 v[116:119], v[156:159], v[184:187], v[116:119]
buffer_load_dwordx4 v241, s[48:51], s43 offen lds
v_mfma_f32_16x16x32_bf16 v[120:123], v[156:159], v[188:191], v[120:123]
v_mfma_f32_16x16x32_bf16 v[124:127], v[156:159], v[192:195], v[124:127]
ds_read_b64_tr_b16 v[156:157], v205
ds_read_b64_tr_b16 v[158:159], v205 offset:512
v_mfma_f32_16x16x32_bf16 v[0:3], v[144:147], v[160:163], v[0:3]
v_add_u32 v205, 25600, v205
v_mfma_f32_16x16x32_bf16 v[4:7], v[144:147], v[164:167], v[4:7]
v_mfma_f32_16x16x32_bf16 v[8:11], v[144:147], v[168:171], v[8:11]
buffer_load_dwordx4 v242, s[48:51], s43 offen offset:1024 lds
v_mfma_f32_16x16x32_bf16 v[12:15], v[144:147], v[172:175], v[12:15]
v_mfma_f32_16x16x32_bf16 v[128:131], v[144:147], v[176:179], v[128:131]
s_waitcnt lgkmcnt(2)
ds_read_b64_tr_b16 v[144:145], v206
ds_read_b64_tr_b16 v[146:147], v206 offset:512
v_mfma_f32_16x16x32_bf16 v[16:19], v[148:151], v[160:163], v[16:19]
v_add_u32 v206, 25600, v206
v_mfma_f32_16x16x32_bf16 v[20:23], v[148:151], v[164:167], v[20:23]
buffer_load_dwordx4 v243, s[48:51], s43 offen offset:2048 lds
v_mfma_f32_16x16x32_bf16 v[24:27], v[148:151], v[168:171], v[24:27]
v_mfma_f32_16x16x32_bf16 v[28:31], v[148:151], v[172:175], v[28:31]
v_mfma_f32_16x16x32_bf16 v[132:135], v[148:151], v[176:179], v[132:135]
ds_read_b64_tr_b16 v[148:149], v207
ds_read_b64_tr_b16 v[150:151], v207 offset:512
v_mfma_f32_16x16x32_bf16 v[32:35], v[152:155], v[160:163], v[32:35]
v_add_u32 v207, 25600, v207
v_mfma_f32_16x16x32_bf16 v[36:39], v[152:155], v[164:167], v[36:39]
buffer_load_dwordx4 v244, s[48:51], s43 offen offset:3072 lds
v_mfma_f32_16x16x32_bf16 v[40:43], v[152:155], v[168:171], v[40:43]
v_mfma_f32_16x16x32_bf16 v[44:47], v[152:155], v[172:175], v[44:47]
v_mfma_f32_16x16x32_bf16 v[136:139], v[152:155], v[176:179], v[136:139]
s_waitcnt lgkmcnt(2)
ds_read_b64_tr_b16 v[152:153], v208
ds_read_b64_tr_b16 v[154:155], v208 offset:512
v_mfma_f32_16x16x32_bf16 v[48:51], v[156:159], v[160:163], v[48:51]
v_add_u32 v208, 25600, v208
v_mfma_f32_16x16x32_bf16 v[52:55], v[156:159], v[164:167], v[52:55]
v_mfma_f32_16x16x32_bf16 v[56:59], v[156:159], v[168:171], v[56:59]
v_mfma_f32_16x16x32_bf16 v[60:63], v[156:159], v[172:175], v[60:63]
v_mfma_f32_16x16x32_bf16 v[140:143], v[156:159], v[176:179], v[140:143]
ds_read_b64_tr_b16 v[156:157], v209
s_waitcnt vmcnt(7)
s_barrier
v_mfma_f32_16x16x32_bf16 v[64:67], v[144:147], v[160:163], v[64:67]
s_add_u32 m0, s78, 86016
s_add_u32 s42, s42, 64
s_add_u32 s43, s43, 262144
buffer_load_dwordx4 v238, s[44:47], s42 offen lds
v_mfma_f32_16x16x32_bf16 v[68:71], v[144:147], v[164:167], v[68:71]
ds_read_b64_tr_b16 v[158:159], v209 offset:512
v_add_u32 v209, 25600, v209
v_mfma_f32_16x16x32_bf16 v[72:75], v[144:147], v[168:171], v[72:75]
ds_read_b128 v[180:183], v200
v_mfma_f32_16x16x32_bf16 v[76:79], v[144:147], v[172:175], v[76:79]
s_waitcnt lgkmcnt(2)
ds_read_b64_tr_b16 v[144:145], v202
ds_read_b64_tr_b16 v[146:147], v202 offset:512
v_mfma_f32_16x16x32_bf16 v[80:83], v[148:151], v[160:163], v[80:83]
ds_read_b128 v[184:187], v200 offset:1024
buffer_load_dwordx4 v239, s[44:47], s42 offen offset:1024 lds
v_mfma_f32_16x16x32_bf16 v[84:87], v[148:151], v[164:167], v[84:87]
ds_read_b128 v[188:191], v200 offset:2048
v_add_u32 v202, 4294864896, v202
v_mfma_f32_16x16x32_bf16 v[88:91], v[148:151], v[168:171], v[88:91]
ds_read_b128 v[192:195], v200 offset:3072
v_add_u32 v200, 4294864896, v200
v_mfma_f32_16x16x32_bf16 v[92:95], v[148:151], v[172:175], v[92:95]
ds_read_b128 v[196:199], v201
v_add_u32 v201, 4294864896, v201
v_mfma_f32_16x16x32_bf16 v[96:99], v[152:155], v[160:163], v[96:99]
ds_read_b64_tr_b16 v[148:149], v203
ds_read_b64_tr_b16 v[150:151], v203 offset:512
v_mfma_f32_16x16x32_bf16 v[100:103], v[152:155], v[164:167], v[100:103]
s_mov_b32 m0, 94208
s_mov_b64 exec, s[80:81]
buffer_load_dwordx4 v240, s[44:47], s42 offen lds
s_add_u32 m0, s79, 86016
s_mov_b64 exec, -1
v_add_u32 v203, 4294864896, v203
v_mfma_f32_16x16x32_bf16 v[104:107], v[152:155], v[168:171], v[104:107]
v_mfma_f32_16x16x32_bf16 v[108:111], v[152:155], v[172:175], v[108:111]
s_waitcnt lgkmcnt(2)
ds_read_b64_tr_b16 v[152:153], v204
ds_read_b64_tr_b16 v[154:155], v204 offset:512
v_mfma_f32_16x16x32_bf16 v[112:115], v[156:159], v[160:163], v[112:115]
v_add_u32 v204, 4294864896, v204
v_mfma_f32_16x16x32_bf16 v[116:119], v[156:159], v[164:167], v[116:119]
buffer_load_dwordx4 v241, s[48:51], s43 offen lds
v_mfma_f32_16x16x32_bf16 v[120:123], v[156:159], v[168:171], v[120:123]
v_mfma_f32_16x16x32_bf16 v[124:127], v[156:159], v[172:175], v[124:127]
ds_read_b64_tr_b16 v[156:157], v205
ds_read_b64_tr_b16 v[158:159], v205 offset:512
v_mfma_f32_16x16x32_bf16 v[0:3], v[144:147], v[180:183], v[0:3]
v_add_u32 v205, 4294864896, v205
v_mfma_f32_16x16x32_bf16 v[4:7], v[144:147], v[184:187], v[4:7]
v_mfma_f32_16x16x32_bf16 v[8:11], v[144:147], v[188:191], v[8:11]
buffer_load_dwordx4 v242, s[48:51], s43 offen offset:1024 lds
v_mfma_f32_16x16x32_bf16 v[12:15], v[144:147], v[192:195], v[12:15]
v_mfma_f32_16x16x32_bf16 v[128:131], v[144:147], v[196:199], v[128:131]
s_waitcnt lgkmcnt(2)
ds_read_b64_tr_b16 v[144:145], v206
ds_read_b64_tr_b16 v[146:147], v206 offset:512
v_mfma_f32_16x16x32_bf16 v[16:19], v[148:151], v[180:183], v[16:19]
v_add_u32 v206, 4294864896, v206
v_mfma_f32_16x16x32_bf16 v[20:23], v[148:151], v[184:187], v[20:23]
buffer_load_dwordx4 v243, s[48:51], s43 offen offset:2048 lds
v_mfma_f32_16x16x32_bf16 v[24:27], v[148:151], v[188:191], v[24:27]
v_mfma_f32_16x16x32_bf16 v[28:31], v[148:151], v[192:195], v[28:31]
v_mfma_f32_16x16x32_bf16 v[132:135], v[148:151], v[196:199], v[132:135]
ds_read_b64_tr_b16 v[148:149], v207
ds_read_b64_tr_b16 v[150:151], v207 offset:512
v_mfma_f32_16x16x32_bf16 v[32:35], v[152:155], v[180:183], v[32:35]
v_add_u32 v207, 4294864896, v207
v_mfma_f32_16x16x32_bf16 v[36:39], v[152:155], v[184:187], v[36:39]
buffer_load_dwordx4 v244, s[48:51], s43 offen offset:3072 lds
v_mfma_f32_16x16x32_bf16 v[40:43], v[152:155], v[188:191], v[40:43]
v_mfma_f32_16x16x32_bf16 v[44:47], v[152:155], v[192:195], v[44:47]
v_mfma_f32_16x16x32_bf16 v[136:139], v[152:155], v[196:199], v[136:139]
s_waitcnt lgkmcnt(2)
ds_read_b64_tr_b16 v[152:153], v208
ds_read_b64_tr_b16 v[154:155], v208 offset:512
v_mfma_f32_16x16x32_bf16 v[48:51], v[156:159], v[180:183], v[48:51]
v_add_u32 v208, 4294864896, v208
v_mfma_f32_16x16x32_bf16 v[52:55], v[156:159], v[184:187], v[52:55]
v_mfma_f32_16x16x32_bf16 v[56:59], v[156:159], v[188:191], v[56:59]
v_mfma_f32_16x16x32_bf16 v[60:63], v[156:159], v[192:195], v[60:63]
v_mfma_f32_16x16x32_bf16 v[140:143], v[156:159], v[196:199], v[140:143]
ds_read_b64_tr_b16 v[156:157], v209
s_waitcnt vmcnt(7)
s_barrier
v_mfma_f32_16x16x32_bf16 v[64:67], v[144:147], v[180:183], v[64:67]
s_add_u32 m0, s78, 111616
s_add_u32 s42, s42, 64
s_add_u32 s43, s43, 262144
buffer_load_dwordx4 v238, s[44:47], s42 offen lds
v_mfma_f32_16x16x32_bf16 v[68:71], v[144:147], v[184:187], v[68:71]
ds_read_b64_tr_b16 v[158:159], v209 offset:512
v_add_u32 v209, 4294864896, v209
v_mfma_f32_16x16x32_bf16 v[72:75], v[144:147], v[188:191], v[72:75]
ds_read_b128 v[160:163], v200
v_mfma_f32_16x16x32_bf16 v[76:79], v[144:147], v[192:195], v[76:79]
s_waitcnt lgkmcnt(2)
ds_read_b64_tr_b16 v[144:145], v202
ds_read_b64_tr_b16 v[146:147], v202 offset:512
v_mfma_f32_16x16x32_bf16 v[80:83], v[148:151], v[180:183], v[80:83]
ds_read_b128 v[164:167], v200 offset:1024
buffer_load_dwordx4 v239, s[44:47], s42 offen offset:1024 lds
v_mfma_f32_16x16x32_bf16 v[84:87], v[148:151], v[184:187], v[84:87]
ds_read_b128 v[168:171], v200 offset:2048
v_add_u32 v202, 51200, v202
v_mfma_f32_16x16x32_bf16 v[88:91], v[148:151], v[188:191], v[88:91]
ds_read_b128 v[172:175], v200 offset:3072
v_add_u32 v200, 51200, v200
v_mfma_f32_16x16x32_bf16 v[92:95], v[148:151], v[192:195], v[92:95]
ds_read_b128 v[176:179], v201
v_add_u32 v201, 51200, v201
v_mfma_f32_16x16x32_bf16 v[96:99], v[152:155], v[180:183], v[96:99]
ds_read_b64_tr_b16 v[148:149], v203
ds_read_b64_tr_b16 v[150:151], v203 offset:512
v_mfma_f32_16x16x32_bf16 v[100:103], v[152:155], v[184:187], v[100:103]
s_mov_b32 m0, 119808
s_mov_b64 exec, s[80:81]
buffer_load_dwordx4 v240, s[44:47], s42 offen lds
s_add_u32 m0, s79, 111616
s_mov_b64 exec, -1
v_add_u32 v203, 51200, v203
v_mfma_f32_16x16x32_bf16 v[104:107], v[152:155], v[188:191], v[104:107]
v_mfma_f32_16x16x32_bf16 v[108:111], v[152:155], v[192:195], v[108:111]
s_waitcnt lgkmcnt(2)
ds_read_b64_tr_b16 v[152:153], v204
ds_read_b64_tr_b16 v[154:155], v204 offset:512
v_mfma_f32_16x16x32_bf16 v[112:115], v[156:159], v[180:183], v[112:115]
v_add_u32 v204, 51200, v204
v_mfma_f32_16x16x32_bf16 v[116:119], v[156:159], v[184:187], v[116:119]
buffer_load_dwordx4 v241, s[48:51], s43 offen lds
v_mfma_f32_16x16x32_bf16 v[120:123], v[156:159], v[188:191], v[120:123]
v_mfma_f32_16x16x32_bf16 v[124:127], v[156:159], v[192:195], v[124:127]
ds_read_b64_tr_b16 v[156:157], v205
ds_read_b64_tr_b16 v[158:159], v205 offset:512
v_mfma_f32_16x16x32_bf16 v[0:3], v[144:147], v[160:163], v[0:3]
v_add_u32 v205, 51200, v205
s_sub_u32 s72, s72, 1
s_cmp_lg_u32 s72, 0
s_cbranch_scc1 LB_qloop
v_mfma_f32_16x16x32_bf16 v[4:7], v[144:147], v[164:167], v[4:7]
v_mfma_f32_16x16x32_bf16 v[8:11], v[144:147], v[168:171], v[8:11]
buffer_load_dwordx4 v242, s[48:51], s43 offen offset:1024 lds
v_mfma_f32_16x16x32_bf16 v[12:15], v[144:147], v[172:175], v[12:15]
v_mfma_f32_16x16x32_bf16 v[128:131], v[144:147], v[176:179], v[128:131]
s_waitcnt lgkmcnt(2)
ds_read_b64_tr_b16 v[144:145], v206
ds_read_b64_tr_b16 v[146:147], v206 offset:512
v_mfma_f32_16x16x32_bf16 v[16:19], v[148:151], v[160:163], v[16:19]
v_add_u32 v206, 51200, v206
v_mfma_f32_16x16x32_bf16 v[20:23], v[148:151], v[164:167], v[20:23]
buffer_load_dwordx4 v243, s[48:51], s43 offen offset:2048 lds
v_mfma_f32_16x16x32_bf16 v[24:27], v[148:151], v[168:171], v[24:27]
v_mfma_f32_16x16x32_bf16 v[28:31], v[148:151], v[172:175], v[28:31]
v_mfma_f32_16x16x32_bf16 v[132:135], v[148:151], v[176:179], v[132:135]
ds_read_b64_tr_b16 v[148:149], v207
ds_read_b64_tr_b16 v[150:151], v207 offset:512
v_mfma_f32_16x16x32_bf16 v[32:35], v[152:155], v[160:163], v[32:35]
v_add_u32 v207, 51200, v207
v_mfma_f32_16x16x32_bf16 v[36:39], v[152:155], v[164:167], v[36:39]
buffer_load_dwordx4 v244, s[48:51], s43 offen offset:3072 lds
v_mfma_f32_16x16x32_bf16 v[40:43], v[152:155], v[168:171], v[40:43]
v_mfma_f32_16x16x32_bf16 v[44:47], v[152:155], v[172:175], v[44:47]
v_mfma_f32_16x16x32_bf16 v[136:139], v[152:155], v[176:179], v[136:139]
s_waitcnt lgkmcnt(2)
ds_read_b64_tr_b16 v[152:153], v208
ds_read_b64_tr_b16 v[154:155], v208 offset:512
v_mfma_f32_16x16x32_bf16 v[48:51], v[156:159], v[160:163], v[48:51]
v_add_u32 v208, 51200, v208
v_mfma_f32_16x16x32_bf16 v[52:55], v[156:159], v[164:167], v[52:55]
v_mfma_f32_16x16x32_bf16 v[56:59], v[156:159], v[168:171], v[56:59]
v_mfma_f32_16x16x32_bf16 v[60:63], v[156:159], v[172:175], v[60:63]
v_mfma_f32_16x16x32_bf16 v[140:143], v[156:159], v[176:179], v[140:143]
ds_read_b64_tr_b16 v[156:157], v209
s_waitcnt vmcnt(7)
s_barrier
v_mfma_f32_16x16x32_bf16 v[64:67], v[144:147], v[160:163], v[64:67]
s_add_u32 m0, s78, 137216
s_add_u32 s42, s42, 64
s_add_u32 s43, s43, 262144
buffer_load_dwordx4 v238, s[44:47], s42 offen lds
v_mfma_f32_16x16x32_bf16 v[68:71], v[144:147], v[164:167], v[68:71]
ds_read_b64_tr_b16 v[158:159], v209 offset:512
v_add_u32 v209, 51200, v209
v_mfma_f32_16x16x32_bf16 v[72:75], v[144:147], v[168:171], v[72:75]
ds_read_b128 v[180:183], v200
v_mfma_f32_16x16x32_bf16 v[76:79], v[144:147], v[172:175], v[76:79]
s_waitcnt lgkmcnt(2)
ds_read_b64_tr_b16 v[144:145], v202
ds_read_b64_tr_b16 v[146:147], v202 offset:512
v_mfma_f32_16x16x32_bf16 v[80:83], v[148:151], v[160:163], v[80:83]
ds_read_b128 v[184:187], v200 offset:1024
buffer_load_dwordx4 v239, s[44:47], s42 offen offset:1024 lds
v_mfma_f32_16x16x32_bf16 v[84:87], v[148:151], v[164:167], v[84:87]
ds_read_b128 v[188:191], v200 offset:2048
v_add_u32 v202, 25600, v202
v_mfma_f32_16x16x32_bf16 v[88:91], v[148:151], v[168:171], v[88:91]
ds_read_b128 v[192:195], v200 offset:3072
v_add_u32 v200, 25600, v200
v_mfma_f32_16x16x32_bf16 v[92:95], v[148:151], v[172:175], v[92:95]
ds_read_b128 v[196:199], v201
v_add_u32 v201, 25600, v201
v_mfma_f32_16x16x32_bf16 v[96:99], v[152:155], v[160:163], v[96:99]
ds_read_b64_tr_b16 v[148:149], v203
ds_read_b64_tr_b16 v[150:151], v203 offset:512
v_mfma_f32_16x16x32_bf16 v[100:103], v[152:155], v[164:167], v[100:103]
s_mov_b32 m0, 145408
s_mov_b64 exec, s[80:81]
buffer_load_dwordx4 v240, s[44:47], s42 offen lds
s_add_u32 m0, s79, 137216
s_mov_b64 exec, -1
v_add_u32 v203, 25600, v203
v_mfma_f32_16x16x32_bf16 v[104:107], v[152:155], v[168:171], v[104:107]
v_mfma_f32_16x16x32_bf16 v[108:111], v[152:155], v[172:175], v[108:111]
s_waitcnt lgkmcnt(2)
ds_read_b64_tr_b16 v[152:153], v204
ds_read_b64_tr_b16 v[154:155], v204 offset:512
v_mfma_f32_16x16x32_bf16 v[112:115], v[156:159], v[160:163], v[112:115]
v_add_u32 v204, 25600, v204
v_mfma_f32_16x16x32_bf16 v[116:119], v[156:159], v[164:167], v[116:119]
buffer_load_dwordx4 v241, s[48:51], s43 offen lds
v_mfma_f32_16x16x32_bf16 v[120:123], v[156:159], v[168:171], v[120:123]
v_mfma_f32_16x16x32_bf16 v[124:127], v[156:159], v[172:175], v[124:127]
ds_read_b64_tr_b16 v[156:157], v205
ds_read_b64_tr_b16 v[158:159], v205 offset:512
v_mfma_f32_16x16x32_bf16 v[0:3], v[144:147], v[180:183], v[0:3]
v_add_u32 v205, 25600, v205
v_mfma_f32_16x16x32_bf16 v[4:7], v[144:147], v[184:187], v[4:7]
v_mfma_f32_16x16x32_bf16 v[8:11], v[144:147], v[188:191], v[8:11]
buffer_load_dwordx4 v242, s[48:51], s43 offen offset:1024 lds
v_mfma_f32_16x16x32_bf16 v[12:15], v[144:147], v[192:195], v[12:15]
v_mfma_f32_16x16x32_bf16 v[128:131], v[144:147], v[196:199], v[128:131]
s_waitcnt lgkmcnt(2)
ds_read_b64_tr_b16 v[144:145], v206
ds_read_b64_tr_b16 v[146:147], v206 offset:512
v_mfma_f32_16x16x32_bf16 v[16:19], v[148:151], v[180:183], v[16:19]
v_add_u32 v206, 25600, v206
v_mfma_f32_16x16x32_bf16 v[20:23], v[148:151], v[184:187], v[20:23]
buffer_load_dwordx4 v243, s[48:51], s43 offen offset:2048 lds
v_mfma_f32_16x16x32_bf16 v[24:27], v[148:151], v[188:191], v[24:27]
v_mfma_f32_16x16x32_bf16 v[28:31], v[148:151], v[192:195], v[28:31]
v_mfma_f32_16x16x32_bf16 v[132:135], v[148:151], v[196:199], v[132:135]
ds_read_b64_tr_b16 v[148:149], v207
ds_read_b64_tr_b16 v[150:151], v207 offset:512
v_mfma_f32_16x16x32_bf16 v[32:35], v[152:155], v[180:183], v[32:35]
v_add_u32 v207, 25600, v207
v_mfma_f32_16x16x32_bf16 v[36:39], v[152:155], v[184:187], v[36:39]
buffer_load_dwordx4 v244, s[48:51], s43 offen offset:3072 lds
v_mfma_f32_16x16x32_bf16 v[40:43], v[152:155], v[188:191], v[40:43]
v_mfma_f32_16x16x32_bf16 v[44:47], v[152:155], v[192:195], v[44:47]
v_mfma_f32_16x16x32_bf16 v[136:139], v[152:155], v[196:199], v[136:139]
s_waitcnt lgkmcnt(2)
ds_read_b64_tr_b16 v[152:153], v208
ds_read_b64_tr_b16 v[154:155], v208 offset:512
v_mfma_f32_16x16x32_bf16 v[48:51], v[156:159], v[180:183], v[48:51]
v_add_u32 v208, 25600, v208
v_mfma_f32_16x16x32_bf16 v[52:55], v[156:159], v[184:187], v[52:55]
v_mfma_f32_16x16x32_bf16 v[56:59], v[156:159], v[188:191], v[56:59]
v_mfma_f32_16x16x32_bf16 v[60:63], v[156:159], v[192:195], v[60:63]
v_mfma_f32_16x16x32_bf16 v[140:143], v[156:159], v[196:199], v[140:143]
ds_read_b64_tr_b16 v[156:157], v209
s_waitcnt vmcnt(7)
s_barrier
v_mfma_f32_16x16x32_bf16 v[64:67], v[144:147], v[180:183], v[64:67]
s_add_u32 s9, s74, 16384
s_and_b32 s9, s9, 0x3ffff
s_add_u32 m0, s76, 34816
s_nop 0
buffer_load_dwordx4 v245, s[52:55], s9 offen nt lds
v_mfma_f32_16x16x32_bf16 v[68:71], v[144:147], v[184:187], v[68:71]
ds_read_b64_tr_b16 v[158:159], v209 offset:512
v_add_u32 v209, 25600, v209
v_mfma_f32_16x16x32_bf16 v[72:75], v[144:147], v[188:191], v[72:75]
ds_read_b128 v[160:163], v200
v_mfma_f32_16x16x32_bf16 v[76:79], v[144:147], v[192:195], v[76:79]
s_waitcnt lgkmcnt(2)
ds_read_b64_tr_b16 v[144:145], v202
buffer_load_dwordx4 v246, s[52:55], s9 offen offset:1088 nt lds
v_mfma_f32_16x16x32_bf16 v[80:83], v[148:151], v[180:183], v[80:83]
ds_read_b64_tr_b16 v[146:147], v202 offset:512
v_add_u32 v202, 25600, v202
v_mfma_f32_16x16x32_bf16 v[84:87], v[148:151], v[184:187], v[84:87]
ds_read_b128 v[164:167], v200 offset:1024
v_mfma_f32_16x16x32_bf16 v[88:91], v[148:151], v[188:191], v[88:91]
ds_read_b128 v[168:171], v200 offset:2048
buffer_load_dwordx4 v247, s[52:55], s9 offen offset:2176 nt lds
v_mfma_f32_16x16x32_bf16 v[92:95], v[148:151], v[192:195], v[92:95]
ds_read_b128 v[172:175], v200 offset:3072
v_add_u32 v200, 25600, v200
v_mfma_f32_16x16x32_bf16 v[96:99], v[152:155], v[180:183], v[96:99]
ds_read_b128 v[176:179], v201
v_add_u32 v201, 25600, v201
v_mfma_f32_16x16x32_bf16 v[100:103], v[152:155], v[184:187], v[100:103]
ds_read_b64_tr_b16 v[148:149], v203
buffer_load_dwordx4 v248, s[52:55], s9 offen offset:3264 nt lds
v_mfma_f32_16x16x32_bf16 v[104:107], v[152:155], v[188:191], v[104:107]
ds_read_b64_tr_b16 v[150:151], v203 offset:512
v_add_u32 v203, 25600, v203
v_mfma_f32_16x16x32_bf16 v[108:111], v[152:155], v[192:195], v[108:111]
s_waitcnt lgkmcnt(4)
ds_read_b64_tr_b16 v[152:153], v204
ds_read_b64_tr_b16 v[154:155], v204 offset:512
v_mfma_f32_16x16x32_bf16 v[112:115], v[156:159], v[180:183], v[112:115]
s_add_u32 s9, s74, 24576
s_and_b32 s9, s9, 0x3ffff
s_add_u32 m0, s76, 52224
s_nop 0
buffer_load_dwordx4 v245, s[52:55], s9 offen nt lds
v_mfma_f32_16x16x32_bf16 v[116:119], v[156:159], v[184:187], v[116:119]
v_add_u32 v204, 25600, v204
v_mfma_f32_16x16x32_bf16 v[120:123], v[156:159], v[188:191], v[120:123]
v_mfma_f32_16x16x32_bf16 v[124:127], v[156:159], v[192:195], v[124:127]
ds_read_b64_tr_b16 v[156:157], v205
buffer_load_dwordx4 v246, s[52:55], s9 offen offset:1088 nt lds
v_mfma_f32_16x16x32_bf16 v[0:3], v[144:147], v[160:163], v[0:3]
ds_read_b64_tr_b16 v[158:159], v205 offset:512
v_mul_u32_u24 v252, 1088, v233
v_mfma_f32_16x16x32_bf16 v[4:7], v[144:147], v[164:167], v[4:7]
v_add_u32 v205, 25600, v205
v_lshl_add_u32 v252, v234, 8, v252
v_mfma_f32_16x16x32_bf16 v[8:11], v[144:147], v[168:171], v[8:11]
s_waitcnt lgkmcnt(2)
buffer_load_dwordx4 v247, s[52:55], s9 offen offset:2176 nt lds
v_mfma_f32_16x16x32_bf16 v[12:15], v[144:147], v[172:175], v[12:15]
v_xor_b32 v253, v235, v234
v_mfma_f32_16x16x32_bf16 v[128:131], v[144:147], v[176:179], v[128:131]
ds_read_b64_tr_b16 v[144:145], v206
v_lshl_add_u32 v252, v253, 4, v252
v_mfma_f32_16x16x32_bf16 v[16:19], v[148:151], v[160:163], v[16:19]
buffer_load_dwordx4 v248, s[52:55], s9 offen offset:3264 nt lds
s_mul_i32 s12, s15, 8704
s_xor_b32 s13, s5, 0
s_lshl_b32 s13, s13, 7
s_add_u32 s12, s12, s13
s_xor_b32 s13, s5, 0
s_mul_i32 s13, s13, 17408
s_add_u32 s12, s12, s13
v_mfma_f32_16x16x32_bf16 v[20:23], v[148:151], v[164:167], v[20:23]
ds_read_b64_tr_b16 v[146:147], v206 offset:512
v_add_u32 v221, s12, v252
v_mfma_f32_16x16x32_bf16 v[24:27], v[148:151], v[168:171], v[24:27]
v_add_u32 v206, 25600, v206
s_mul_i32 s12, s15, 8704
s_xor_b32 s13, s5, 1
s_lshl_b32 s13, s13, 7
s_add_u32 s12, s12, s13
s_xor_b32 s13, s5, 0
s_mul_i32 s13, s13, 17408
s_add_u32 s12, s12, s13
v_mfma_f32_16x16x32_bf16 v[28:31], v[148:151], v[172:175], v[28:31]
v_add_u32 v222, s12, v252
v_mfma_f32_16x16x32_bf16 v[132:135], v[148:151], v[176:179], v[132:135]
ds_read_b64_tr_b16 v[148:149], v207
s_mul_i32 s12, s15, 8704
s_xor_b32 s13, s5, 0
s_lshl_b32 s13, s13, 7
s_add_u32 s12, s12, s13
s_xor_b32 s13, s5, 1
s_mul_i32 s13, s13, 17408
s_add_u32 s12, s12, s13
v_mfma_f32_16x16x32_bf16 v[32:35], v[152:155], v[160:163], v[32:35]
ds_read_b64_tr_b16 v[150:151], v207 offset:512
v_add_u32 v223, s12, v252
v_mfma_f32_16x16x32_bf16 v[36:39], v[152:155], v[164:167], v[36:39]
v_add_u32 v207, 25600, v207
s_mul_i32 s12, s15, 8704
s_xor_b32 s13, s5, 1
s_lshl_b32 s13, s13, 7
s_add_u32 s12, s12, s13
s_xor_b32 s13, s5, 1
s_mul_i32 s13, s13, 17408
s_add_u32 s12, s12, s13
v_mfma_f32_16x16x32_bf16 v[40:43], v[152:155], v[168:171], v[40:43]
v_add_u32 v224, s12, v252
v_mfma_f32_16x16x32_bf16 v[44:47], v[152:155], v[172:175], v[44:47]
v_and_b32 v253, 1, v235
v_mfma_f32_16x16x32_bf16 v[136:139], v[152:155], v[176:179], v[136:139]
s_waitcnt lgkmcnt(0)
ds_read_b64_tr_b16 v[152:153], v208
v_lshl_add_u32 v253, v253, 2, v233
v_mfma_f32_16x16x32_bf16 v[48:51], v[156:159], v[160:163], v[48:51]
ds_read_b64_tr_b16 v[154:155], v208 offset:512
v_add_u32 v208, 25600, v208
v_mfma_f32_16x16x32_bf16 v[52:55], v[156:159], v[164:167], v[52:55]
v_lshrrev_b32 v254, 1, v235
v_mfma_f32_16x16x32_bf16 v[56:59], v[156:159], v[168:171], v[56:59]
v_lshlrev_b32 v252, 11, v254
v_mfma_f32_16x16x32_bf16 v[60:63], v[156:159], v[172:175], v[60:63]
v_lshl_add_u32 v252, v253, 7, v252
v_mfma_f32_16x16x32_bf16 v[140:143], v[156:159], v[176:179], v[140:143]
ds_read_b64_tr_b16 v[156:157], v209
s_waitcnt vmcnt(8)
s_barrier
v_mfma_f32_16x16x32_bf16 v[64:67], v[144:147], v[160:163], v[64:67]
ds_read_b64_tr_b16 v[158:159], v209 offset:512
s_add_u32 s9, s74, 8192
s_and_b32 s9, s9, 0x3ffff
s_add_u32 m0, s77, 86016
s_nop 0
v_lshl_add_u32 v252, v234, 3, v252
v_mfma_f32_16x16x32_bf16 v[68:71], v[144:147], v[164:167], v[68:71]
buffer_load_dwordx4 v249, s[56:59], s9 offen nt lds
v_lshrrev_b32 v253, 1, v253
v_mfma_f32_16x16x32_bf16 v[72:75], v[144:147], v[168:171], v[72:75]
ds_read_b128 v[180:183], v200
s_lshl_b32 s12, s15, 13
s_xor_b32 s13, s5, 0
s_lshl_b32 s13, s13, 14
s_add_u32 s12, s12, s13
s_add_u32 s12, s12, 69632
v_mfma_f32_16x16x32_bf16 v[76:79], v[144:147], v[172:175], v[76:79]
ds_read_b64_tr_b16 v[144:145], v202
v_add_u32 v255, s12, v252
v_mfma_f32_16x16x32_bf16 v[80:83], v[148:151], v[160:163], v[80:83]
ds_read_b128 v[184:187], v200 offset:1024
buffer_load_dwordx4 v250, s[56:59], s9 offen offset:1024 nt lds
v_xor_b32 v254, 0, v253
v_mfma_f32_16x16x32_bf16 v[84:87], v[148:151], v[164:167], v[84:87]
ds_read_b64_tr_b16 v[146:147], v202 offset:512
v_add_u32 v209, 25600, v209
v_mfma_f32_16x16x32_bf16 v[88:91], v[148:151], v[168:171], v[88:91]
ds_read_b128 v[188:191], v200 offset:2048
v_lshl_add_u32 v225, v254, 5, v255
v_mfma_f32_16x16x32_bf16 v[92:95], v[148:151], v[172:175], v[92:95]
s_waitcnt lgkmcnt(3)
ds_read_b128 v[192:195], v200 offset:3072
v_xor_b32 v254, 1, v253
v_mfma_f32_16x16x32_bf16 v[96:99], v[152:155], v[160:163], v[96:99]
ds_read_b128 v[196:199], v201
v_lshl_add_u32 v226, v254, 5, v255
v_mfma_f32_16x16x32_bf16 v[100:103], v[152:155], v[164:167], v[100:103]
ds_read_b64_tr_b16 v[148:149], v203
buffer_load_dwordx4 v249, s[56:59], s9 offen offset:2048 nt lds
v_mfma_f32_16x16x32_bf16 v[104:107], v[152:155], v[168:171], v[104:107]
ds_read_b64_tr_b16 v[150:151], v203 offset:512
v_xor_b32 v254, 2, v253
v_mfma_f32_16x16x32_bf16 v[108:111], v[152:155], v[172:175], v[108:111]
ds_read_b64_tr_b16 v[152:153], v204
v_lshl_add_u32 v227, v254, 5, v255
v_mfma_f32_16x16x32_bf16 v[112:115], v[156:159], v[160:163], v[112:115]
ds_read_b64_tr_b16 v[154:155], v204 offset:512
v_xor_b32 v254, 3, v253
v_mfma_f32_16x16x32_bf16 v[116:119], v[156:159], v[164:167], v[116:119]
buffer_load_dwordx4 v250, s[56:59], s9 offen offset:3072 nt lds
v_mfma_f32_16x16x32_bf16 v[120:123], v[156:159], v[168:171], v[120:123]
v_lshl_add_u32 v228, v254, 5, v255
s_lshl_b32 s12, s15, 13
s_xor_b32 s13, s5, 1
s_lshl_b32 s13, s13, 14
s_add_u32 s12, s12, s13
v_mfma_f32_16x16x32_bf16 v[124:127], v[156:159], v[172:175], v[124:127]
s_waitcnt lgkmcnt(1)
ds_read_b64_tr_b16 v[156:157], v205
s_add_u32 s12, s12, 69632
v_add_u32 v255, s12, v252
v_mfma_f32_16x16x32_bf16 v[0:3], v[144:147], v[180:183], v[0:3]
ds_read_b64_tr_b16 v[158:159], v205 offset:512
v_mfma_f32_16x16x32_bf16 v[4:7], v[144:147], v[184:187], v[4:7]
v_xor_b32 v254, 0, v253
v_mfma_f32_16x16x32_bf16 v[8:11], v[144:147], v[188:191], v[8:11]
v_lshl_add_u32 v229, v254, 5, v255
v_mfma_f32_16x16x32_bf16 v[12:15], v[144:147], v[192:195], v[12:15]
v_xor_b32 v254, 1, v253
v_mfma_f32_16x16x32_bf16 v[128:131], v[144:147], v[196:199], v[128:131]
ds_read_b64_tr_b16 v[144:145], v206
ds_read_b64_tr_b16 v[146:147], v206 offset:512
v_mfma_f32_16x16x32_bf16 v[16:19], v[148:151], v[180:183], v[16:19]
v_lshl_add_u32 v230, v254, 5, v255
v_mfma_f32_16x16x32_bf16 v[20:23], v[148:151], v[184:187], v[20:23]
v_xor_b32 v254, 2, v253
v_mfma_f32_16x16x32_bf16 v[24:27], v[148:151], v[188:191], v[24:27]
v_lshl_add_u32 v231, v254, 5, v255
v_mfma_f32_16x16x32_bf16 v[28:31], v[148:151], v[192:195], v[28:31]
v_mfma_f32_16x16x32_bf16 v[132:135], v[148:151], v[196:199], v[132:135]
s_waitcnt lgkmcnt(2)
ds_read_b64_tr_b16 v[148:149], v207
v_xor_b32 v254, 3, v253
v_mfma_f32_16x16x32_bf16 v[32:35], v[152:155], v[180:183], v[32:35]
ds_read_b64_tr_b16 v[150:151], v207 offset:512
v_lshl_add_u32 v232, v254, 5, v255
v_mfma_f32_16x16x32_bf16 v[36:39], v[152:155], v[184:187], v[36:39]
v_mfma_f32_16x16x32_bf16 v[40:43], v[152:155], v[188:191], v[40:43]
v_mfma_f32_16x16x32_bf16 v[44:47], v[152:155], v[192:195], v[44:47]
v_mfma_f32_16x16x32_bf16 v[136:139], v[152:155], v[196:199], v[136:139]
ds_read_b64_tr_b16 v[152:153], v208
ds_read_b64_tr_b16 v[154:155], v208 offset:512
v_mfma_f32_16x16x32_bf16 v[48:51], v[156:159], v[180:183], v[48:51]
v_mul_f32 v0, s83, v0
v_mfma_f32_16x16x32_bf16 v[52:55], v[156:159], v[184:187], v[52:55]
v_mul_f32 v1, s83, v1
v_mfma_f32_16x16x32_bf16 v[56:59], v[156:159], v[188:191], v[56:59]
v_mul_f32 v2, s83, v2
v_mfma_f32_16x16x32_bf16 v[60:63], v[156:159], v[192:195], v[60:63]
v_mul_f32 v3, s83, v3
v_mfma_f32_16x16x32_bf16 v[140:143], v[156:159], v[196:199], v[140:143]
s_barrier
s_waitcnt lgkmcnt(2)
v_mul_f32 v16, s83, v16
v_mfma_f32_16x16x32_bf16 v[64:67], v[144:147], v[180:183], v[64:67]
ds_read_b64_tr_b16 v[156:157], v209
v_mul_f32 v17, s83, v17
v_mfma_f32_16x16x32_bf16 v[68:71], v[144:147], v[184:187], v[68:71]
ds_read_b64_tr_b16 v[158:159], v209 offset:512
v_mul_f32 v18, s83, v18
v_mfma_f32_16x16x32_bf16 v[72:75], v[144:147], v[188:191], v[72:75]
ds_read_b128 v[160:163], v221
v_mul_f32 v19, s83, v19
v_mfma_f32_16x16x32_bf16 v[76:79], v[144:147], v[192:195], v[76:79]
ds_read_b128 v[164:167], v221 offset:4352
v_cvt_pk_bf16_f32 v0, v0, v1
v_mfma_f32_16x16x32_bf16 v[80:83], v[148:151], v[180:183], v[80:83]
ds_read_b128 v[168:171], v221 offset:64
v_cvt_pk_bf16_f32 v1, v2, v3
v_mfma_f32_16x16x32_bf16 v[84:87], v[148:151], v[184:187], v[84:87]
ds_read_b128 v[172:175], v221 offset:4416
v_cvt_pk_bf16_f32 v16, v16, v17
v_mfma_f32_16x16x32_bf16 v[88:91], v[148:151], v[188:191], v[88:91]
ds_read_b128 v[176:179], v222
v_cvt_pk_bf16_f32 v17, v18, v19
v_mfma_f32_16x16x32_bf16 v[92:95], v[148:151], v[192:195], v[92:95]
s_waitcnt lgkmcnt(3)
ds_read_b128 a[244:247], v222 offset:4352
s_nop 0
v_permlane32_swap_b32 v0, v16
v_mfma_f32_16x16x32_bf16 v[96:99], v[152:155], v[180:183], v[96:99]
ds_read_b128 a[248:251], v222 offset:64
v_permlane32_swap_b32 v1, v17
v_mfma_f32_16x16x32_bf16 v[100:103], v[152:155], v[184:187], v[100:103]
ds_read_b128 a[252:255], v222 offset:4416
s_nop 0
v_permlane16_swap_b32 v0, v16
v_mfma_f32_16x16x32_bf16 v[104:107], v[152:155], v[188:191], v[104:107]
v_permlane16_swap_b32 v1, v17
v_mfma_f32_16x16x32_bf16 v[108:111], v[152:155], v[192:195], v[108:111]
v_accvgpr_write_b32 a160, v0
v_mfma_f32_16x16x32_bf16 v[112:115], v[156:159], v[180:183], v[112:115]
v_accvgpr_write_b32 a161, v1
v_mfma_f32_16x16x32_bf16 v[116:119], v[156:159], v[184:187], v[116:119]
v_accvgpr_write_b32 a162, v16
v_mfma_f32_16x16x32_bf16 v[120:123], v[156:159], v[188:191], v[120:123]
v_accvgpr_write_b32 a163, v17
v_mul_f32 v4, s83, v4
v_mul_f32 v5, s83, v5
v_mul_f32 v6, s83, v6
v_mul_f32 v7, s83, v7
v_mul_f32 v20, s83, v20
v_mul_f32 v21, s83, v21
v_mul_f32 v22, s83, v22
v_mul_f32 v23, s83, v23
v_cvt_pk_bf16_f32 v4, v4, v5
v_cvt_pk_bf16_f32 v5, v6, v7
v_cvt_pk_bf16_f32 v20, v20, v21
v_cvt_pk_bf16_f32 v21, v22, v23
s_nop 0
v_permlane32_swap_b32 v4, v20
v_permlane32_swap_b32 v5, v21
s_nop 0
v_permlane16_swap_b32 v4, v20
v_permlane16_swap_b32 v5, v21
v_accvgpr_write_b32 a176, v4
v_accvgpr_write_b32 a177, v5
v_accvgpr_write_b32 a178, v20
v_accvgpr_write_b32 a179, v21
v_mul_f32 v8, s83, v8
v_mul_f32 v9, s83, v9
v_mul_f32 v10, s83, v10
v_mul_f32 v11, s83, v11
v_mul_f32 v24, s83, v24
v_mul_f32 v25, s83, v25
v_mul_f32 v26, s83, v26
v_mul_f32 v27, s83, v27
v_cvt_pk_bf16_f32 v8, v8, v9
v_cvt_pk_bf16_f32 v9, v10, v11
v_cvt_pk_bf16_f32 v24, v24, v25
v_cvt_pk_bf16_f32 v25, v26, v27
s_nop 0
v_permlane32_swap_b32 v8, v24
v_permlane32_swap_b32 v9, v25
s_nop 0
v_permlane16_swap_b32 v8, v24
v_permlane16_swap_b32 v9, v25
v_accvgpr_write_b32 a192, v8
v_accvgpr_write_b32 a193, v9
v_accvgpr_write_b32 a194, v24
v_accvgpr_write_b32 a195, v25
v_mul_f32 v12, s83, v12
v_mul_f32 v13, s83, v13
v_mul_f32 v14, s83, v14
v_mul_f32 v15, s83, v15
v_mul_f32 v28, s83, v28
v_mul_f32 v29, s83, v29
v_mul_f32 v30, s83, v30
v_mul_f32 v31, s83, v31
v_cvt_pk_bf16_f32 v12, v12, v13
v_cvt_pk_bf16_f32 v13, v14, v15
v_cvt_pk_bf16_f32 v28, v28, v29
v_cvt_pk_bf16_f32 v29, v30, v31
s_nop 0
v_permlane32_swap_b32 v12, v28
v_permlane32_swap_b32 v13, v29
s_nop 0
v_permlane16_swap_b32 v12, v28
v_permlane16_swap_b32 v13, v29
v_accvgpr_write_b32 a208, v12
v_accvgpr_write_b32 a209, v13
v_accvgpr_write_b32 a210, v28
v_accvgpr_write_b32 a211, v29
v_mfma_f32_16x16x32_bf16 v[124:127], v[156:159], v[192:195], v[124:127]
v_mul_f32 v32, s83, v32
v_mul_f32 v33, s83, v33
v_mul_f32 v34, s83, v34
v_mfma_f32_16x16x32_bf16 v[0:3], v[160:163], a[160:163], 0
v_mul_f32 v35, s83, v35
v_mul_f32 v48, s83, v48
v_mfma_f32_16x16x32_bf16 v[8:11], v[160:163], a[176:179], 0
v_mul_f32 v49, s83, v49
v_mul_f32 v50, s83, v50
v_mul_f32 v51, s83, v51
v_mfma_f32_16x16x32_bf16 v[16:19], v[160:163], a[192:195], 0
v_cvt_pk_bf16_f32 v32, v32, v33
v_cvt_pk_bf16_f32 v33, v34, v35
v_mfma_f32_16x16x32_bf16 v[24:27], v[160:163], a[208:211], 0
v_cvt_pk_bf16_f32 v48, v48, v49
v_cvt_pk_bf16_f32 v49, v50, v51
s_nop 0
v_permlane32_swap_b32 v32, v48
v_mfma_f32_16x16x32_bf16 v[4:7], v[164:167], a[160:163], 0
v_permlane32_swap_b32 v33, v49
s_nop 0
v_permlane16_swap_b32 v32, v48
v_mfma_f32_16x16x32_bf16 v[12:15], v[164:167], a[176:179], 0
v_permlane16_swap_b32 v33, v49
v_accvgpr_write_b32 a164, v32
v_accvgpr_write_b32 a165, v33
v_mfma_f32_16x16x32_bf16 v[20:23], v[164:167], a[192:195], 0
v_accvgpr_write_b32 a166, v48
v_accvgpr_write_b32 a167, v49
v_mul_f32 v36, s83, v36
v_mul_f32 v37, s83, v37
v_mul_f32 v38, s83, v38
v_mul_f32 v39, s83, v39
v_mul_f32 v52, s83, v52
v_mul_f32 v53, s83, v53
v_mul_f32 v54, s83, v54
v_mul_f32 v55, s83, v55
v_cvt_pk_bf16_f32 v36, v36, v37
v_mfma_f32_16x16x32_bf16 v[28:31], v[164:167], a[208:211], 0
s_waitcnt lgkmcnt(0)
v_cvt_pk_bf16_f32 v37, v38, v39
v_cvt_pk_bf16_f32 v52, v52, v53
v_cvt_pk_bf16_f32 v53, v54, v55
s_nop 0
v_permlane32_swap_b32 v36, v52
v_permlane32_swap_b32 v37, v53
s_nop 0
v_permlane16_swap_b32 v36, v52
v_permlane16_swap_b32 v37, v53
v_accvgpr_write_b32 a180, v36
v_accvgpr_write_b32 a181, v37
v_accvgpr_write_b32 a182, v52
v_accvgpr_write_b32 a183, v53
v_mul_f32 v40, s83, v40
v_mul_f32 v41, s83, v41
v_mul_f32 v42, s83, v42
v_mul_f32 v43, s83, v43
v_mul_f32 v56, s83, v56
v_mul_f32 v57, s83, v57
v_mul_f32 v58, s83, v58
v_mul_f32 v59, s83, v59
v_cvt_pk_bf16_f32 v40, v40, v41
v_mfma_f32_16x16x32_bf16 v[0:3], v[168:171], a[164:167], v[0:3]
v_cvt_pk_bf16_f32 v41, v42, v43
v_cvt_pk_bf16_f32 v56, v56, v57
v_cvt_pk_bf16_f32 v57, v58, v59
s_nop 0
v_permlane32_swap_b32 v40, v56
v_permlane32_swap_b32 v41, v57
s_nop 0
v_permlane16_swap_b32 v40, v56
v_permlane16_swap_b32 v41, v57
v_accvgpr_write_b32 a196, v40
v_accvgpr_write_b32 a197, v41
v_accvgpr_write_b32 a198, v56
v_accvgpr_write_b32 a199, v57
v_mul_f32 v44, s83, v44
v_mul_f32 v45, s83, v45
v_mul_f32 v46, s83, v46
v_mul_f32 v47, s83, v47
v_mul_f32 v60, s83, v60
v_mul_f32 v61, s83, v61
v_mul_f32 v62, s83, v62
v_mul_f32 v63, s83, v63
v_cvt_pk_bf16_f32 v44, v44, v45
v_mfma_f32_16x16x32_bf16 v[8:11], v[168:171], a[180:183], v[8:11]
v_cvt_pk_bf16_f32 v45, v46, v47
v_cvt_pk_bf16_f32 v60, v60, v61
v_cvt_pk_bf16_f32 v61, v62, v63
s_nop 0
v_permlane32_swap_b32 v44, v60
v_permlane32_swap_b32 v45, v61
s_nop 0
v_permlane16_swap_b32 v44, v60
v_permlane16_swap_b32 v45, v61
v_accvgpr_write_b32 a212, v44
v_accvgpr_write_b32 a213, v45
v_accvgpr_write_b32 a214, v60
v_accvgpr_write_b32 a215, v61
v_mul_f32 v128, s83, v128
v_mul_f32 v129, s83, v129
v_mul_f32 v130, s83, v130
v_mul_f32 v131, s83, v131
v_mul_f32 v132, s83, v132
v_mul_f32 v133, s83, v133
v_mfma_f32_16x16x32_bf16 v[16:19], v[168:171], a[196:199], v[16:19]
v_mul_f32 v134, s83, v134
v_mul_f32 v135, s83, v135
v_cvt_pk_bf16_f32 v128, v128, v129
v_cvt_pk_bf16_f32 v129, v130, v131
v_cvt_pk_bf16_f32 v132, v132, v133
v_cvt_pk_bf16_f32 v133, v134, v135
s_nop 0
v_permlane32_swap_b32 v128, v132
v_permlane32_swap_b32 v129, v133
s_nop 0
v_mfma_f32_16x16x32_bf16 v[24:27], v[168:171], a[212:215], v[24:27]
v_permlane16_swap_b32 v128, v132
v_permlane16_swap_b32 v129, v133
v_accvgpr_write_b32 a224, v128
v_mov_b32 v210, v128
v_accvgpr_write_b32 a225, v129
v_mov_b32 v211, v129
v_accvgpr_write_b32 a226, v132
v_mov_b32 v212, v132
v_accvgpr_write_b32 a227, v133
v_mov_b32 v213, v133
v_mul_f32 v136, s83, v136
v_mul_f32 v137, s83, v137
v_mul_f32 v138, s83, v138
v_mfma_f32_16x16x32_bf16 v[4:7], v[172:175], a[164:167], v[4:7]
v_mul_f32 v139, s83, v139
v_mul_f32 v140, s83, v140
v_mul_f32 v141, s83, v141
v_mul_f32 v142, s83, v142
v_mul_f32 v143, s83, v143
v_cvt_pk_bf16_f32 v136, v136, v137
v_cvt_pk_bf16_f32 v137, v138, v139
v_cvt_pk_bf16_f32 v140, v140, v141
v_mfma_f32_16x16x32_bf16 v[12:15], v[172:175], a[180:183], v[12:15]
v_cvt_pk_bf16_f32 v141, v142, v143
s_nop 0
v_permlane32_swap_b32 v136, v140
v_permlane32_swap_b32 v137, v141
s_nop 0
v_permlane16_swap_b32 v136, v140
v_permlane16_swap_b32 v137, v141
v_accvgpr_write_b32 a228, v136
v_mov_b32 v214, v136
v_accvgpr_write_b32 a229, v137
v_mov_b32 v215, v137
v_accvgpr_write_b32 a230, v140
v_mov_b32 v216, v140
v_mfma_f32_16x16x32_bf16 v[20:23], v[172:175], a[196:199], v[20:23]
v_accvgpr_write_b32 a231, v141
v_mov_b32 v217, v141
v_lshlrev_b32 v201, 4, v251
s_lshl_b32 s8, s3, 11
s_add_u32 s8, s8, 122880
v_add_u32 v252, s8, v201
ds_write_b128 v252, v[210:213]
ds_write_b128 v252, v[214:217] offset:1024
s_xor_b32 s8, s3, 1
s_lshl_b32 s8, s8, 11
s_add_u32 s8, s8, 122880
v_add_u32 v201, s8, v201
v_mul_f32 v64, s83, v64
v_mul_f32 v65, s83, v65
v_mul_f32 v66, s83, v66
v_mul_f32 v67, s83, v67
v_mul_f32 v80, s83, v80
v_mul_f32 v81, s83, v81
v_mul_f32 v82, s83, v82
v_mul_f32 v83, s83, v83
v_cvt_pk_bf16_f32 v64, v64, v65
v_cvt_pk_bf16_f32 v65, v66, v67
v_cvt_pk_bf16_f32 v80, v80, v81
v_cvt_pk_bf16_f32 v81, v82, v83
s_nop 0
v_permlane32_swap_b32 v64, v80
v_permlane32_swap_b32 v65, v81
s_nop 0
v_permlane16_swap_b32 v64, v80
v_permlane16_swap_b32 v65, v81
v_accvgpr_write_b32 a168, v64
v_accvgpr_write_b32 a169, v65
v_accvgpr_write_b32 a170, v80
v_accvgpr_write_b32 a171, v81
v_mul_f32 v68, s83, v68
v_mul_f32 v69, s83, v69
v_mul_f32 v70, s83, v70
v_mul_f32 v71, s83, v71
v_mul_f32 v84, s83, v84
v_mul_f32 v85, s83, v85
v_mul_f32 v86, s83, v86
v_mul_f32 v87, s83, v87
v_cvt_pk_bf16_f32 v68, v68, v69
v_mfma_f32_16x16x32_bf16 v[28:31], v[172:175], a[212:215], v[28:31]
v_cvt_pk_bf16_f32 v69, v70, v71
v_cvt_pk_bf16_f32 v84, v84, v85
v_cvt_pk_bf16_f32 v85, v86, v87
s_nop 0
v_permlane32_swap_b32 v68, v84
v_permlane32_swap_b32 v69, v85
s_nop 0
v_permlane16_swap_b32 v68, v84
v_permlane16_swap_b32 v69, v85
v_accvgpr_write_b32 a184, v68
v_accvgpr_write_b32 a185, v69
v_accvgpr_write_b32 a186, v84
v_accvgpr_write_b32 a187, v85
v_mul_f32 v72, s83, v72
v_mul_f32 v73, s83, v73
v_mul_f32 v74, s83, v74
v_mul_f32 v75, s83, v75
v_mul_f32 v88, s83, v88
v_mul_f32 v89, s83, v89
v_mul_f32 v90, s83, v90
v_mul_f32 v91, s83, v91
v_cvt_pk_bf16_f32 v72, v72, v73
v_mfma_f32_16x16x32_bf16 v[0:3], v[176:179], a[168:171], v[0:3]
v_cvt_pk_bf16_f32 v73, v74, v75
v_cvt_pk_bf16_f32 v88, v88, v89
v_cvt_pk_bf16_f32 v89, v90, v91
s_nop 0
v_permlane32_swap_b32 v72, v88
v_permlane32_swap_b32 v73, v89
s_nop 0
v_permlane16_swap_b32 v72, v88
v_permlane16_swap_b32 v73, v89
v_accvgpr_write_b32 a200, v72
v_accvgpr_write_b32 a201, v73
v_accvgpr_write_b32 a202, v88
v_accvgpr_write_b32 a203, v89
v_mul_f32 v76, s83, v76
v_mul_f32 v77, s83, v77
v_mul_f32 v78, s83, v78
v_mul_f32 v79, s83, v79
v_mul_f32 v92, s83, v92
v_mul_f32 v93, s83, v93
v_mul_f32 v94, s83, v94
v_mul_f32 v95, s83, v95
v_cvt_pk_bf16_f32 v76, v76, v77
v_mfma_f32_16x16x32_bf16 v[8:11], v[176:179], a[184:187], v[8:11]
v_cvt_pk_bf16_f32 v77, v78, v79
v_cvt_pk_bf16_f32 v92, v92, v93
v_cvt_pk_bf16_f32 v93, v94, v95
s_nop 0
v_permlane32_swap_b32 v76, v92
v_permlane32_swap_b32 v77, v93
s_nop 0
v_permlane16_swap_b32 v76, v92
v_permlane16_swap_b32 v77, v93
v_accvgpr_write_b32 a216, v76
v_accvgpr_write_b32 a217, v77
v_accvgpr_write_b32 a218, v92
v_accvgpr_write_b32 a219, v93
v_mul_f32 v96, s83, v96
v_mul_f32 v97, s83, v97
v_mfma_f32_16x16x32_bf16 v[16:19], v[176:179], a[200:203], v[16:19]
v_mul_f32 v98, s83, v98
v_mul_f32 v99, s83, v99
v_mul_f32 v112, s83, v112
v_mfma_f32_16x16x32_bf16 v[24:27], v[176:179], a[216:219], v[24:27]
v_mul_f32 v113, s83, v113
v_mul_f32 v114, s83, v114
v_mul_f32 v115, s83, v115
v_cvt_pk_bf16_f32 v96, v96, v97
v_mfma_f32_16x16x32_bf16 v[4:7], a[244:247], a[168:171], v[4:7]
v_cvt_pk_bf16_f32 v97, v98, v99
v_cvt_pk_bf16_f32 v112, v112, v113
v_cvt_pk_bf16_f32 v113, v114, v115
s_nop 0
v_permlane32_swap_b32 v96, v112
v_mfma_f32_16x16x32_bf16 v[12:15], a[244:247], a[184:187], v[12:15]
v_permlane32_swap_b32 v97, v113
s_nop 0
v_permlane16_swap_b32 v96, v112
v_permlane16_swap_b32 v97, v113
v_mfma_f32_16x16x32_bf16 v[20:23], a[244:247], a[200:203], v[20:23]
v_accvgpr_write_b32 a172, v96
v_accvgpr_write_b32 a173, v97
v_accvgpr_write_b32 a174, v112
v_accvgpr_write_b32 a175, v113
v_mul_f32 v100, s83, v100
v_mul_f32 v101, s83, v101
v_mul_f32 v102, s83, v102
v_mul_f32 v103, s83, v103
v_mul_f32 v116, s83, v116
v_mul_f32 v117, s83, v117
v_mul_f32 v118, s83, v118
v_mul_f32 v119, s83, v119
v_cvt_pk_bf16_f32 v100, v100, v101
v_mfma_f32_16x16x32_bf16 v[28:31], a[244:247], a[216:219], v[28:31]
v_cvt_pk_bf16_f32 v101, v102, v103
v_cvt_pk_bf16_f32 v116, v116, v117
v_cvt_pk_bf16_f32 v117, v118, v119
s_nop 0
v_permlane32_swap_b32 v100, v116
v_permlane32_swap_b32 v101, v117
s_nop 0
v_permlane16_swap_b32 v100, v116
v_permlane16_swap_b32 v101, v117
v_accvgpr_write_b32 a188, v100
v_accvgpr_write_b32 a189, v101
v_accvgpr_write_b32 a190, v116
v_accvgpr_write_b32 a191, v117
v_mul_f32 v104, s83, v104
v_mul_f32 v105, s83, v105
v_mul_f32 v106, s83, v106
v_mul_f32 v107, s83, v107
v_mul_f32 v120, s83, v120
v_mul_f32 v121, s83, v121
v_mul_f32 v122, s83, v122
v_mul_f32 v123, s83, v123
v_cvt_pk_bf16_f32 v104, v104, v105
v_cvt_pk_bf16_f32 v105, v106, v107
v_mfma_f32_16x16x32_bf16 v[0:3], a[248:251], a[172:175], v[0:3]
v_cvt_pk_bf16_f32 v120, v120, v121
v_cvt_pk_bf16_f32 v121, v122, v123
s_nop 0
v_permlane32_swap_b32 v104, v120
v_permlane32_swap_b32 v105, v121
s_nop 0
v_permlane16_swap_b32 v104, v120
v_permlane16_swap_b32 v105, v121
v_accvgpr_write_b32 a204, v104
v_accvgpr_write_b32 a205, v105
v_accvgpr_write_b32 a206, v120
v_accvgpr_write_b32 a207, v121
v_mul_f32 v108, s83, v108
v_mul_f32 v109, s83, v109
v_mul_f32 v110, s83, v110
v_mul_f32 v111, s83, v111
v_mul_f32 v124, s83, v124
v_mul_f32 v125, s83, v125
v_mul_f32 v126, s83, v126
v_mul_f32 v127, s83, v127
v_cvt_pk_bf16_f32 v108, v108, v109
s_waitcnt lgkmcnt(0)
s_barrier
ds_read_b128 a[232:235], v201
ds_read_b128 a[236:239], v201 offset:1024
v_mfma_f32_16x16x32_bf16 v[8:11], a[248:251], a[188:191], v[8:11]
v_cvt_pk_bf16_f32 v109, v110, v111
v_cvt_pk_bf16_f32 v124, v124, v125
v_cvt_pk_bf16_f32 v125, v126, v127
s_nop 0
v_permlane32_swap_b32 v108, v124
v_permlane32_swap_b32 v109, v125
s_nop 0
v_permlane16_swap_b32 v108, v124
v_permlane16_swap_b32 v109, v125
v_accvgpr_write_b32 a220, v108
v_accvgpr_write_b32 a221, v109
v_accvgpr_write_b32 a222, v124
v_accvgpr_write_b32 a223, v125
v_mfma_f32_16x16x32_bf16 v[16:19], a[248:251], a[204:207], v[16:19]
s_nop 0
v_mfma_f32_16x16x32_bf16 v[24:27], a[248:251], a[220:223], v[24:27]
v_mfma_f32_16x16x32_bf16 v[4:7], a[252:255], a[172:175], v[4:7]
v_mfma_f32_16x16x32_bf16 v[12:15], a[252:255], a[188:191], v[12:15]
v_mfma_f32_16x16x32_bf16 v[20:23], a[252:255], a[204:207], v[20:23]
v_mfma_f32_16x16x32_bf16 v[28:31], a[252:255], a[220:223], v[28:31]
v_mfma_f32_16x16x32_bf16 v[64:67], v[160:163], a[224:227], 0
v_mfma_f32_16x16x32_bf16 v[68:71], v[164:167], a[224:227], 0
v_mfma_f32_16x16x32_bf16 v[64:67], v[168:171], a[228:231], v[64:67]
v_mfma_f32_16x16x32_bf16 v[68:71], v[172:175], a[228:231], v[68:71]
s_waitcnt lgkmcnt(0)
v_mfma_f32_16x16x32_bf16 v[64:67], v[176:179], a[232:235], v[64:67]
v_mfma_f32_16x16x32_bf16 v[68:71], a[244:247], a[232:235], v[68:71]
v_mfma_f32_16x16x32_bf16 v[64:67], a[248:251], a[236:239], v[64:67]
v_mfma_f32_16x16x32_bf16 v[68:71], a[252:255], a[236:239], v[68:71]
v_xor_b32 v252, 32, v251
v_lshlrev_b32 v216, 2, v252
v_xor_b32 v252, 16, v251
v_lshlrev_b32 v217, 2, v252
v_max_f32 v211, v0, v1
v_max3_f32 v211, v211, v2, v3
v_max3_f32 v211, v211, v4, v5
v_max3_f32 v211, v211, v6, v7
v_max_f32 v212, v8, v9
v_max3_f32 v212, v212, v10, v11
v_max3_f32 v212, v212, v12, v13
v_max3_f32 v212, v212, v14, v15
v_max_f32 v213, v16, v17
v_max3_f32 v213, v213, v18, v19
v_max3_f32 v213, v213, v20, v21
v_max3_f32 v213, v213, v22, v23
v_max_f32 v214, v24, v25
v_max3_f32 v214, v214, v26, v27
v_max3_f32 v214, v214, v28, v29
v_max3_f32 v214, v214, v30, v31
v_max_f32 v215, v64, v65
v_max3_f32 v215, v215, v66, v67
v_max3_f32 v215, v215, v68, v69
v_max3_f32 v215, v215, v70, v71
v_mov_b32 v192, v211
v_mov_b32 v193, v212
v_mov_b32 v194, v213
v_mov_b32 v195, v214
v_mov_b32 v196, v215
v_permlane32_swap_b32 v192, v211
v_permlane32_swap_b32 v193, v212
v_permlane32_swap_b32 v194, v213
v_permlane32_swap_b32 v195, v214
v_permlane32_swap_b32 v196, v215
v_max_f32 v211, v211, v192
v_max_f32 v212, v212, v193
v_max_f32 v213, v213, v194
v_max_f32 v214, v214, v195
v_max_f32 v215, v215, v196
v_mov_b32 v192, v211
v_mov_b32 v193, v212
v_mov_b32 v194, v213
v_mov_b32 v195, v214
v_mov_b32 v196, v215
v_permlane16_swap_b32 v192, v211
v_permlane16_swap_b32 v193, v212
v_permlane16_swap_b32 v194, v213
v_permlane16_swap_b32 v195, v214
v_permlane16_swap_b32 v196, v215
v_max_f32 v211, v211, v192
v_max_f32 v212, v212, v193
v_max_f32 v213, v213, v194
v_max_f32 v214, v214, v195
v_max_f32 v215, v215, v196
v_sub_f32 v72, 0, v211
v_sub_f32 v73, 0, v211
v_sub_f32 v74, 0, v211
v_sub_f32 v75, 0, v211
v_sub_f32 v76, 0, v212
v_sub_f32 v77, 0, v212
v_sub_f32 v78, 0, v212
v_sub_f32 v79, 0, v212
v_sub_f32 v80, 0, v213
v_sub_f32 v81, 0, v213
v_sub_f32 v82, 0, v213
v_sub_f32 v83, 0, v213
v_sub_f32 v84, 0, v214
v_sub_f32 v85, 0, v214
v_sub_f32 v86, 0, v214
v_sub_f32 v87, 0, v214
v_sub_f32 v88, 0, v215
v_sub_f32 v89, 0, v215
v_sub_f32 v90, 0, v215
v_sub_f32 v91, 0, v215
v_sub_f32 v64, v64, v215
v_sub_f32 v65, v65, v215
v_sub_f32 v66, v66, v215
v_sub_f32 v67, v67, v215
v_sub_f32 v68, v68, v215
v_sub_f32 v69, v69, v215
v_sub_f32 v70, v70, v215
v_sub_f32 v71, v71, v215
v_mov_b32 v209, 0
v_mov_b32 v252, 1065369472
v_accvgpr_write_b32 a240, v252
v_accvgpr_write_b32 a241, v252
v_accvgpr_write_b32 a242, v252
v_accvgpr_write_b32 a243, v252
ds_read_b128 v[128:131], v223
s_waitcnt lgkmcnt(0)
ds_read_b128 v[132:135], v223 offset:4352
ds_read_b128 v[136:139], v223 offset:64
v_mfma_f32_16x16x32_bf16 v[32:35], v[128:131], a[160:163], v[72:75]
v_sub_f32 v0, v0, v211
v_exp_f32 v192, v0
v_sub_f32 v1, v1, v211
v_sub_f32 v2, v2, v211
v_mfma_f32_16x16x32_bf16 v[40:43], v[128:131], a[176:179], v[76:79]
ds_read_b128 v[140:143], v223 offset:4416
v_exp_f32 v193, v1
v_exp_f32 v194, v2
v_mfma_f32_16x16x32_bf16 v[48:51], v[128:131], a[192:195], v[80:83]
v_cvt_pk_bf16_f32 v92, v192, v193
v_sub_f32 v3, v3, v211
v_exp_f32 v195, v3
v_mfma_f32_16x16x32_bf16 v[56:59], v[128:131], a[208:211], v[84:87]
s_waitcnt vmcnt(0)
s_barrier
s_waitcnt lgkmcnt(1)
v_cvt_pk_bf16_f32 v93, v194, v195
v_sub_f32 v4, v4, v211
v_exp_f32 v196, v4
v_mfma_f32_16x16x32_bf16 v[36:39], v[132:135], a[160:163], v[72:75]
s_add_u32 s9, s74, 16384
s_and_b32 s9, s9, 0x3ffff
s_add_u32 m0, s77, 102400
s_nop 0
buffer_load_dwordx4 v249, s[56:59], s9 offen nt lds
v_mfma_f32_16x16x32_bf16 v[44:47], v[132:135], a[176:179], v[76:79]
ds_read_b128 v[128:131], v224
v_sub_f32 v5, v5, v211
v_exp_f32 v197, v5
v_sub_f32 v6, v6, v211
v_mfma_f32_16x16x32_bf16 v[52:55], v[132:135], a[192:195], v[80:83]
v_exp_f32 v198, v6
v_cvt_pk_bf16_f32 v94, v196, v197
v_sub_f32 v7, v7, v211
v_sub_f32 v8, v8, v212
v_mfma_f32_16x16x32_bf16 v[60:63], v[132:135], a[208:211], v[84:87]
v_exp_f32 v199, v7
v_exp_f32 v192, v8
v_mfma_f32_16x16x32_bf16 v[32:35], v[136:139], a[164:167], v[32:35]
buffer_load_dwordx4 v250, s[56:59], s9 offen offset:1024 nt lds
v_cvt_pk_bf16_f32 v95, v198, v199
v_sub_f32 v9, v9, v212
v_exp_f32 v193, v9
v_mfma_f32_16x16x32_bf16 v[40:43], v[136:139], a[180:183], v[40:43]
v_cvt_pk_bf16_f32 v96, v192, v193
v_sub_f32 v10, v10, v212
v_exp_f32 v194, v10
v_sub_f32 v11, v11, v212
v_mfma_f32_16x16x32_bf16 v[48:51], v[136:139], a[196:199], v[48:51]
ds_read_b128 v[132:135], v224 offset:4352
v_exp_f32 v195, v11
v_sub_f32 v12, v12, v212
v_sub_f32 v13, v13, v212
v_mfma_f32_16x16x32_bf16 v[56:59], v[136:139], a[212:215], v[56:59]
v_exp_f32 v196, v12
v_exp_f32 v197, v13
v_mfma_f32_16x16x32_bf16 v[144:147], a[240:243], v[92:95], 0
s_waitcnt lgkmcnt(1)
buffer_load_dwordx4 v249, s[56:59], s9 offen offset:2048 nt lds
v_cvt_pk_bf16_f32 v97, v194, v195
v_cvt_pk_bf16_f32 v98, v196, v197
v_sub_f32 v14, v14, v212
v_sub_f32 v15, v15, v212
v_mfma_f32_16x16x32_bf16 v[36:39], v[140:143], a[164:167], v[36:39]
v_exp_f32 v198, v14
v_exp_f32 v199, v15
v_sub_f32 v16, v16, v213
v_mfma_f32_16x16x32_bf16 v[44:47], v[140:143], a[180:183], v[44:47]
v_exp_f32 v192, v16
v_cvt_pk_bf16_f32 v99, v198, v199
v_sub_f32 v17, v17, v213
v_sub_f32 v18, v18, v213
v_mfma_f32_16x16x32_bf16 v[52:55], v[140:143], a[196:199], v[52:55]
ds_read_b128 v[136:139], v224 offset:64
v_exp_f32 v193, v17
v_exp_f32 v194, v18
v_mfma_f32_16x16x32_bf16 v[60:63], v[140:143], a[212:215], v[60:63]
buffer_load_dwordx4 v250, s[56:59], s9 offen offset:3072 nt lds
v_cvt_pk_bf16_f32 v100, v192, v193
v_sub_f32 v19, v19, v213
v_sub_f32 v20, v20, v213
v_mfma_f32_16x16x32_bf16 v[32:35], v[128:131], a[168:171], v[32:35]
v_exp_f32 v195, v19
v_exp_f32 v196, v20
v_sub_f32 v21, v21, v213
v_mfma_f32_16x16x32_bf16 v[40:43], v[128:131], a[184:187], v[40:43]
v_exp_f32 v197, v21
v_cvt_pk_bf16_f32 v101, v194, v195
v_sub_f32 v22, v22, v213
v_sub_f32 v23, v23, v213
v_mfma_f32_16x16x32_bf16 v[48:51], v[128:131], a[200:203], v[48:51]
ds_read_b128 v[140:143], v224 offset:4416
v_exp_f32 v198, v22
v_exp_f32 v199, v23
v_mfma_f32_16x16x32_bf16 v[56:59], v[128:131], a[216:219], v[56:59]
s_add_u32 s9, s74, 24576
s_and_b32 s9, s9, 0x3ffff
s_add_u32 m0, s77, 118784
s_nop 0
buffer_load_dwordx4 v249, s[56:59], s9 offen nt lds
v_mfma_f32_16x16x32_bf16 v[148:151], a[240:243], v[96:99], 0
s_waitcnt lgkmcnt(1)
v_cvt_pk_bf16_f32 v102, v196, v197
v_cvt_pk_bf16_f32 v103, v198, v199
v_sub_f32 v24, v24, v214
v_sub_f32 v25, v25, v214
v_mfma_f32_16x16x32_bf16 v[36:39], v[132:135], a[168:171], v[36:39]
v_exp_f32 v192, v24
v_exp_f32 v193, v25
v_sub_f32 v26, v26, v214
v_mfma_f32_16x16x32_bf16 v[44:47], v[132:135], a[184:187], v[44:47]
ds_read_b64_tr_b16 v[160:161], v225
v_exp_f32 v194, v26
v_cvt_pk_bf16_f32 v104, v192, v193
v_sub_f32 v27, v27, v214
v_mfma_f32_16x16x32_bf16 v[52:55], v[132:135], a[200:203], v[52:55]
ds_read_b64_tr_b16 v[162:163], v225 offset:4096
buffer_load_dwordx4 v250, s[56:59], s9 offen offset:1024 nt lds
v_mfma_f32_16x16x32_bf16 v[60:63], v[132:135], a[216:219], v[60:63]
v_exp_f32 v195, v27
v_sub_f32 v28, v28, v214
v_exp_f32 v196, v28
v_mfma_f32_16x16x32_bf16 v[152:155], a[240:243], v[100:103], 0
v_cvt_pk_bf16_f32 v105, v194, v195
v_sub_f32 v29, v29, v214
v_exp_f32 v197, v29
v_mfma_f32_16x16x32_bf16 v[32:35], v[136:139], a[172:175], v[32:35]
ds_read_b64_tr_b16 v[164:165], v226
v_cvt_pk_bf16_f32 v106, v196, v197
v_sub_f32 v30, v30, v214
v_exp_f32 v198, v30
v_mfma_f32_16x16x32_bf16 v[40:43], v[136:139], a[188:191], v[40:43]
ds_read_b64_tr_b16 v[166:167], v226 offset:4096
buffer_load_dwordx4 v249, s[56:59], s9 offen offset:2048 nt lds
v_mfma_f32_16x16x32_bf16 v[48:51], v[136:139], a[204:207], v[48:51]
v_sub_f32 v31, v31, v214
v_exp_f32 v199, v31
s_nop 0
v_cvt_pk_bf16_f32 v107, v198, v199
v_mfma_f32_16x16x32_bf16 v[56:59], v[136:139], a[220:223], v[56:59]
s_nop 0
v_mfma_f32_16x16x32_bf16 v[156:159], a[240:243], v[104:107], 0
s_waitcnt lgkmcnt(2)
ds_read_b64_tr_b16 v[168:169], v227
v_mfma_f32_16x16x32_bf16 v[36:39], v[140:143], a[172:175], v[36:39]
ds_read_b64_tr_b16 v[170:171], v227 offset:4096
buffer_load_dwordx4 v250, s[56:59], s9 offen offset:3072 nt lds
v_mfma_f32_16x16x32_bf16 v[44:47], v[140:143], a[188:191], v[44:47]
v_mfma_f32_16x16x32_bf16 v[52:55], v[140:143], a[204:207], v[52:55]
ds_read_b64_tr_b16 v[174:175], v228 offset:4096
v_mfma_f32_16x16x32_bf16 v[60:63], v[140:143], a[220:223], v[60:63]
ds_read_b64_tr_b16 v[172:173], v228
v_mov_b32 v205, v144
v_mov_b32 v206, v148
v_mov_b32 v207, v152
v_mov_b32 v208, v156
s_waitcnt lgkmcnt(0)
s_add_u32 s70, s74, 32768
s_and_b32 s70, s70, 0x3ffff
s_add_u32 s71, s70, 8192
s_mov_b32 s72, 7
LB_loop:
v_mfma_f32_16x16x32_bf16 a[0:3], v[160:163], v[92:95], a[0:3]
v_exp_f32 v192, v64
v_mfma_f32_16x16x32_bf16 a[32:35], v[160:163], v[96:99], a[32:35]
v_exp_f32 v193, v65
v_mfma_f32_16x16x32_bf16 a[64:67], v[160:163], v[100:103], a[64:67]
v_exp_f32 v194, v66
v_mfma_f32_16x16x32_bf16 a[96:99], v[160:163], v[104:107], a[96:99]
s_waitcnt lgkmcnt(0)
v_exp_f32 v195, v67
v_mfma_f32_16x16x32_bf16 a[4:7], v[164:167], v[92:95], a[4:7]
ds_read_b64_tr_b16 v[176:177], v225 offset:1024
v_cvt_pk_bf16_f32 v124, v192, v193
v_mfma_f32_16x16x32_bf16 a[36:39], v[164:167], v[96:99], a[36:39]
ds_read_b64_tr_b16 v[178:179], v225 offset:5120
v_cvt_pk_bf16_f32 v125, v194, v195
v_mfma_f32_16x16x32_bf16 a[68:71], v[164:167], v[100:103], a[68:71]
v_exp_f32 v196, v68
v_mfma_f32_16x16x32_bf16 a[100:103], v[164:167], v[104:107], a[100:103]
v_exp_f32 v197, v69
v_mfma_f32_16x16x32_bf16 a[8:11], v[168:171], v[92:95], a[8:11]
ds_read_b64_tr_b16 v[180:181], v226 offset:1024
v_cvt_pk_bf16_f32 v126, v196, v197
v_mfma_f32_16x16x32_bf16 a[40:43], v[168:171], v[96:99], a[40:43]
ds_read_b64_tr_b16 v[182:183], v226 offset:5120
v_mfma_f32_16x16x32_bf16 a[72:75], v[168:171], v[100:103], a[72:75]
v_exp_f32 v198, v70
v_mfma_f32_16x16x32_bf16 a[104:107], v[168:171], v[104:107], a[104:107]
v_exp_f32 v199, v71
v_mfma_f32_16x16x32_bf16 a[12:15], v[172:175], v[92:95], a[12:15]
ds_read_b64_tr_b16 v[184:185], v227 offset:1024
v_cvt_pk_bf16_f32 v127, v198, v199
v_mfma_f32_16x16x32_bf16 a[44:47], v[172:175], v[96:99], a[44:47]
ds_read_b64_tr_b16 v[186:187], v227 offset:5120
v_mfma_f32_16x16x32_bf16 a[76:79], v[172:175], v[100:103], a[76:79]
v_exp_f32 v192, v32
v_mfma_f32_16x16x32_bf16 a[108:111], v[172:175], v[104:107], a[108:111]
s_waitcnt vmcnt(8)
s_barrier
v_mfma_f32_16x16x32_bf16 v[240:243], a[240:243], v[124:127], 0
s_waitcnt lgkmcnt(2)
s_add_u32 m0, s76, 0
s_nop 0
buffer_load_dwordx4 v245, s[52:55], s70 offen nt lds
v_mfma_f32_16x16x32_bf16 a[16:19], v[176:179], v[92:95], a[16:19]
ds_read_b64_tr_b16 v[188:189], v228 offset:1024
v_mfma_f32_16x16x32_bf16 a[48:51], v[176:179], v[96:99], a[48:51]
ds_read_b64_tr_b16 v[190:191], v228 offset:5120
v_mfma_f32_16x16x32_bf16 a[80:83], v[176:179], v[100:103], a[80:83]
v_exp_f32 v193, v33
v_mfma_f32_16x16x32_bf16 a[112:115], v[176:179], v[104:107], a[112:115]
buffer_load_dwordx4 v246, s[52:55], s70 offen offset:1088 nt lds
v_cvt_pk_bf16_f32 v108, v192, v193
v_mfma_f32_16x16x32_bf16 a[20:23], v[180:183], v[92:95], a[20:23]
v_exp_f32 v194, v34
v_mfma_f32_16x16x32_bf16 a[52:55], v[180:183], v[96:99], a[52:55]
v_cmp_lt_f32 vcc, s75, v240
s_cbranch_vccnz LB_stub_1
LB_ret_2:
v_add_f32 v209, v209, v240
v_mfma_f32_16x16x32_bf16 a[84:87], v[180:183], v[100:103], a[84:87]
v_exp_f32 v195, v35
v_mfma_f32_16x16x32_bf16 a[116:119], v[180:183], v[104:107], a[116:119]
s_waitcnt lgkmcnt(0)
buffer_load_dwordx4 v247, s[52:55], s70 offen offset:2176 nt lds
v_cvt_pk_bf16_f32 v109, v194, v195
v_mfma_f32_16x16x32_bf16 a[24:27], v[184:187], v[92:95], a[24:27]
v_exp_f32 v196, v36
v_mfma_f32_16x16x32_bf16 a[56:59], v[184:187], v[96:99], a[56:59]
v_exp_f32 v197, v37
v_mfma_f32_16x16x32_bf16 a[88:91], v[184:187], v[100:103], a[88:91]
v_exp_f32 v198, v38
v_mfma_f32_16x16x32_bf16 a[120:123], v[184:187], v[104:107], a[120:123]
buffer_load_dwordx4 v248, s[52:55], s70 offen offset:3264 nt lds
v_cvt_pk_bf16_f32 v110, v196, v197
v_mfma_f32_16x16x32_bf16 a[128:131], v[160:163], v[124:127], a[128:131]
ds_read_b128 v[128:131], v221 offset:34816
v_mfma_f32_16x16x32_bf16 a[28:31], v[188:191], v[92:95], a[28:31]
v_exp_f32 v199, v39
v_mfma_f32_16x16x32_bf16 a[60:63], v[188:191], v[96:99], a[60:63]
v_exp_f32 v192, v40
v_mfma_f32_16x16x32_bf16 a[92:95], v[188:191], v[100:103], a[92:95]
s_add_u32 m0, s76, 17408
s_nop 0
buffer_load_dwordx4 v245, s[52:55], s71 offen nt lds
v_cvt_pk_bf16_f32 v111, v198, v199
v_mfma_f32_16x16x32_bf16 a[124:127], v[188:191], v[104:107], a[124:127]
v_exp_f32 v193, v41
v_mfma_f32_16x16x32_bf16 a[132:135], v[164:167], v[124:127], a[132:135]
ds_read_b128 v[132:135], v221 offset:39168
v_cvt_pk_bf16_f32 v112, v192, v193
v_mfma_f32_16x16x32_bf16 a[136:139], v[168:171], v[124:127], a[136:139]
v_exp_f32 v194, v42
v_mfma_f32_16x16x32_bf16 a[140:143], v[172:175], v[124:127], a[140:143]
buffer_load_dwordx4 v246, s[52:55], s71 offen offset:1088 nt lds
v_mfma_f32_16x16x32_bf16 a[144:147], v[176:179], v[124:127], a[144:147]
v_exp_f32 v195, v43
v_mfma_f32_16x16x32_bf16 a[148:151], v[180:183], v[124:127], a[148:151]
v_exp_f32 v196, v44
v_mfma_f32_16x16x32_bf16 a[152:155], v[184:187], v[124:127], a[152:155]
v_exp_f32 v197, v45
v_mfma_f32_16x16x32_bf16 a[156:159], v[188:191], v[124:127], a[156:159]
s_waitcnt lgkmcnt(0)
ds_read_b128 v[136:139], v221 offset:34880
buffer_load_dwordx4 v247, s[52:55], s71 offen offset:2176 nt lds
v_mfma_f32_16x16x32_bf16 v[0:3], v[128:131], a[160:163], v[72:75]
v_exp_f32 v198, v46
v_mfma_f32_16x16x32_bf16 v[8:11], v[128:131], a[176:179], v[76:79]
v_exp_f32 v199, v47
v_mfma_f32_16x16x32_bf16 v[16:19], v[128:131], a[192:195], v[80:83]
v_exp_f32 v192, v48
v_mfma_f32_16x16x32_bf16 v[24:27], v[128:131], a[208:211], v[84:87]
buffer_load_dwordx4 v248, s[52:55], s71 offen offset:3264 nt lds
v_cvt_pk_bf16_f32 v113, v194, v195
v_mfma_f32_16x16x32_bf16 v[64:67], v[128:131], a[224:227], v[88:91]
ds_read_b128 v[140:143], v221 offset:39232
v_cvt_pk_bf16_f32 v114, v196, v197
v_mfma_f32_16x16x32_bf16 v[4:7], v[132:135], a[160:163], v[72:75]
v_exp_f32 v193, v49
v_mfma_f32_16x16x32_bf16 v[12:15], v[132:135], a[176:179], v[76:79]
v_exp_f32 v194, v50
v_mfma_f32_16x16x32_bf16 v[20:23], v[132:135], a[192:195], v[80:83]
v_exp_f32 v195, v51
v_mfma_f32_16x16x32_bf16 v[28:31], v[132:135], a[208:211], v[84:87]
v_exp_f32 v196, v52
v_mfma_f32_16x16x32_bf16 v[68:71], v[132:135], a[224:227], v[88:91]
v_exp_f32 v197, v53
v_mfma_f32_16x16x32_bf16 v[144:147], a[240:243], v[108:111], 0
s_waitcnt lgkmcnt(0)
ds_read_b128 v[128:131], v222 offset:34816
v_cvt_pk_bf16_f32 v115, v198, v199
v_mfma_f32_16x16x32_bf16 v[0:3], v[136:139], a[164:167], v[0:3]
v_exp_f32 v198, v54
v_mfma_f32_16x16x32_bf16 v[8:11], v[136:139], a[180:183], v[8:11]
v_exp_f32 v199, v55
v_mfma_f32_16x16x32_bf16 v[16:19], v[136:139], a[196:199], v[16:19]
v_cvt_pk_bf16_f32 v116, v192, v193
v_cvt_pk_bf16_f32 v117, v194, v195
v_mfma_f32_16x16x32_bf16 v[24:27], v[136:139], a[212:215], v[24:27]
v_exp_f32 v192, v56
v_mfma_f32_16x16x32_bf16 v[64:67], v[136:139], a[228:231], v[64:67]
ds_read_b128 v[132:135], v222 offset:39168
v_cvt_pk_bf16_f32 v118, v196, v197
v_mfma_f32_16x16x32_bf16 v[4:7], v[140:143], a[164:167], v[4:7]
v_exp_f32 v193, v57
v_mfma_f32_16x16x32_bf16 v[12:15], v[140:143], a[180:183], v[12:15]
v_exp_f32 v194, v58
v_mfma_f32_16x16x32_bf16 v[20:23], v[140:143], a[196:199], v[20:23]
v_exp_f32 v195, v59
v_mfma_f32_16x16x32_bf16 v[28:31], v[140:143], a[212:215], v[28:31]
v_exp_f32 v196, v60
v_mfma_f32_16x16x32_bf16 v[68:71], v[140:143], a[228:231], v[68:71]
v_exp_f32 v197, v61
v_mfma_f32_16x16x32_bf16 v[148:151], a[240:243], v[112:115], 0
s_waitcnt lgkmcnt(0)
ds_read_b128 v[136:139], v222 offset:34880
v_cvt_pk_bf16_f32 v119, v198, v199
v_mfma_f32_16x16x32_bf16 v[0:3], v[128:131], a[168:171], v[0:3]
v_exp_f32 v198, v62
v_mfma_f32_16x16x32_bf16 v[8:11], v[128:131], a[184:187], v[8:11]
v_exp_f32 v199, v63
v_mfma_f32_16x16x32_bf16 v[16:19], v[128:131], a[200:203], v[16:19]
v_cvt_pk_bf16_f32 v120, v192, v193
v_cvt_pk_bf16_f32 v121, v194, v195
v_mfma_f32_16x16x32_bf16 v[24:27], v[128:131], a[216:219], v[24:27]
v_cvt_pk_bf16_f32 v122, v196, v197
v_cvt_pk_bf16_f32 v123, v198, v199
v_mfma_f32_16x16x32_bf16 v[64:67], v[128:131], a[232:235], v[64:67]
v_mfma_f32_16x16x32_bf16 v[4:7], v[132:135], a[168:171], v[4:7]
ds_read_b128 v[140:143], v222 offset:39232
v_mfma_f32_16x16x32_bf16 v[12:15], v[132:135], a[184:187], v[12:15]
v_mfma_f32_16x16x32_bf16 v[20:23], v[132:135], a[200:203], v[20:23]
v_mfma_f32_16x16x32_bf16 v[28:31], v[132:135], a[216:219], v[28:31]
v_mfma_f32_16x16x32_bf16 v[68:71], v[132:135], a[232:235], v[68:71]
ds_read_b64_tr_b16 v[160:161], v229
v_mfma_f32_16x16x32_bf16 v[152:155], a[240:243], v[116:119], 0
s_waitcnt lgkmcnt(2)
ds_read_b64_tr_b16 v[162:163], v229 offset:4096
v_mfma_f32_16x16x32_bf16 v[0:3], v[136:139], a[172:175], v[0:3]
v_mfma_f32_16x16x32_bf16 v[8:11], v[136:139], a[188:191], v[8:11]
v_mfma_f32_16x16x32_bf16 v[16:19], v[136:139], a[204:207], v[16:19]
ds_read_b64_tr_b16 v[164:165], v230
v_mfma_f32_16x16x32_bf16 v[24:27], v[136:139], a[220:223], v[24:27]
ds_read_b64_tr_b16 v[166:167], v230 offset:4096
v_mfma_f32_16x16x32_bf16 v[64:67], v[136:139], a[236:239], v[64:67]
v_mfma_f32_16x16x32_bf16 v[156:159], a[240:243], v[120:123], 0
s_waitcnt lgkmcnt(4)
v_mfma_f32_16x16x32_bf16 v[4:7], v[140:143], a[172:175], v[4:7]
ds_read_b64_tr_b16 v[168:169], v231
v_mfma_f32_16x16x32_bf16 v[12:15], v[140:143], a[188:191], v[12:15]
ds_read_b64_tr_b16 v[170:171], v231 offset:4096
v_mfma_f32_16x16x32_bf16 v[20:23], v[140:143], a[204:207], v[20:23]
v_mfma_f32_16x16x32_bf16 v[28:31], v[140:143], a[220:223], v[28:31]
ds_read_b64_tr_b16 v[174:175], v232 offset:4096
v_mfma_f32_16x16x32_bf16 v[68:71], v[140:143], a[236:239], v[68:71]
ds_read_b64_tr_b16 v[172:173], v232
v_max3_f32 v210, v144, v148, v152
v_max_f32 v210, v210, v156
v_cmp_lt_f32 vcc, s75, v210
s_cbranch_vccnz LB_stub_3
LB_ret_4:
s_waitcnt lgkmcnt(2)
v_add_f32 v205, v205, v144
v_add_f32 v206, v206, v148
v_add_f32 v207, v207, v152
v_add_f32 v208, v208, v156
v_mfma_f32_16x16x32_bf16 a[0:3], v[160:163], v[108:111], a[0:3]
v_mfma_f32_16x16x32_bf16 a[32:35], v[160:163], v[112:115], a[32:35]
v_mfma_f32_16x16x32_bf16 a[64:67], v[160:163], v[116:119], a[64:67]
v_mfma_f32_16x16x32_bf16 a[96:99], v[160:163], v[120:123], a[96:99]
ds_read_b64_tr_b16 v[176:177], v229 offset:1024
v_mfma_f32_16x16x32_bf16 a[4:7], v[164:167], v[108:111], a[4:7]
ds_read_b64_tr_b16 v[178:179], v229 offset:5120
v_mfma_f32_16x16x32_bf16 a[36:39], v[164:167], v[112:115], a[36:39]
v_exp_f32 v192, v0
v_mfma_f32_16x16x32_bf16 a[68:71], v[164:167], v[116:119], a[68:71]
v_exp_f32 v193, v1
v_mfma_f32_16x16x32_bf16 a[100:103], v[164:167], v[120:123], a[100:103]
ds_read_b64_tr_b16 v[180:181], v230 offset:1024
v_cvt_pk_bf16_f32 v92, v192, v193
v_mfma_f32_16x16x32_bf16 a[8:11], v[168:171], v[108:111], a[8:11]
ds_read_b64_tr_b16 v[182:183], v230 offset:5120
v_mfma_f32_16x16x32_bf16 a[40:43], v[168:171], v[112:115], a[40:43]
v_exp_f32 v194, v2
v_mfma_f32_16x16x32_bf16 a[72:75], v[168:171], v[116:119], a[72:75]
v_exp_f32 v195, v3
v_mfma_f32_16x16x32_bf16 a[104:107], v[168:171], v[120:123], a[104:107]
s_waitcnt lgkmcnt(2)
ds_read_b64_tr_b16 v[184:185], v231 offset:1024
v_cvt_pk_bf16_f32 v93, v194, v195
v_mfma_f32_16x16x32_bf16 a[12:15], v[172:175], v[108:111], a[12:15]
ds_read_b64_tr_b16 v[186:187], v231 offset:5120
v_mfma_f32_16x16x32_bf16 a[44:47], v[172:175], v[112:115], a[44:47]
v_exp_f32 v196, v4
v_mfma_f32_16x16x32_bf16 a[76:79], v[172:175], v[116:119], a[76:79]
v_exp_f32 v197, v5
v_mfma_f32_16x16x32_bf16 a[108:111], v[172:175], v[120:123], a[108:111]
ds_read_b64_tr_b16 v[188:189], v232 offset:1024
v_cvt_pk_bf16_f32 v94, v196, v197
v_mfma_f32_16x16x32_bf16 a[16:19], v[176:179], v[108:111], a[16:19]
ds_read_b64_tr_b16 v[190:191], v232 offset:5120
v_mfma_f32_16x16x32_bf16 a[48:51], v[176:179], v[112:115], a[48:51]
v_exp_f32 v198, v6
v_mfma_f32_16x16x32_bf16 a[80:83], v[176:179], v[116:119], a[80:83]
v_exp_f32 v199, v7
v_mfma_f32_16x16x32_bf16 a[112:115], v[176:179], v[120:123], a[112:115]
s_waitcnt lgkmcnt(2)
v_exp_f32 v192, v8
v_mfma_f32_16x16x32_bf16 a[20:23], v[180:183], v[108:111], a[20:23]
ds_read_b128 v[128:131], v223 offset:34816
v_cvt_pk_bf16_f32 v95, v198, v199
v_mfma_f32_16x16x32_bf16 a[52:55], v[180:183], v[112:115], a[52:55]
v_exp_f32 v193, v9
v_mfma_f32_16x16x32_bf16 a[84:87], v[180:183], v[116:119], a[84:87]
v_exp_f32 v194, v10
v_mfma_f32_16x16x32_bf16 a[116:119], v[180:183], v[120:123], a[116:119]
v_exp_f32 v195, v11
v_mfma_f32_16x16x32_bf16 a[24:27], v[184:187], v[108:111], a[24:27]
ds_read_b128 v[132:135], v223 offset:39168
v_cvt_pk_bf16_f32 v96, v192, v193
v_mfma_f32_16x16x32_bf16 a[56:59], v[184:187], v[112:115], a[56:59]
v_exp_f32 v196, v12
v_mfma_f32_16x16x32_bf16 a[88:91], v[184:187], v[116:119], a[88:91]
v_exp_f32 v197, v13
v_mfma_f32_16x16x32_bf16 a[120:123], v[184:187], v[120:123], a[120:123]
s_waitcnt lgkmcnt(1)
v_exp_f32 v198, v14
v_mfma_f32_16x16x32_bf16 a[28:31], v[188:191], v[108:111], a[28:31]
v_exp_f32 v199, v15
v_mfma_f32_16x16x32_bf16 a[60:63], v[188:191], v[112:115], a[60:63]
ds_read_b128 v[136:139], v223 offset:34880
v_cvt_pk_bf16_f32 v97, v194, v195
v_mfma_f32_16x16x32_bf16 a[92:95], v[188:191], v[116:119], a[92:95]
v_exp_f32 v192, v16
v_mfma_f32_16x16x32_bf16 a[124:127], v[188:191], v[120:123], a[124:127]
v_exp_f32 v193, v17
v_mfma_f32_16x16x32_bf16 v[32:35], v[128:131], a[160:163], v[72:75]
v_exp_f32 v194, v18
v_mfma_f32_16x16x32_bf16 v[40:43], v[128:131], a[176:179], v[76:79]
ds_read_b128 v[140:143], v223 offset:39232
v_cvt_pk_bf16_f32 v98, v196, v197
v_mfma_f32_16x16x32_bf16 v[48:51], v[128:131], a[192:195], v[80:83]
v_exp_f32 v195, v19
v_mfma_f32_16x16x32_bf16 v[56:59], v[128:131], a[208:211], v[84:87]
s_waitcnt vmcnt(8)
s_barrier
s_waitcnt lgkmcnt(1)
v_cvt_pk_bf16_f32 v99, v198, v199
v_mfma_f32_16x16x32_bf16 v[36:39], v[132:135], a[160:163], v[72:75]
s_add_u32 m0, s77, 69632
s_nop 0
buffer_load_dwordx4 v249, s[56:59], s70 offen nt lds
v_cvt_pk_bf16_f32 v100, v192, v193
v_mfma_f32_16x16x32_bf16 v[44:47], v[132:135], a[176:179], v[76:79]
v_exp_f32 v196, v20
v_mfma_f32_16x16x32_bf16 v[52:55], v[132:135], a[192:195], v[80:83]
ds_read_b128 v[128:131], v224 offset:34816
v_cvt_pk_bf16_f32 v101, v194, v195
v_mfma_f32_16x16x32_bf16 v[60:63], v[132:135], a[208:211], v[84:87]
v_exp_f32 v197, v21
v_mfma_f32_16x16x32_bf16 v[144:147], a[240:243], v[92:95], 0
buffer_load_dwordx4 v250, s[56:59], s70 offen offset:1024 nt lds
v_cvt_pk_bf16_f32 v102, v196, v197
v_mfma_f32_16x16x32_bf16 v[32:35], v[136:139], a[164:167], v[32:35]
v_exp_f32 v198, v22
v_mfma_f32_16x16x32_bf16 v[40:43], v[136:139], a[180:183], v[40:43]
ds_read_b128 v[132:135], v224 offset:39168
v_mfma_f32_16x16x32_bf16 v[48:51], v[136:139], a[196:199], v[48:51]
v_exp_f32 v199, v23
v_mfma_f32_16x16x32_bf16 v[56:59], v[136:139], a[212:215], v[56:59]
s_waitcnt lgkmcnt(1)
buffer_load_dwordx4 v249, s[56:59], s70 offen offset:2048 nt lds
v_cvt_pk_bf16_f32 v103, v198, v199
v_mfma_f32_16x16x32_bf16 v[36:39], v[140:143], a[164:167], v[36:39]
v_exp_f32 v192, v24
v_mfma_f32_16x16x32_bf16 v[44:47], v[140:143], a[180:183], v[44:47]
v_exp_f32 v193, v25
v_mfma_f32_16x16x32_bf16 v[52:55], v[140:143], a[196:199], v[52:55]
ds_read_b128 v[136:139], v224 offset:34880
v_cvt_pk_bf16_f32 v104, v192, v193
v_mfma_f32_16x16x32_bf16 v[60:63], v[140:143], a[212:215], v[60:63]
buffer_load_dwordx4 v250, s[56:59], s70 offen offset:3072 nt lds
v_mfma_f32_16x16x32_bf16 v[148:151], a[240:243], v[96:99], 0
v_exp_f32 v194, v26
v_mfma_f32_16x16x32_bf16 v[32:35], v[128:131], a[168:171], v[32:35]
v_exp_f32 v195, v27
v_mfma_f32_16x16x32_bf16 v[40:43], v[128:131], a[184:187], v[40:43]
v_exp_f32 v196, v28
v_mfma_f32_16x16x32_bf16 v[48:51], v[128:131], a[200:203], v[48:51]
ds_read_b128 v[140:143], v224 offset:39232
s_add_u32 m0, s77, 86016
s_nop 0
buffer_load_dwordx4 v249, s[56:59], s71 offen nt lds
v_mfma_f32_16x16x32_bf16 v[56:59], v[128:131], a[216:219], v[56:59]
s_waitcnt lgkmcnt(1)
v_exp_f32 v197, v29
v_mfma_f32_16x16x32_bf16 v[36:39], v[132:135], a[168:171], v[36:39]
v_exp_f32 v198, v30
v_mfma_f32_16x16x32_bf16 v[44:47], v[132:135], a[184:187], v[44:47]
ds_read_b64_tr_b16 v[160:161], v225 offset:32768
v_cvt_pk_bf16_f32 v105, v194, v195
v_mfma_f32_16x16x32_bf16 v[52:55], v[132:135], a[200:203], v[52:55]
ds_read_b64_tr_b16 v[162:163], v225 offset:36864
buffer_load_dwordx4 v250, s[56:59], s71 offen offset:1024 nt lds
v_mfma_f32_16x16x32_bf16 v[60:63], v[132:135], a[216:219], v[60:63]
v_exp_f32 v199, v31
v_mfma_f32_16x16x32_bf16 v[152:155], a[240:243], v[100:103], 0
v_cvt_pk_bf16_f32 v106, v196, v197
v_cvt_pk_bf16_f32 v107, v198, v199
v_mfma_f32_16x16x32_bf16 v[32:35], v[136:139], a[172:175], v[32:35]
ds_read_b64_tr_b16 v[164:165], v226 offset:32768
v_mfma_f32_16x16x32_bf16 v[40:43], v[136:139], a[188:191], v[40:43]
ds_read_b64_tr_b16 v[166:167], v226 offset:36864
buffer_load_dwordx4 v249, s[56:59], s71 offen offset:2048 nt lds
v_mfma_f32_16x16x32_bf16 v[48:51], v[136:139], a[204:207], v[48:51]
v_mfma_f32_16x16x32_bf16 v[56:59], v[136:139], a[220:223], v[56:59]
v_mfma_f32_16x16x32_bf16 v[156:159], a[240:243], v[104:107], 0
s_waitcnt lgkmcnt(2)
ds_read_b64_tr_b16 v[168:169], v227 offset:32768
v_mfma_f32_16x16x32_bf16 v[36:39], v[140:143], a[172:175], v[36:39]
ds_read_b64_tr_b16 v[170:171], v227 offset:36864
buffer_load_dwordx4 v250, s[56:59], s71 offen offset:3072 nt lds
v_mfma_f32_16x16x32_bf16 v[44:47], v[140:143], a[188:191], v[44:47]
v_mfma_f32_16x16x32_bf16 v[52:55], v[140:143], a[204:207], v[52:55]
ds_read_b64_tr_b16 v[174:175], v228 offset:36864
v_mfma_f32_16x16x32_bf16 v[60:63], v[140:143], a[220:223], v[60:63]
ds_read_b64_tr_b16 v[172:173], v228 offset:32768
s_add_u32 s70, s70, 16384
s_and_b32 s70, s70, 0x3ffff
s_add_u32 s71, s70, 8192
v_max3_f32 v210, v144, v148, v152
v_max_f32 v210, v210, v156
v_cmp_lt_f32 vcc, s75, v210
s_cbranch_vccnz LB_stub_5
LB_ret_6:
v_add_f32 v205, v205, v144
v_add_f32 v206, v206, v148
v_add_f32 v207, v207, v152
v_add_f32 v208, v208, v156
v_mfma_f32_16x16x32_bf16 a[0:3], v[160:163], v[92:95], a[0:3]
v_exp_f32 v192, v64
v_mfma_f32_16x16x32_bf16 a[32:35], v[160:163], v[96:99], a[32:35]
v_exp_f32 v193, v65
v_mfma_f32_16x16x32_bf16 a[64:67], v[160:163], v[100:103], a[64:67]
v_exp_f32 v194, v66
v_mfma_f32_16x16x32_bf16 a[96:99], v[160:163], v[104:107], a[96:99]
s_waitcnt lgkmcnt(0)
v_exp_f32 v195, v67
v_mfma_f32_16x16x32_bf16 a[4:7], v[164:167], v[92:95], a[4:7]
ds_read_b64_tr_b16 v[176:177], v225 offset:33792
v_cvt_pk_bf16_f32 v124, v192, v193
v_mfma_f32_16x16x32_bf16 a[36:39], v[164:167], v[96:99], a[36:39]
ds_read_b64_tr_b16 v[178:179], v225 offset:37888
v_cvt_pk_bf16_f32 v125, v194, v195
v_mfma_f32_16x16x32_bf16 a[68:71], v[164:167], v[100:103], a[68:71]
v_exp_f32 v196, v68
v_mfma_f32_16x16x32_bf16 a[100:103], v[164:167], v[104:107], a[100:103]
v_exp_f32 v197, v69
v_mfma_f32_16x16x32_bf16 a[8:11], v[168:171], v[92:95], a[8:11]
ds_read_b64_tr_b16 v[180:181], v226 offset:33792
v_cvt_pk_bf16_f32 v126, v196, v197
v_mfma_f32_16x16x32_bf16 a[40:43], v[168:171], v[96:99], a[40:43]
ds_read_b64_tr_b16 v[182:183], v226 offset:37888
v_mfma_f32_16x16x32_bf16 a[72:75], v[168:171], v[100:103], a[72:75]
v_exp_f32 v198, v70
v_mfma_f32_16x16x32_bf16 a[104:107], v[168:171], v[104:107], a[104:107]
v_exp_f32 v199, v71
v_mfma_f32_16x16x32_bf16 a[12:15], v[172:175], v[92:95], a[12:15]
ds_read_b64_tr_b16 v[184:185], v227 offset:33792
v_cvt_pk_bf16_f32 v127, v198, v199
v_mfma_f32_16x16x32_bf16 a[44:47], v[172:175], v[96:99], a[44:47]
ds_read_b64_tr_b16 v[186:187], v227 offset:37888
v_mfma_f32_16x16x32_bf16 a[76:79], v[172:175], v[100:103], a[76:79]
v_exp_f32 v192, v32
v_mfma_f32_16x16x32_bf16 a[108:111], v[172:175], v[104:107], a[108:111]
s_waitcnt vmcnt(8)
s_barrier
v_mfma_f32_16x16x32_bf16 v[240:243], a[240:243], v[124:127], 0
s_waitcnt lgkmcnt(2)
s_add_u32 m0, s76, 34816
s_nop 0
buffer_load_dwordx4 v245, s[52:55], s70 offen nt lds
v_mfma_f32_16x16x32_bf16 a[16:19], v[176:179], v[92:95], a[16:19]
ds_read_b64_tr_b16 v[188:189], v228 offset:33792
v_mfma_f32_16x16x32_bf16 a[48:51], v[176:179], v[96:99], a[48:51]
ds_read_b64_tr_b16 v[190:191], v228 offset:37888
v_mfma_f32_16x16x32_bf16 a[80:83], v[176:179], v[100:103], a[80:83]
v_exp_f32 v193, v33
v_mfma_f32_16x16x32_bf16 a[112:115], v[176:179], v[104:107], a[112:115]
buffer_load_dwordx4 v246, s[52:55], s70 offen offset:1088 nt lds
v_cvt_pk_bf16_f32 v108, v192, v193
v_mfma_f32_16x16x32_bf16 a[20:23], v[180:183], v[92:95], a[20:23]
v_exp_f32 v194, v34
v_mfma_f32_16x16x32_bf16 a[52:55], v[180:183], v[96:99], a[52:55]
v_cmp_lt_f32 vcc, s75, v240
s_cbranch_vccnz LB_stub_7
LB_ret_8:
v_add_f32 v209, v209, v240
v_mfma_f32_16x16x32_bf16 a[84:87], v[180:183], v[100:103], a[84:87]
v_exp_f32 v195, v35
v_mfma_f32_16x16x32_bf16 a[116:119], v[180:183], v[104:107], a[116:119]
s_waitcnt lgkmcnt(0)
buffer_load_dwordx4 v247, s[52:55], s70 offen offset:2176 nt lds
v_cvt_pk_bf16_f32 v109, v194, v195
v_mfma_f32_16x16x32_bf16 a[24:27], v[184:187], v[92:95], a[24:27]
v_exp_f32 v196, v36
v_mfma_f32_16x16x32_bf16 a[56:59], v[184:187], v[96:99], a[56:59]
v_exp_f32 v197, v37
v_mfma_f32_16x16x32_bf16 a[88:91], v[184:187], v[100:103], a[88:91]
v_exp_f32 v198, v38
v_mfma_f32_16x16x32_bf16 a[120:123], v[184:187], v[104:107], a[120:123]
buffer_load_dwordx4 v248, s[52:55], s70 offen offset:3264 nt lds
v_cvt_pk_bf16_f32 v110, v196, v197
v_mfma_f32_16x16x32_bf16 a[128:131], v[160:163], v[124:127], a[128:131]
ds_read_b128 v[128:131], v221
v_mfma_f32_16x16x32_bf16 a[28:31], v[188:191], v[92:95], a[28:31]
v_exp_f32 v199, v39
v_mfma_f32_16x16x32_bf16 a[60:63], v[188:191], v[96:99], a[60:63]
v_exp_f32 v192, v40
v_mfma_f32_16x16x32_bf16 a[92:95], v[188:191], v[100:103], a[92:95]
s_add_u32 m0, s76, 52224
s_nop 0
buffer_load_dwordx4 v245, s[52:55], s71 offen nt lds
v_cvt_pk_bf16_f32 v111, v198, v199
v_mfma_f32_16x16x32_bf16 a[124:127], v[188:191], v[104:107], a[124:127]
v_exp_f32 v193, v41
v_mfma_f32_16x16x32_bf16 a[132:135], v[164:167], v[124:127], a[132:135]
ds_read_b128 v[132:135], v221 offset:4352
v_cvt_pk_bf16_f32 v112, v192, v193
v_mfma_f32_16x16x32_bf16 a[136:139], v[168:171], v[124:127], a[136:139]
v_exp_f32 v194, v42
v_mfma_f32_16x16x32_bf16 a[140:143], v[172:175], v[124:127], a[140:143]
buffer_load_dwordx4 v246, s[52:55], s71 offen offset:1088 nt lds
v_mfma_f32_16x16x32_bf16 a[144:147], v[176:179], v[124:127], a[144:147]
v_exp_f32 v195, v43
v_mfma_f32_16x16x32_bf16 a[148:151], v[180:183], v[124:127], a[148:151]
v_exp_f32 v196, v44
v_mfma_f32_16x16x32_bf16 a[152:155], v[184:187], v[124:127], a[152:155]
v_exp_f32 v197, v45
v_mfma_f32_16x16x32_bf16 a[156:159], v[188:191], v[124:127], a[156:159]
s_waitcnt lgkmcnt(0)
ds_read_b128 v[136:139], v221 offset:64
buffer_load_dwordx4 v247, s[52:55], s71 offen offset:2176 nt lds
v_mfma_f32_16x16x32_bf16 v[0:3], v[128:131], a[160:163], v[72:75]
v_exp_f32 v198, v46
v_mfma_f32_16x16x32_bf16 v[8:11], v[128:131], a[176:179], v[76:79]
v_exp_f32 v199, v47
v_mfma_f32_16x16x32_bf16 v[16:19], v[128:131], a[192:195], v[80:83]
v_exp_f32 v192, v48
v_mfma_f32_16x16x32_bf16 v[24:27], v[128:131], a[208:211], v[84:87]
buffer_load_dwordx4 v248, s[52:55], s71 offen offset:3264 nt lds
v_cvt_pk_bf16_f32 v113, v194, v195
v_mfma_f32_16x16x32_bf16 v[64:67], v[128:131], a[224:227], v[88:91]
ds_read_b128 v[140:143], v221 offset:4416
v_cvt_pk_bf16_f32 v114, v196, v197
v_mfma_f32_16x16x32_bf16 v[4:7], v[132:135], a[160:163], v[72:75]
v_exp_f32 v193, v49
v_mfma_f32_16x16x32_bf16 v[12:15], v[132:135], a[176:179], v[76:79]
v_exp_f32 v194, v50
v_mfma_f32_16x16x32_bf16 v[20:23], v[132:135], a[192:195], v[80:83]
v_exp_f32 v195, v51
v_mfma_f32_16x16x32_bf16 v[28:31], v[132:135], a[208:211], v[84:87]
v_exp_f32 v196, v52
v_mfma_f32_16x16x32_bf16 v[68:71], v[132:135], a[224:227], v[88:91]
v_exp_f32 v197, v53
v_mfma_f32_16x16x32_bf16 v[144:147], a[240:243], v[108:111], 0
s_waitcnt lgkmcnt(0)
ds_read_b128 v[128:131], v222
v_cvt_pk_bf16_f32 v115, v198, v199
v_mfma_f32_16x16x32_bf16 v[0:3], v[136:139], a[164:167], v[0:3]
v_exp_f32 v198, v54
v_mfma_f32_16x16x32_bf16 v[8:11], v[136:139], a[180:183], v[8:11]
v_exp_f32 v199, v55
v_mfma_f32_16x16x32_bf16 v[16:19], v[136:139], a[196:199], v[16:19]
v_cvt_pk_bf16_f32 v116, v192, v193
v_cvt_pk_bf16_f32 v117, v194, v195
v_mfma_f32_16x16x32_bf16 v[24:27], v[136:139], a[212:215], v[24:27]
v_exp_f32 v192, v56
v_mfma_f32_16x16x32_bf16 v[64:67], v[136:139], a[228:231], v[64:67]
ds_read_b128 v[132:135], v222 offset:4352
v_cvt_pk_bf16_f32 v118, v196, v197
v_mfma_f32_16x16x32_bf16 v[4:7], v[140:143], a[164:167], v[4:7]
v_exp_f32 v193, v57
v_mfma_f32_16x16x32_bf16 v[12:15], v[140:143], a[180:183], v[12:15]
v_exp_f32 v194, v58
v_mfma_f32_16x16x32_bf16 v[20:23], v[140:143], a[196:199], v[20:23]
v_exp_f32 v195, v59
v_mfma_f32_16x16x32_bf16 v[28:31], v[140:143], a[212:215], v[28:31]
v_exp_f32 v196, v60
v_mfma_f32_16x16x32_bf16 v[68:71], v[140:143], a[228:231], v[68:71]
v_exp_f32 v197, v61
v_mfma_f32_16x16x32_bf16 v[148:151], a[240:243], v[112:115], 0
s_waitcnt lgkmcnt(0)
ds_read_b128 v[136:139], v222 offset:64
v_cvt_pk_bf16_f32 v119, v198, v199
v_mfma_f32_16x16x32_bf16 v[0:3], v[128:131], a[168:171], v[0:3]
v_exp_f32 v198, v62
v_mfma_f32_16x16x32_bf16 v[8:11], v[128:131], a[184:187], v[8:11]
v_exp_f32 v199, v63
v_mfma_f32_16x16x32_bf16 v[16:19], v[128:131], a[200:203], v[16:19]
v_cvt_pk_bf16_f32 v120, v192, v193
v_cvt_pk_bf16_f32 v121, v194, v195
v_mfma_f32_16x16x32_bf16 v[24:27], v[128:131], a[216:219], v[24:27]
v_cvt_pk_bf16_f32 v122, v196, v197
v_cvt_pk_bf16_f32 v123, v198, v199
v_mfma_f32_16x16x32_bf16 v[64:67], v[128:131], a[232:235], v[64:67]
v_mfma_f32_16x16x32_bf16 v[4:7], v[132:135], a[168:171], v[4:7]
ds_read_b128 v[140:143], v222 offset:4416
v_mfma_f32_16x16x32_bf16 v[12:15], v[132:135], a[184:187], v[12:15]
v_mfma_f32_16x16x32_bf16 v[20:23], v[132:135], a[200:203], v[20:23]
v_mfma_f32_16x16x32_bf16 v[28:31], v[132:135], a[216:219], v[28:31]
v_mfma_f32_16x16x32_bf16 v[68:71], v[132:135], a[232:235], v[68:71]
ds_read_b64_tr_b16 v[160:161], v229 offset:32768
v_mfma_f32_16x16x32_bf16 v[152:155], a[240:243], v[116:119], 0
s_waitcnt lgkmcnt(2)
ds_read_b64_tr_b16 v[162:163], v229 offset:36864
v_mfma_f32_16x16x32_bf16 v[0:3], v[136:139], a[172:175], v[0:3]
v_mfma_f32_16x16x32_bf16 v[8:11], v[136:139], a[188:191], v[8:11]
v_mfma_f32_16x16x32_bf16 v[16:19], v[136:139], a[204:207], v[16:19]
ds_read_b64_tr_b16 v[164:165], v230 offset:32768
v_mfma_f32_16x16x32_bf16 v[24:27], v[136:139], a[220:223], v[24:27]
ds_read_b64_tr_b16 v[166:167], v230 offset:36864
v_mfma_f32_16x16x32_bf16 v[64:67], v[136:139], a[236:239], v[64:67]
v_mfma_f32_16x16x32_bf16 v[156:159], a[240:243], v[120:123], 0
s_waitcnt lgkmcnt(4)
v_mfma_f32_16x16x32_bf16 v[4:7], v[140:143], a[172:175], v[4:7]
ds_read_b64_tr_b16 v[168:169], v231 offset:32768
v_mfma_f32_16x16x32_bf16 v[12:15], v[140:143], a[188:191], v[12:15]
ds_read_b64_tr_b16 v[170:171], v231 offset:36864
v_mfma_f32_16x16x32_bf16 v[20:23], v[140:143], a[204:207], v[20:23]
v_mfma_f32_16x16x32_bf16 v[28:31], v[140:143], a[220:223], v[28:31]
ds_read_b64_tr_b16 v[174:175], v232 offset:36864
v_mfma_f32_16x16x32_bf16 v[68:71], v[140:143], a[236:239], v[68:71]
ds_read_b64_tr_b16 v[172:173], v232 offset:32768
v_max3_f32 v210, v144, v148, v152
v_max_f32 v210, v210, v156
v_cmp_lt_f32 vcc, s75, v210
s_cbranch_vccnz LB_stub_9
LB_ret_10:
s_waitcnt lgkmcnt(2)
v_add_f32 v205, v205, v144
v_add_f32 v206, v206, v148
v_add_f32 v207, v207, v152
v_add_f32 v208, v208, v156
v_mfma_f32_16x16x32_bf16 a[0:3], v[160:163], v[108:111], a[0:3]
v_mfma_f32_16x16x32_bf16 a[32:35], v[160:163], v[112:115], a[32:35]
v_mfma_f32_16x16x32_bf16 a[64:67], v[160:163], v[116:119], a[64:67]
v_mfma_f32_16x16x32_bf16 a[96:99], v[160:163], v[120:123], a[96:99]
ds_read_b64_tr_b16 v[176:177], v229 offset:33792
v_mfma_f32_16x16x32_bf16 a[4:7], v[164:167], v[108:111], a[4:7]
ds_read_b64_tr_b16 v[178:179], v229 offset:37888
v_mfma_f32_16x16x32_bf16 a[36:39], v[164:167], v[112:115], a[36:39]
v_exp_f32 v192, v0
v_mfma_f32_16x16x32_bf16 a[68:71], v[164:167], v[116:119], a[68:71]
v_exp_f32 v193, v1
v_mfma_f32_16x16x32_bf16 a[100:103], v[164:167], v[120:123], a[100:103]
ds_read_b64_tr_b16 v[180:181], v230 offset:33792
v_cvt_pk_bf16_f32 v92, v192, v193
v_mfma_f32_16x16x32_bf16 a[8:11], v[168:171], v[108:111], a[8:11]
ds_read_b64_tr_b16 v[182:183], v230 offset:37888
v_mfma_f32_16x16x32_bf16 a[40:43], v[168:171], v[112:115], a[40:43]
v_exp_f32 v194, v2
v_mfma_f32_16x16x32_bf16 a[72:75], v[168:171], v[116:119], a[72:75]
v_exp_f32 v195, v3
v_mfma_f32_16x16x32_bf16 a[104:107], v[168:171], v[120:123], a[104:107]
s_waitcnt lgkmcnt(2)
ds_read_b64_tr_b16 v[184:185], v231 offset:33792
v_cvt_pk_bf16_f32 v93, v194, v195
v_mfma_f32_16x16x32_bf16 a[12:15], v[172:175], v[108:111], a[12:15]
ds_read_b64_tr_b16 v[186:187], v231 offset:37888
v_mfma_f32_16x16x32_bf16 a[44:47], v[172:175], v[112:115], a[44:47]
v_exp_f32 v196, v4
v_mfma_f32_16x16x32_bf16 a[76:79], v[172:175], v[116:119], a[76:79]
v_exp_f32 v197, v5
v_mfma_f32_16x16x32_bf16 a[108:111], v[172:175], v[120:123], a[108:111]
ds_read_b64_tr_b16 v[188:189], v232 offset:33792
v_cvt_pk_bf16_f32 v94, v196, v197
v_mfma_f32_16x16x32_bf16 a[16:19], v[176:179], v[108:111], a[16:19]
ds_read_b64_tr_b16 v[190:191], v232 offset:37888
v_mfma_f32_16x16x32_bf16 a[48:51], v[176:179], v[112:115], a[48:51]
v_exp_f32 v198, v6
v_mfma_f32_16x16x32_bf16 a[80:83], v[176:179], v[116:119], a[80:83]
v_exp_f32 v199, v7
v_mfma_f32_16x16x32_bf16 a[112:115], v[176:179], v[120:123], a[112:115]
s_waitcnt lgkmcnt(2)
v_exp_f32 v192, v8
v_mfma_f32_16x16x32_bf16 a[20:23], v[180:183], v[108:111], a[20:23]
ds_read_b128 v[128:131], v223
v_cvt_pk_bf16_f32 v95, v198, v199
v_mfma_f32_16x16x32_bf16 a[52:55], v[180:183], v[112:115], a[52:55]
v_exp_f32 v193, v9
v_mfma_f32_16x16x32_bf16 a[84:87], v[180:183], v[116:119], a[84:87]
v_exp_f32 v194, v10
v_mfma_f32_16x16x32_bf16 a[116:119], v[180:183], v[120:123], a[116:119]
v_exp_f32 v195, v11
v_mfma_f32_16x16x32_bf16 a[24:27], v[184:187], v[108:111], a[24:27]
ds_read_b128 v[132:135], v223 offset:4352
v_cvt_pk_bf16_f32 v96, v192, v193
v_mfma_f32_16x16x32_bf16 a[56:59], v[184:187], v[112:115], a[56:59]
v_exp_f32 v196, v12
v_mfma_f32_16x16x32_bf16 a[88:91], v[184:187], v[116:119], a[88:91]
v_exp_f32 v197, v13
v_mfma_f32_16x16x32_bf16 a[120:123], v[184:187], v[120:123], a[120:123]
s_waitcnt lgkmcnt(1)
v_exp_f32 v198, v14
v_mfma_f32_16x16x32_bf16 a[28:31], v[188:191], v[108:111], a[28:31]
v_exp_f32 v199, v15
v_mfma_f32_16x16x32_bf16 a[60:63], v[188:191], v[112:115], a[60:63]
ds_read_b128 v[136:139], v223 offset:64
v_cvt_pk_bf16_f32 v97, v194, v195
v_mfma_f32_16x16x32_bf16 a[92:95], v[188:191], v[116:119], a[92:95]
v_exp_f32 v192, v16
v_mfma_f32_16x16x32_bf16 a[124:127], v[188:191], v[120:123], a[124:127]
v_exp_f32 v193, v17
v_mfma_f32_16x16x32_bf16 v[32:35], v[128:131], a[160:163], v[72:75]
v_exp_f32 v194, v18
v_mfma_f32_16x16x32_bf16 v[40:43], v[128:131], a[176:179], v[76:79]
ds_read_b128 v[140:143], v223 offset:4416
v_cvt_pk_bf16_f32 v98, v196, v197
v_mfma_f32_16x16x32_bf16 v[48:51], v[128:131], a[192:195], v[80:83]
v_exp_f32 v195, v19
v_mfma_f32_16x16x32_bf16 v[56:59], v[128:131], a[208:211], v[84:87]
s_waitcnt vmcnt(8)
s_barrier
s_waitcnt lgkmcnt(1)
v_cvt_pk_bf16_f32 v99, v198, v199
v_mfma_f32_16x16x32_bf16 v[36:39], v[132:135], a[160:163], v[72:75]
s_add_u32 m0, s77, 102400
s_nop 0
buffer_load_dwordx4 v249, s[56:59], s70 offen nt lds
v_cvt_pk_bf16_f32 v100, v192, v193
v_mfma_f32_16x16x32_bf16 v[44:47], v[132:135], a[176:179], v[76:79]
v_exp_f32 v196, v20
v_mfma_f32_16x16x32_bf16 v[52:55], v[132:135], a[192:195], v[80:83]
ds_read_b128 v[128:131], v224
v_cvt_pk_bf16_f32 v101, v194, v195
v_mfma_f32_16x16x32_bf16 v[60:63], v[132:135], a[208:211], v[84:87]
v_exp_f32 v197, v21
v_mfma_f32_16x16x32_bf16 v[144:147], a[240:243], v[92:95], 0
buffer_load_dwordx4 v250, s[56:59], s70 offen offset:1024 nt lds
v_cvt_pk_bf16_f32 v102, v196, v197
v_mfma_f32_16x16x32_bf16 v[32:35], v[136:139], a[164:167], v[32:35]
v_exp_f32 v198, v22
v_mfma_f32_16x16x32_bf16 v[40:43], v[136:139], a[180:183], v[40:43]
ds_read_b128 v[132:135], v224 offset:4352
v_mfma_f32_16x16x32_bf16 v[48:51], v[136:139], a[196:199], v[48:51]
v_exp_f32 v199, v23
v_mfma_f32_16x16x32_bf16 v[56:59], v[136:139], a[212:215], v[56:59]
s_waitcnt lgkmcnt(1)
buffer_load_dwordx4 v249, s[56:59], s70 offen offset:2048 nt lds
v_cvt_pk_bf16_f32 v103, v198, v199
v_mfma_f32_16x16x32_bf16 v[36:39], v[140:143], a[164:167], v[36:39]
v_exp_f32 v192, v24
v_mfma_f32_16x16x32_bf16 v[44:47], v[140:143], a[180:183], v[44:47]
v_exp_f32 v193, v25
v_mfma_f32_16x16x32_bf16 v[52:55], v[140:143], a[196:199], v[52:55]
ds_read_b128 v[136:139], v224 offset:64
v_cvt_pk_bf16_f32 v104, v192, v193
v_mfma_f32_16x16x32_bf16 v[60:63], v[140:143], a[212:215], v[60:63]
buffer_load_dwordx4 v250, s[56:59], s70 offen offset:3072 nt lds
v_mfma_f32_16x16x32_bf16 v[148:151], a[240:243], v[96:99], 0
v_exp_f32 v194, v26
v_mfma_f32_16x16x32_bf16 v[32:35], v[128:131], a[168:171], v[32:35]
v_exp_f32 v195, v27
v_mfma_f32_16x16x32_bf16 v[40:43], v[128:131], a[184:187], v[40:43]
v_exp_f32 v196, v28
v_mfma_f32_16x16x32_bf16 v[48:51], v[128:131], a[200:203], v[48:51]
ds_read_b128 v[140:143], v224 offset:4416
s_add_u32 m0, s77, 118784
s_nop 0
buffer_load_dwordx4 v249, s[56:59], s71 offen nt lds
v_mfma_f32_16x16x32_bf16 v[56:59], v[128:131], a[216:219], v[56:59]
s_waitcnt lgkmcnt(1)
v_exp_f32 v197, v29
v_mfma_f32_16x16x32_bf16 v[36:39], v[132:135], a[168:171], v[36:39]
v_exp_f32 v198, v30
v_mfma_f32_16x16x32_bf16 v[44:47], v[132:135], a[184:187], v[44:47]
ds_read_b64_tr_b16 v[160:161], v225
v_cvt_pk_bf16_f32 v105, v194, v195
v_mfma_f32_16x16x32_bf16 v[52:55], v[132:135], a[200:203], v[52:55]
ds_read_b64_tr_b16 v[162:163], v225 offset:4096
buffer_load_dwordx4 v250, s[56:59], s71 offen offset:1024 nt lds
v_mfma_f32_16x16x32_bf16 v[60:63], v[132:135], a[216:219], v[60:63]
v_exp_f32 v199, v31
v_mfma_f32_16x16x32_bf16 v[152:155], a[240:243], v[100:103], 0
v_cvt_pk_bf16_f32 v106, v196, v197
v_cvt_pk_bf16_f32 v107, v198, v199
v_mfma_f32_16x16x32_bf16 v[32:35], v[136:139], a[172:175], v[32:35]
ds_read_b64_tr_b16 v[164:165], v226
v_mfma_f32_16x16x32_bf16 v[40:43], v[136:139], a[188:191], v[40:43]
ds_read_b64_tr_b16 v[166:167], v226 offset:4096
buffer_load_dwordx4 v249, s[56:59], s71 offen offset:2048 nt lds
v_mfma_f32_16x16x32_bf16 v[48:51], v[136:139], a[204:207], v[48:51]
v_mfma_f32_16x16x32_bf16 v[56:59], v[136:139], a[220:223], v[56:59]
v_mfma_f32_16x16x32_bf16 v[156:159], a[240:243], v[104:107], 0
s_waitcnt lgkmcnt(2)
ds_read_b64_tr_b16 v[168:169], v227
v_mfma_f32_16x16x32_bf16 v[36:39], v[140:143], a[172:175], v[36:39]
ds_read_b64_tr_b16 v[170:171], v227 offset:4096
buffer_load_dwordx4 v250, s[56:59], s71 offen offset:3072 nt lds
v_mfma_f32_16x16x32_bf16 v[44:47], v[140:143], a[188:191], v[44:47]
v_mfma_f32_16x16x32_bf16 v[52:55], v[140:143], a[204:207], v[52:55]
ds_read_b64_tr_b16 v[174:175], v228 offset:4096
v_mfma_f32_16x16x32_bf16 v[60:63], v[140:143], a[220:223], v[60:63]
ds_read_b64_tr_b16 v[172:173], v228
s_add_u32 s70, s70, 16384
s_and_b32 s70, s70, 0x3ffff
s_add_u32 s71, s70, 8192
v_max3_f32 v210, v144, v148, v152
v_max_f32 v210, v210, v156
v_cmp_lt_f32 vcc, s75, v210
s_cbranch_vccnz LB_stub_11
LB_ret_12:
v_add_f32 v205, v205, v144
v_add_f32 v206, v206, v148
v_add_f32 v207, v207, v152
v_add_f32 v208, v208, v156
s_cmp_lg_u32 s72, 2
s_cbranch_scc1 LB_pf_13
s_mov_b32 s8, 0
buffer_load_dwordx4 v[200:203], v237, s[32:35], s8 offen
buffer_load_dwordx4 v[200:203], v237, s[32:35], s8 offen offset:1024
buffer_load_dwordx4 v[200:203], v237, s[32:35], s8 offen offset:2048
buffer_load_dwordx4 v[200:203], v237, s[32:35], s8 offen offset:3072
s_mov_b32 s8, 4096
buffer_load_dwordx4 v[200:203], v237, s[32:35], s8 offen
buffer_load_dwordx4 v[200:203], v237, s[32:35], s8 offen offset:1024
buffer_load_dwordx4 v[200:203], v237, s[32:35], s8 offen offset:2048
buffer_load_dwordx4 v[200:203], v237, s[32:35], s8 offen offset:3072
s_mov_b32 s8, 8192
buffer_load_dwordx4 v[200:203], v237, s[32:35], s8 offen
LB_pf_13:
s_sub_u32 s72, s72, 1
s_cmp_lg_u32 s72, 0
s_cbranch_scc1 LB_loop
v_mfma_f32_16x16x32_bf16 a[0:3], v[160:163], v[92:95], a[0:3]
v_exp_f32 v192, v64
v_mfma_f32_16x16x32_bf16 a[32:35], v[160:163], v[96:99], a[32:35]
v_exp_f32 v193, v65
v_mfma_f32_16x16x32_bf16 a[64:67], v[160:163], v[100:103], a[64:67]
v_exp_f32 v194, v66
v_mfma_f32_16x16x32_bf16 a[96:99], v[160:163], v[104:107], a[96:99]
s_waitcnt lgkmcnt(0)
v_exp_f32 v195, v67
v_mfma_f32_16x16x32_bf16 a[4:7], v[164:167], v[92:95], a[4:7]
ds_read_b64_tr_b16 v[176:177], v225 offset:1024
v_cvt_pk_bf16_f32 v124, v192, v193
v_mfma_f32_16x16x32_bf16 a[36:39], v[164:167], v[96:99], a[36:39]
ds_read_b64_tr_b16 v[178:179], v225 offset:5120
v_cvt_pk_bf16_f32 v125, v194, v195
v_mfma_f32_16x16x32_bf16 a[68:71], v[164:167], v[100:103], a[68:71]
v_exp_f32 v196, v68
v_mfma_f32_16x16x32_bf16 a[100:103], v[164:167], v[104:107], a[100:103]
v_exp_f32 v197, v69
v_mfma_f32_16x16x32_bf16 a[8:11], v[168:171], v[92:95], a[8:11]
ds_read_b64_tr_b16 v[180:181], v226 offset:1024
v_cvt_pk_bf16_f32 v126, v196, v197
v_mfma_f32_16x16x32_bf16 a[40:43], v[168:171], v[96:99], a[40:43]
ds_read_b64_tr_b16 v[182:183], v226 offset:5120
v_mfma_f32_16x16x32_bf16 a[72:75], v[168:171], v[100:103], a[72:75]
v_exp_f32 v198, v70
v_mfma_f32_16x16x32_bf16 a[104:107], v[168:171], v[104:107], a[104:107]
v_exp_f32 v199, v71
v_mfma_f32_16x16x32_bf16 a[12:15], v[172:175], v[92:95], a[12:15]
ds_read_b64_tr_b16 v[184:185], v227 offset:1024
v_cvt_pk_bf16_f32 v127, v198, v199
v_mfma_f32_16x16x32_bf16 a[44:47], v[172:175], v[96:99], a[44:47]
ds_read_b64_tr_b16 v[186:187], v227 offset:5120
v_mfma_f32_16x16x32_bf16 a[76:79], v[172:175], v[100:103], a[76:79]
v_exp_f32 v192, v32
v_mfma_f32_16x16x32_bf16 a[108:111], v[172:175], v[104:107], a[108:111]
s_waitcnt vmcnt(8)
s_barrier
v_mfma_f32_16x16x32_bf16 v[240:243], a[240:243], v[124:127], 0
s_waitcnt lgkmcnt(2)
s_add_u32 m0, s82, 135168
s_mov_b32 s10, 0
buffer_load_dwordx4 v218, s[60:63], s10 offen lds
v_mfma_f32_16x16x32_bf16 a[16:19], v[176:179], v[92:95], a[16:19]
ds_read_b64_tr_b16 v[188:189], v228 offset:1024
v_mfma_f32_16x16x32_bf16 a[48:51], v[176:179], v[96:99], a[48:51]
ds_read_b64_tr_b16 v[190:191], v228 offset:5120
v_mfma_f32_16x16x32_bf16 a[80:83], v[176:179], v[100:103], a[80:83]
v_exp_f32 v193, v33
v_mfma_f32_16x16x32_bf16 a[112:115], v[176:179], v[104:107], a[112:115]
buffer_load_dwordx4 v219, s[60:63], s10 offen offset:1024 lds
v_cvt_pk_bf16_f32 v108, v192, v193
v_mfma_f32_16x16x32_bf16 a[20:23], v[180:183], v[92:95], a[20:23]
v_exp_f32 v194, v34
v_mfma_f32_16x16x32_bf16 a[52:55], v[180:183], v[96:99], a[52:55]
v_cmp_lt_f32 vcc, s75, v240
s_cbranch_vccnz LB_stub_14
LB_ret_15:
v_add_f32 v209, v209, v240
v_mfma_f32_16x16x32_bf16 a[84:87], v[180:183], v[100:103], a[84:87]
v_exp_f32 v195, v35
v_mfma_f32_16x16x32_bf16 a[116:119], v[180:183], v[104:107], a[116:119]
s_waitcnt lgkmcnt(0)
buffer_load_dwordx4 v220, s[60:63], s10 offen offset:2048 lds
v_cvt_pk_bf16_f32 v109, v194, v195
v_mfma_f32_16x16x32_bf16 a[24:27], v[184:187], v[92:95], a[24:27]
v_exp_f32 v196, v36
v_mfma_f32_16x16x32_bf16 a[56:59], v[184:187], v[96:99], a[56:59]
v_exp_f32 v197, v37
v_mfma_f32_16x16x32_bf16 a[88:91], v[184:187], v[100:103], a[88:91]
v_exp_f32 v198, v38
v_mfma_f32_16x16x32_bf16 a[120:123], v[184:187], v[104:107], a[120:123]
s_add_u32 m0, s82, 147456
s_mov_b32 s10, 36864
buffer_load_dwordx4 v218, s[60:63], s10 offen lds
v_cvt_pk_bf16_f32 v110, v196, v197
v_mfma_f32_16x16x32_bf16 a[128:131], v[160:163], v[124:127], a[128:131]
ds_read_b128 v[128:131], v221 offset:34816
v_mfma_f32_16x16x32_bf16 a[28:31], v[188:191], v[92:95], a[28:31]
v_exp_f32 v199, v39
v_mfma_f32_16x16x32_bf16 a[60:63], v[188:191], v[96:99], a[60:63]
v_exp_f32 v192, v40
v_mfma_f32_16x16x32_bf16 a[92:95], v[188:191], v[100:103], a[92:95]
buffer_load_dwordx4 v219, s[60:63], s10 offen offset:1024 lds
v_cvt_pk_bf16_f32 v111, v198, v199
v_mfma_f32_16x16x32_bf16 a[124:127], v[188:191], v[104:107], a[124:127]
v_exp_f32 v193, v41
v_mfma_f32_16x16x32_bf16 a[132:135], v[164:167], v[124:127], a[132:135]
ds_read_b128 v[132:135], v221 offset:39168
v_cvt_pk_bf16_f32 v112, v192, v193
v_mfma_f32_16x16x32_bf16 a[136:139], v[168:171], v[124:127], a[136:139]
v_exp_f32 v194, v42
v_mfma_f32_16x16x32_bf16 a[140:143], v[172:175], v[124:127], a[140:143]
buffer_load_dwordx4 v220, s[60:63], s10 offen offset:2048 lds
v_mfma_f32_16x16x32_bf16 a[144:147], v[176:179], v[124:127], a[144:147]
v_exp_f32 v195, v43
v_mfma_f32_16x16x32_bf16 a[148:151], v[180:183], v[124:127], a[148:151]
v_exp_f32 v196, v44
v_mfma_f32_16x16x32_bf16 a[152:155], v[184:187], v[124:127], a[152:155]
v_exp_f32 v197, v45
v_mfma_f32_16x16x32_bf16 a[156:159], v[188:191], v[124:127], a[156:159]
s_waitcnt lgkmcnt(0)
ds_read_b128 v[136:139], v221 offset:34880
s_add_u32 m0, s82, 0
s_mov_b32 s10, 73728
buffer_load_dwordx4 v218, s[60:63], s10 offen lds
v_mfma_f32_16x16x32_bf16 v[0:3], v[128:131], a[160:163], v[72:75]
v_exp_f32 v198, v46
v_mfma_f32_16x16x32_bf16 v[8:11], v[128:131], a[176:179], v[76:79]
v_exp_f32 v199, v47
v_mfma_f32_16x16x32_bf16 v[16:19], v[128:131], a[192:195], v[80:83]
v_exp_f32 v192, v48
v_mfma_f32_16x16x32_bf16 v[24:27], v[128:131], a[208:211], v[84:87]
buffer_load_dwordx4 v219, s[60:63], s10 offen offset:1024 lds
v_cvt_pk_bf16_f32 v113, v194, v195
v_mfma_f32_16x16x32_bf16 v[64:67], v[128:131], a[224:227], v[88:91]
ds_read_b128 v[140:143], v221 offset:39232
v_cvt_pk_bf16_f32 v114, v196, v197
v_mfma_f32_16x16x32_bf16 v[4:7], v[132:135], a[160:163], v[72:75]
v_exp_f32 v193, v49
v_mfma_f32_16x16x32_bf16 v[12:15], v[132:135], a[176:179], v[76:79]
v_exp_f32 v194, v50
v_mfma_f32_16x16x32_bf16 v[20:23], v[132:135], a[192:195], v[80:83]
buffer_load_dwordx4 v220, s[60:63], s10 offen offset:2048 lds
v_cvt_pk_bf16_f32 v115, v198, v199
v_mfma_f32_16x16x32_bf16 v[28:31], v[132:135], a[208:211], v[84:87]
v_exp_f32 v195, v51
v_mfma_f32_16x16x32_bf16 v[68:71], v[132:135], a[224:227], v[88:91]
v_exp_f32 v196, v52
v_mfma_f32_16x16x32_bf16 v[144:147], a[240:243], v[108:111], 0
s_waitcnt lgkmcnt(0)
ds_read_b128 v[128:131], v222 offset:34816
v_cvt_pk_bf16_f32 v116, v192, v193
v_mfma_f32_16x16x32_bf16 v[0:3], v[136:139], a[164:167], v[0:3]
s_add_u32 m0, s82, 12288
s_mov_b32 s10, 110592
buffer_load_dwordx4 v218, s[60:63], s10 offen lds
v_cvt_pk_bf16_f32 v117, v194, v195
v_mfma_f32_16x16x32_bf16 v[8:11], v[136:139], a[180:183], v[8:11]
v_exp_f32 v197, v53
v_mfma_f32_16x16x32_bf16 v[16:19], v[136:139], a[196:199], v[16:19]
v_exp_f32 v198, v54
v_mfma_f32_16x16x32_bf16 v[24:27], v[136:139], a[212:215], v[24:27]
v_exp_f32 v199, v55
v_mfma_f32_16x16x32_bf16 v[64:67], v[136:139], a[228:231], v[64:67]
ds_read_b128 v[132:135], v222 offset:39168
buffer_load_dwordx4 v219, s[60:63], s10 offen offset:1024 lds
v_mfma_f32_16x16x32_bf16 v[4:7], v[140:143], a[164:167], v[4:7]
v_exp_f32 v192, v56
v_mfma_f32_16x16x32_bf16 v[12:15], v[140:143], a[180:183], v[12:15]
v_exp_f32 v193, v57
v_mfma_f32_16x16x32_bf16 v[20:23], v[140:143], a[196:199], v[20:23]
v_exp_f32 v194, v58
v_mfma_f32_16x16x32_bf16 v[28:31], v[140:143], a[212:215], v[28:31]
buffer_load_dwordx4 v220, s[60:63], s10 offen offset:2048 lds
v_cvt_pk_bf16_f32 v118, v196, v197
v_mfma_f32_16x16x32_bf16 v[68:71], v[140:143], a[228:231], v[68:71]
v_exp_f32 v195, v59
v_mfma_f32_16x16x32_bf16 v[148:151], a[240:243], v[112:115], 0
s_waitcnt lgkmcnt(0)
ds_read_b128 v[136:139], v222 offset:34880
v_cvt_pk_bf16_f32 v119, v198, v199
v_mfma_f32_16x16x32_bf16 v[0:3], v[128:131], a[168:171], v[0:3]
v_exp_f32 v196, v60
v_mfma_f32_16x16x32_bf16 v[8:11], v[128:131], a[184:187], v[8:11]
v_exp_f32 v197, v61
v_mfma_f32_16x16x32_bf16 v[16:19], v[128:131], a[200:203], v[16:19]
v_exp_f32 v198, v62
v_mfma_f32_16x16x32_bf16 v[24:27], v[128:131], a[216:219], v[24:27]
v_exp_f32 v199, v63
v_mfma_f32_16x16x32_bf16 v[64:67], v[128:131], a[232:235], v[64:67]
v_cvt_pk_bf16_f32 v120, v192, v193
v_cvt_pk_bf16_f32 v121, v194, v195
v_mfma_f32_16x16x32_bf16 v[4:7], v[132:135], a[168:171], v[4:7]
ds_read_b128 v[140:143], v222 offset:39232
v_cvt_pk_bf16_f32 v122, v196, v197
v_mfma_f32_16x16x32_bf16 v[12:15], v[132:135], a[184:187], v[12:15]
v_cvt_pk_bf16_f32 v123, v198, v199
v_mfma_f32_16x16x32_bf16 v[20:23], v[132:135], a[200:203], v[20:23]
v_mfma_f32_16x16x32_bf16 v[28:31], v[132:135], a[216:219], v[28:31]
v_mfma_f32_16x16x32_bf16 v[68:71], v[132:135], a[232:235], v[68:71]
ds_read_b64_tr_b16 v[160:161], v229
v_mfma_f32_16x16x32_bf16 v[152:155], a[240:243], v[116:119], 0
s_waitcnt lgkmcnt(2)
ds_read_b64_tr_b16 v[162:163], v229 offset:4096
v_mfma_f32_16x16x32_bf16 v[0:3], v[136:139], a[172:175], v[0:3]
v_mfma_f32_16x16x32_bf16 v[8:11], v[136:139], a[188:191], v[8:11]
v_mfma_f32_16x16x32_bf16 v[16:19], v[136:139], a[204:207], v[16:19]
ds_read_b64_tr_b16 v[164:165], v230
v_mfma_f32_16x16x32_bf16 v[24:27], v[136:139], a[220:223], v[24:27]
ds_read_b64_tr_b16 v[166:167], v230 offset:4096
v_mfma_f32_16x16x32_bf16 v[64:67], v[136:139], a[236:239], v[64:67]
v_mfma_f32_16x16x32_bf16 v[156:159], a[240:243], v[120:123], 0
s_waitcnt lgkmcnt(4)
v_mfma_f32_16x16x32_bf16 v[4:7], v[140:143], a[172:175], v[4:7]
ds_read_b64_tr_b16 v[168:169], v231
v_mfma_f32_16x16x32_bf16 v[12:15], v[140:143], a[188:191], v[12:15]
ds_read_b64_tr_b16 v[170:171], v231 offset:4096
v_mfma_f32_16x16x32_bf16 v[20:23], v[140:143], a[204:207], v[20:23]
v_mfma_f32_16x16x32_bf16 v[28:31], v[140:143], a[220:223], v[28:31]
ds_read_b64_tr_b16 v[174:175], v232 offset:4096
v_mfma_f32_16x16x32_bf16 v[68:71], v[140:143], a[236:239], v[68:71]
ds_read_b64_tr_b16 v[172:173], v232
v_max3_f32 v210, v144, v148, v152
v_max_f32 v210, v210, v156
v_cmp_lt_f32 vcc, s75, v210
s_cbranch_vccnz LB_stub_16
LB_ret_17:
s_waitcnt lgkmcnt(2)
v_add_f32 v205, v205, v144
v_add_f32 v206, v206, v148
v_add_f32 v207, v207, v152
v_add_f32 v208, v208, v156
v_mfma_f32_16x16x32_bf16 a[0:3], v[160:163], v[108:111], a[0:3]
v_mfma_f32_16x16x32_bf16 a[32:35], v[160:163], v[112:115], a[32:35]
v_mfma_f32_16x16x32_bf16 a[64:67], v[160:163], v[116:119], a[64:67]
v_mfma_f32_16x16x32_bf16 a[96:99], v[160:163], v[120:123], a[96:99]
ds_read_b64_tr_b16 v[176:177], v229 offset:1024
v_mfma_f32_16x16x32_bf16 a[4:7], v[164:167], v[108:111], a[4:7]
ds_read_b64_tr_b16 v[178:179], v229 offset:5120
v_mfma_f32_16x16x32_bf16 a[36:39], v[164:167], v[112:115], a[36:39]
v_exp_f32 v192, v0
v_mfma_f32_16x16x32_bf16 a[68:71], v[164:167], v[116:119], a[68:71]
v_exp_f32 v193, v1
v_mfma_f32_16x16x32_bf16 a[100:103], v[164:167], v[120:123], a[100:103]
ds_read_b64_tr_b16 v[180:181], v230 offset:1024
v_cvt_pk_bf16_f32 v92, v192, v193
v_mfma_f32_16x16x32_bf16 a[8:11], v[168:171], v[108:111], a[8:11]
ds_read_b64_tr_b16 v[182:183], v230 offset:5120
v_mfma_f32_16x16x32_bf16 a[40:43], v[168:171], v[112:115], a[40:43]
v_exp_f32 v194, v2
v_mfma_f32_16x16x32_bf16 a[72:75], v[168:171], v[116:119], a[72:75]
v_exp_f32 v195, v3
v_mfma_f32_16x16x32_bf16 a[104:107], v[168:171], v[120:123], a[104:107]
s_waitcnt lgkmcnt(2)
ds_read_b64_tr_b16 v[184:185], v231 offset:1024
v_cvt_pk_bf16_f32 v93, v194, v195
v_mfma_f32_16x16x32_bf16 a[12:15], v[172:175], v[108:111], a[12:15]
ds_read_b64_tr_b16 v[186:187], v231 offset:5120
v_mfma_f32_16x16x32_bf16 a[44:47], v[172:175], v[112:115], a[44:47]
v_exp_f32 v196, v4
v_mfma_f32_16x16x32_bf16 a[76:79], v[172:175], v[116:119], a[76:79]
v_exp_f32 v197, v5
v_mfma_f32_16x16x32_bf16 a[108:111], v[172:175], v[120:123], a[108:111]
ds_read_b64_tr_b16 v[188:189], v232 offset:1024
v_cvt_pk_bf16_f32 v94, v196, v197
v_mfma_f32_16x16x32_bf16 a[16:19], v[176:179], v[108:111], a[16:19]
ds_read_b64_tr_b16 v[190:191], v232 offset:5120
v_mfma_f32_16x16x32_bf16 a[48:51], v[176:179], v[112:115], a[48:51]
v_exp_f32 v198, v6
v_mfma_f32_16x16x32_bf16 a[80:83], v[176:179], v[116:119], a[80:83]
v_exp_f32 v199, v7
v_mfma_f32_16x16x32_bf16 a[112:115], v[176:179], v[120:123], a[112:115]
s_waitcnt lgkmcnt(2)
v_exp_f32 v192, v8
v_mfma_f32_16x16x32_bf16 a[20:23], v[180:183], v[108:111], a[20:23]
ds_read_b128 v[128:131], v223 offset:34816
v_cvt_pk_bf16_f32 v95, v198, v199
v_mfma_f32_16x16x32_bf16 a[52:55], v[180:183], v[112:115], a[52:55]
v_exp_f32 v193, v9
v_mfma_f32_16x16x32_bf16 a[84:87], v[180:183], v[116:119], a[84:87]
v_exp_f32 v194, v10
v_mfma_f32_16x16x32_bf16 a[116:119], v[180:183], v[120:123], a[116:119]
v_exp_f32 v195, v11
v_mfma_f32_16x16x32_bf16 a[24:27], v[184:187], v[108:111], a[24:27]
ds_read_b128 v[132:135], v223 offset:39168
v_cvt_pk_bf16_f32 v96, v192, v193
v_mfma_f32_16x16x32_bf16 a[56:59], v[184:187], v[112:115], a[56:59]
v_exp_f32 v196, v12
v_mfma_f32_16x16x32_bf16 a[88:91], v[184:187], v[116:119], a[88:91]
v_exp_f32 v197, v13
v_mfma_f32_16x16x32_bf16 a[120:123], v[184:187], v[120:123], a[120:123]
s_waitcnt lgkmcnt(1)
v_exp_f32 v198, v14
v_mfma_f32_16x16x32_bf16 a[28:31], v[188:191], v[108:111], a[28:31]
v_exp_f32 v199, v15
v_mfma_f32_16x16x32_bf16 a[60:63], v[188:191], v[112:115], a[60:63]
ds_read_b128 v[136:139], v223 offset:34880
v_cvt_pk_bf16_f32 v97, v194, v195
v_mfma_f32_16x16x32_bf16 a[92:95], v[188:191], v[116:119], a[92:95]
v_exp_f32 v192, v16
v_mfma_f32_16x16x32_bf16 a[124:127], v[188:191], v[120:123], a[124:127]
v_exp_f32 v193, v17
v_mfma_f32_16x16x32_bf16 v[32:35], v[128:131], a[160:163], v[72:75]
v_exp_f32 v194, v18
v_mfma_f32_16x16x32_bf16 v[40:43], v[128:131], a[176:179], v[76:79]
ds_read_b128 v[140:143], v223 offset:39232
v_cvt_pk_bf16_f32 v98, v196, v197
v_mfma_f32_16x16x32_bf16 v[48:51], v[128:131], a[192:195], v[80:83]
v_exp_f32 v195, v19
v_mfma_f32_16x16x32_bf16 v[56:59], v[128:131], a[208:211], v[84:87]
s_waitcnt vmcnt(12)
s_barrier
s_waitcnt lgkmcnt(1)
v_cvt_pk_bf16_f32 v99, v198, v199
v_mfma_f32_16x16x32_bf16 v[36:39], v[132:135], a[160:163], v[72:75]
v_exp_f32 v196, v20
v_mfma_f32_16x16x32_bf16 v[44:47], v[132:135], a[176:179], v[76:79]
v_exp_f32 v197, v21
v_mfma_f32_16x16x32_bf16 v[52:55], v[132:135], a[192:195], v[80:83]
ds_read_b128 v[128:131], v224 offset:34816
v_cvt_pk_bf16_f32 v100, v192, v193
v_mfma_f32_16x16x32_bf16 v[60:63], v[132:135], a[208:211], v[84:87]
v_exp_f32 v198, v22
v_mfma_f32_16x16x32_bf16 v[144:147], a[240:243], v[92:95], 0
v_exp_f32 v199, v23
v_mfma_f32_16x16x32_bf16 v[32:35], v[136:139], a[164:167], v[32:35]
v_exp_f32 v192, v24
v_mfma_f32_16x16x32_bf16 v[40:43], v[136:139], a[180:183], v[40:43]
ds_read_b128 v[132:135], v224 offset:39168
v_cvt_pk_bf16_f32 v101, v194, v195
v_mfma_f32_16x16x32_bf16 v[48:51], v[136:139], a[196:199], v[48:51]
v_exp_f32 v193, v25
v_mfma_f32_16x16x32_bf16 v[56:59], v[136:139], a[212:215], v[56:59]
s_waitcnt lgkmcnt(1)
v_exp_f32 v194, v26
v_mfma_f32_16x16x32_bf16 v[36:39], v[140:143], a[164:167], v[36:39]
v_exp_f32 v195, v27
v_mfma_f32_16x16x32_bf16 v[44:47], v[140:143], a[180:183], v[44:47]
v_cvt_pk_bf16_f32 v102, v196, v197
v_cvt_pk_bf16_f32 v103, v198, v199
v_mfma_f32_16x16x32_bf16 v[52:55], v[140:143], a[196:199], v[52:55]
ds_read_b128 v[136:139], v224 offset:34880
v_cvt_pk_bf16_f32 v104, v192, v193
v_mfma_f32_16x16x32_bf16 v[60:63], v[140:143], a[212:215], v[60:63]
v_exp_f32 v196, v28
v_mfma_f32_16x16x32_bf16 v[148:151], a[240:243], v[96:99], 0
v_exp_f32 v197, v29
v_mfma_f32_16x16x32_bf16 v[32:35], v[128:131], a[168:171], v[32:35]
v_exp_f32 v198, v30
v_mfma_f32_16x16x32_bf16 v[40:43], v[128:131], a[184:187], v[40:43]
v_exp_f32 v199, v31
v_mfma_f32_16x16x32_bf16 v[48:51], v[128:131], a[200:203], v[48:51]
ds_read_b128 v[140:143], v224 offset:39232
v_cvt_pk_bf16_f32 v105, v194, v195
v_mfma_f32_16x16x32_bf16 v[56:59], v[128:131], a[216:219], v[56:59]
s_waitcnt lgkmcnt(1)
v_cvt_pk_bf16_f32 v106, v196, v197
v_cvt_pk_bf16_f32 v107, v198, v199
v_mfma_f32_16x16x32_bf16 v[36:39], v[132:135], a[168:171], v[36:39]
v_mfma_f32_16x16x32_bf16 v[44:47], v[132:135], a[184:187], v[44:47]
ds_read_b64_tr_b16 v[160:161], v225 offset:32768
v_mfma_f32_16x16x32_bf16 v[52:55], v[132:135], a[200:203], v[52:55]
ds_read_b64_tr_b16 v[162:163], v225 offset:36864
v_mfma_f32_16x16x32_bf16 v[60:63], v[132:135], a[216:219], v[60:63]
v_mfma_f32_16x16x32_bf16 v[152:155], a[240:243], v[100:103], 0
v_mfma_f32_16x16x32_bf16 v[32:35], v[136:139], a[172:175], v[32:35]
ds_read_b64_tr_b16 v[164:165], v226 offset:32768
v_mfma_f32_16x16x32_bf16 v[40:43], v[136:139], a[188:191], v[40:43]
ds_read_b64_tr_b16 v[166:167], v226 offset:36864
v_mfma_f32_16x16x32_bf16 v[48:51], v[136:139], a[204:207], v[48:51]
v_mfma_f32_16x16x32_bf16 v[56:59], v[136:139], a[220:223], v[56:59]
v_mfma_f32_16x16x32_bf16 v[156:159], a[240:243], v[104:107], 0
s_waitcnt lgkmcnt(4)
ds_read_b64_tr_b16 v[168:169], v227 offset:32768
v_mfma_f32_16x16x32_bf16 v[36:39], v[140:143], a[172:175], v[36:39]
ds_read_b64_tr_b16 v[170:171], v227 offset:36864
v_mfma_f32_16x16x32_bf16 v[44:47], v[140:143], a[188:191], v[44:47]
v_mfma_f32_16x16x32_bf16 v[52:55], v[140:143], a[204:207], v[52:55]
ds_read_b64_tr_b16 v[174:175], v228 offset:36864
v_mfma_f32_16x16x32_bf16 v[60:63], v[140:143], a[220:223], v[60:63]
ds_read_b64_tr_b16 v[172:173], v228 offset:32768
v_max3_f32 v210, v144, v148, v152
v_max_f32 v210, v210, v156
v_cmp_lt_f32 vcc, s75, v210
s_cbranch_vccnz LB_stub_18
LB_ret_19:
s_waitcnt lgkmcnt(2)
v_add_f32 v205, v205, v144
v_add_f32 v206, v206, v148
v_add_f32 v207, v207, v152
v_add_f32 v208, v208, v156
v_mfma_f32_16x16x32_bf16 a[0:3], v[160:163], v[92:95], a[0:3]
v_exp_f32 v192, v64
v_mfma_f32_16x16x32_bf16 a[32:35], v[160:163], v[96:99], a[32:35]
v_exp_f32 v193, v65
v_mfma_f32_16x16x32_bf16 a[64:67], v[160:163], v[100:103], a[64:67]
v_exp_f32 v194, v66
v_mfma_f32_16x16x32_bf16 a[96:99], v[160:163], v[104:107], a[96:99]
v_exp_f32 v195, v67
v_mfma_f32_16x16x32_bf16 a[4:7], v[164:167], v[92:95], a[4:7]
ds_read_b64_tr_b16 v[176:177], v225 offset:33792
v_cvt_pk_bf16_f32 v124, v192, v193
v_mfma_f32_16x16x32_bf16 a[36:39], v[164:167], v[96:99], a[36:39]
ds_read_b64_tr_b16 v[178:179], v225 offset:37888
v_cvt_pk_bf16_f32 v125, v194, v195
v_mfma_f32_16x16x32_bf16 a[68:71], v[164:167], v[100:103], a[68:71]
v_exp_f32 v196, v68
v_mfma_f32_16x16x32_bf16 a[100:103], v[164:167], v[104:107], a[100:103]
v_exp_f32 v197, v69
v_mfma_f32_16x16x32_bf16 a[8:11], v[168:171], v[92:95], a[8:11]
ds_read_b64_tr_b16 v[180:181], v226 offset:33792
v_cvt_pk_bf16_f32 v126, v196, v197
v_mfma_f32_16x16x32_bf16 a[40:43], v[168:171], v[96:99], a[40:43]
ds_read_b64_tr_b16 v[182:183], v226 offset:37888
v_mfma_f32_16x16x32_bf16 a[72:75], v[168:171], v[100:103], a[72:75]
v_exp_f32 v198, v70
v_mfma_f32_16x16x32_bf16 a[104:107], v[168:171], v[104:107], a[104:107]
s_waitcnt lgkmcnt(2)
v_exp_f32 v199, v71
v_mfma_f32_16x16x32_bf16 a[12:15], v[172:175], v[92:95], a[12:15]
ds_read_b64_tr_b16 v[184:185], v227 offset:33792
v_cvt_pk_bf16_f32 v127, v198, v199
v_mfma_f32_16x16x32_bf16 a[44:47], v[172:175], v[96:99], a[44:47]
ds_read_b64_tr_b16 v[186:187], v227 offset:37888
v_exp_f32 v192, v32
v_mfma_f32_16x16x32_bf16 a[76:79], v[172:175], v[100:103], a[76:79]
v_exp_f32 v193, v33
v_mfma_f32_16x16x32_bf16 a[108:111], v[172:175], v[104:107], a[108:111]
s_barrier
v_exp_f32 v194, v34
v_cvt_pk_bf16_f32 v108, v192, v193
v_mfma_f32_16x16x32_bf16 v[240:243], a[240:243], v[124:127], 0
s_add_u32 m0, s82, 24576
s_mov_b32 s10, 147456
buffer_load_dwordx4 v218, s[60:63], s10 offen lds
v_exp_f32 v195, v35
v_mfma_f32_16x16x32_bf16 a[16:19], v[176:179], v[92:95], a[16:19]
ds_read_b64_tr_b16 v[188:189], v228 offset:33792
v_exp_f32 v196, v36
v_mfma_f32_16x16x32_bf16 a[48:51], v[176:179], v[96:99], a[48:51]
ds_read_b64_tr_b16 v[190:191], v228 offset:37888
v_exp_f32 v197, v37
v_mfma_f32_16x16x32_bf16 a[80:83], v[176:179], v[100:103], a[80:83]
v_exp_f32 v198, v38
v_exp_f32 v199, v39
v_mfma_f32_16x16x32_bf16 a[112:115], v[176:179], v[104:107], a[112:115]
s_waitcnt lgkmcnt(2)
buffer_load_dwordx4 v219, s[60:63], s10 offen offset:1024 lds
v_exp_f32 v192, v40
v_mfma_f32_16x16x32_bf16 a[20:23], v[180:183], v[92:95], a[20:23]
v_exp_f32 v193, v41
v_cvt_pk_bf16_f32 v109, v194, v195
v_mfma_f32_16x16x32_bf16 a[52:55], v[180:183], v[96:99], a[52:55]
v_cmp_lt_f32 vcc, s75, v240
s_cbranch_vccnz LB_stub_20
LB_ret_21:
v_add_f32 v209, v209, v240
v_mfma_f32_16x16x32_bf16 a[84:87], v[180:183], v[100:103], a[84:87]
v_exp_f32 v194, v42
v_cvt_pk_bf16_f32 v110, v196, v197
v_mfma_f32_16x16x32_bf16 a[116:119], v[180:183], v[104:107], a[116:119]
buffer_load_dwordx4 v220, s[60:63], s10 offen offset:2048 lds
v_exp_f32 v195, v43
v_cvt_pk_bf16_f32 v111, v198, v199
v_mfma_f32_16x16x32_bf16 a[24:27], v[184:187], v[92:95], a[24:27]
v_exp_f32 v196, v44
v_cvt_pk_bf16_f32 v112, v192, v193
v_mfma_f32_16x16x32_bf16 a[56:59], v[184:187], v[96:99], a[56:59]
v_exp_f32 v197, v45
v_cvt_pk_bf16_f32 v113, v194, v195
v_mfma_f32_16x16x32_bf16 a[88:91], v[184:187], v[100:103], a[88:91]
v_exp_f32 v198, v46
v_cvt_pk_bf16_f32 v114, v196, v197
v_mfma_f32_16x16x32_bf16 a[120:123], v[184:187], v[104:107], a[120:123]
v_exp_f32 v199, v47
v_exp_f32 v192, v48
v_mfma_f32_16x16x32_bf16 a[128:131], v[160:163], v[124:127], a[128:131]
s_waitcnt lgkmcnt(0)
v_exp_f32 v193, v49
v_cvt_pk_bf16_f32 v115, v198, v199
v_mfma_f32_16x16x32_bf16 a[28:31], v[188:191], v[92:95], a[28:31]
v_exp_f32 v194, v50
v_cvt_pk_bf16_f32 v116, v192, v193
v_mfma_f32_16x16x32_bf16 a[60:63], v[188:191], v[96:99], a[60:63]
v_exp_f32 v195, v51
v_mfma_f32_16x16x32_bf16 a[92:95], v[188:191], v[100:103], a[92:95]
ds_read_b64_tr_b16 v[160:161], v229 offset:32768
v_exp_f32 v196, v52
v_cvt_pk_bf16_f32 v117, v194, v195
v_mfma_f32_16x16x32_bf16 a[124:127], v[188:191], v[104:107], a[124:127]
ds_read_b64_tr_b16 v[162:163], v229 offset:36864
v_exp_f32 v197, v53
v_mfma_f32_16x16x32_bf16 a[132:135], v[164:167], v[124:127], a[132:135]
v_exp_f32 v198, v54
v_cvt_pk_bf16_f32 v118, v196, v197
v_mfma_f32_16x16x32_bf16 a[136:139], v[168:171], v[124:127], a[136:139]
v_exp_f32 v199, v55
v_mfma_f32_16x16x32_bf16 a[140:143], v[172:175], v[124:127], a[140:143]
ds_read_b64_tr_b16 v[164:165], v230 offset:32768
v_exp_f32 v192, v56
v_cvt_pk_bf16_f32 v119, v198, v199
v_mfma_f32_16x16x32_bf16 a[144:147], v[176:179], v[124:127], a[144:147]
ds_read_b64_tr_b16 v[166:167], v230 offset:36864
v_exp_f32 v193, v57
v_mfma_f32_16x16x32_bf16 a[148:151], v[180:183], v[124:127], a[148:151]
v_exp_f32 v194, v58
v_cvt_pk_bf16_f32 v120, v192, v193
v_mfma_f32_16x16x32_bf16 a[152:155], v[184:187], v[124:127], a[152:155]
v_exp_f32 v195, v59
v_mfma_f32_16x16x32_bf16 a[156:159], v[188:191], v[124:127], a[156:159]
ds_read_b64_tr_b16 v[168:169], v231 offset:32768
v_exp_f32 v196, v60
v_cvt_pk_bf16_f32 v121, v194, v195
v_mfma_f32_16x16x32_bf16 v[144:147], a[240:243], v[108:111], 0
ds_read_b64_tr_b16 v[170:171], v231 offset:36864
v_exp_f32 v197, v61
v_mfma_f32_16x16x32_bf16 v[148:151], a[240:243], v[112:115], 0
v_exp_f32 v198, v62
v_cvt_pk_bf16_f32 v122, v196, v197
v_exp_f32 v199, v63
s_nop 0
v_cvt_pk_bf16_f32 v123, v198, v199
v_mfma_f32_16x16x32_bf16 v[152:155], a[240:243], v[116:119], 0
ds_read_b64_tr_b16 v[174:175], v232 offset:36864
v_mfma_f32_16x16x32_bf16 v[156:159], a[240:243], v[120:123], 0
ds_read_b64_tr_b16 v[172:173], v232 offset:32768
s_nop 4
v_max3_f32 v210, v144, v148, v152
s_nop 0
v_max_f32 v210, v210, v156
v_cmp_lt_f32 vcc, s75, v210
s_cbranch_vccnz LB_stub_22
LB_ret_23:
s_waitcnt lgkmcnt(2)
v_add_f32 v205, v205, v144
v_add_f32 v206, v206, v148
v_add_f32 v207, v207, v152
v_add_f32 v208, v208, v156
v_mfma_f32_16x16x32_bf16 a[0:3], v[160:163], v[108:111], a[0:3]
v_mfma_f32_16x16x32_bf16 a[32:35], v[160:163], v[112:115], a[32:35]
v_mfma_f32_16x16x32_bf16 a[64:67], v[160:163], v[116:119], a[64:67]
v_mfma_f32_16x16x32_bf16 a[96:99], v[160:163], v[120:123], a[96:99]
ds_read_b64_tr_b16 v[176:177], v229 offset:33792
v_mfma_f32_16x16x32_bf16 a[4:7], v[164:167], v[108:111], a[4:7]
ds_read_b64_tr_b16 v[178:179], v229 offset:37888
v_mfma_f32_16x16x32_bf16 a[36:39], v[164:167], v[112:115], a[36:39]
v_mfma_f32_16x16x32_bf16 a[68:71], v[164:167], v[116:119], a[68:71]
v_mfma_f32_16x16x32_bf16 a[100:103], v[164:167], v[120:123], a[100:103]
ds_read_b64_tr_b16 v[180:181], v230 offset:33792
v_mfma_f32_16x16x32_bf16 a[8:11], v[168:171], v[108:111], a[8:11]
ds_read_b64_tr_b16 v[182:183], v230 offset:37888
v_mfma_f32_16x16x32_bf16 a[40:43], v[168:171], v[112:115], a[40:43]
v_mfma_f32_16x16x32_bf16 a[72:75], v[168:171], v[116:119], a[72:75]
v_mfma_f32_16x16x32_bf16 a[104:107], v[168:171], v[120:123], a[104:107]
s_waitcnt lgkmcnt(4)
ds_read_b64_tr_b16 v[184:185], v231 offset:33792
v_mfma_f32_16x16x32_bf16 a[12:15], v[172:175], v[108:111], a[12:15]
ds_read_b64_tr_b16 v[186:187], v231 offset:37888
v_mfma_f32_16x16x32_bf16 a[44:47], v[172:175], v[112:115], a[44:47]
v_mfma_f32_16x16x32_bf16 a[76:79], v[172:175], v[116:119], a[76:79]
v_mfma_f32_16x16x32_bf16 a[108:111], v[172:175], v[120:123], a[108:111]
s_waitcnt lgkmcnt(4)
ds_read_b64_tr_b16 v[188:189], v232 offset:33792
v_mfma_f32_16x16x32_bf16 a[16:19], v[176:179], v[108:111], a[16:19]
ds_read_b64_tr_b16 v[190:191], v232 offset:37888
v_mfma_f32_16x16x32_bf16 a[48:51], v[176:179], v[112:115], a[48:51]
v_mfma_f32_16x16x32_bf16 a[80:83], v[176:179], v[116:119], a[80:83]
v_mfma_f32_16x16x32_bf16 a[112:115], v[176:179], v[120:123], a[112:115]
s_waitcnt lgkmcnt(4)
v_mfma_f32_16x16x32_bf16 a[20:23], v[180:183], v[108:111], a[20:23]
v_mfma_f32_16x16x32_bf16 a[52:55], v[180:183], v[112:115], a[52:55]
v_mfma_f32_16x16x32_bf16 a[84:87], v[180:183], v[116:119], a[84:87]
v_mfma_f32_16x16x32_bf16 a[116:119], v[180:183], v[120:123], a[116:119]
s_waitcnt lgkmcnt(2)
v_mfma_f32_16x16x32_bf16 a[24:27], v[184:187], v[108:111], a[24:27]
v_mfma_f32_16x16x32_bf16 a[56:59], v[184:187], v[112:115], a[56:59]
v_mfma_f32_16x16x32_bf16 a[88:91], v[184:187], v[116:119], a[88:91]
v_mfma_f32_16x16x32_bf16 a[120:123], v[184:187], v[120:123], a[120:123]
s_waitcnt lgkmcnt(0)
v_mfma_f32_16x16x32_bf16 a[28:31], v[188:191], v[108:111], a[28:31]
v_mfma_f32_16x16x32_bf16 a[60:63], v[188:191], v[112:115], a[60:63]
v_mfma_f32_16x16x32_bf16 a[92:95], v[188:191], v[116:119], a[92:95]
v_mfma_f32_16x16x32_bf16 a[124:127], v[188:191], v[120:123], a[124:127]
LB_oproj:
v_rcp_f32 v128, v205
v_rcp_f32 v129, v205
v_rcp_f32 v130, v206
v_rcp_f32 v131, v206
v_rcp_f32 v132, v207
v_rcp_f32 v133, v207
v_rcp_f32 v134, v208
v_rcp_f32 v135, v208
v_lshlrev_b32 v237, 4, v251
s_lshl_b32 s8, s3, 14
s_add_u32 s8, s8, 69632
v_add_u32 v238, s8, v237
s_lshl_b32 s8, s3, 12
s_add_u32 s8, s8, 36864
v_add_u32 v239, s8, v237
s_xor_b32 s9, s3, 1
s_lshl_b32 s8, s9, 12
s_add_u32 s8, s8, 36864
v_add_u32 v240, s8, v237
v_lshlrev_b32 v252, 3, v251
s_lshl_b32 s8, s3, 9
s_add_u32 s8, s8, 53248
v_add_u32 v241, s8, v252
s_lshl_b32 s8, s9, 9
s_add_u32 s8, s8, 53248
v_add_u32 v242, s8, v252
s_lshl_b32 s8, s3, 11
s_add_u32 s8, s8, 61440
v_add_u32 v243, s8, v237
s_waitcnt lgkmcnt(0)
s_barrier
v_accvgpr_read_b32 v0, a128
v_accvgpr_read_b32 v1, a129
v_accvgpr_read_b32 v2, a130
v_accvgpr_read_b32 v3, a131
v_accvgpr_read_b32 v4, a132
v_accvgpr_read_b32 v5, a133
v_accvgpr_read_b32 v6, a134
v_accvgpr_read_b32 v7, a135
v_accvgpr_read_b32 v8, a136
v_accvgpr_read_b32 v9, a137
v_accvgpr_read_b32 v10, a138
v_accvgpr_read_b32 v11, a139
v_accvgpr_read_b32 v12, a140
v_accvgpr_read_b32 v13, a141
v_accvgpr_read_b32 v14, a142
v_accvgpr_read_b32 v15, a143
v_accvgpr_read_b32 v16, a144
v_accvgpr_read_b32 v17, a145
v_accvgpr_read_b32 v18, a146
v_accvgpr_read_b32 v19, a147
v_accvgpr_read_b32 v20, a148
v_accvgpr_read_b32 v21, a149
v_accvgpr_read_b32 v22, a150
v_accvgpr_read_b32 v23, a151
v_accvgpr_read_b32 v24, a152
v_accvgpr_read_b32 v25, a153
v_accvgpr_read_b32 v26, a154
v_accvgpr_read_b32 v27, a155
v_accvgpr_read_b32 v28, a156
v_accvgpr_read_b32 v29, a157
v_accvgpr_read_b32 v30, a158
v_accvgpr_read_b32 v31, a159
s_cmp_eq_u32 s5, 1
s_cbranch_scc1 LB_j1_24
ds_write_b128 v239, v[16:19]
ds_write_b128 v239, v[20:23] offset:1024
ds_write_b128 v239, v[24:27] offset:2048
ds_write_b128 v239, v[28:31] offset:3072
v_mov_b32 v160, v0
v_mov_b32 v161, v1
v_mov_b32 v162, v2
v_mov_b32 v163, v3
v_mov_b32 v164, v4
v_mov_b32 v165, v5
v_mov_b32 v166, v6
v_mov_b32 v167, v7
v_mov_b32 v168, v8
v_mov_b32 v169, v9
v_mov_b32 v170, v10
v_mov_b32 v171, v11
v_mov_b32 v172, v12
v_mov_b32 v173, v13
v_mov_b32 v174, v14
v_mov_b32 v175, v15
s_branch LB_jd_25
LB_j1_24:
ds_write_b128 v239, v[0:3]
ds_write_b128 v239, v[4:7] offset:1024
ds_write_b128 v239, v[8:11] offset:2048
ds_write_b128 v239, v[12:15] offset:3072
v_mov_b32 v160, v16
v_mov_b32 v161, v17
v_mov_b32 v162, v18
v_mov_b32 v163, v19
v_mov_b32 v164, v20
v_mov_b32 v165, v21
v_mov_b32 v166, v22
v_mov_b32 v167, v23
v_mov_b32 v168, v24
v_mov_b32 v169, v25
v_mov_b32 v170, v26
v_mov_b32 v171, v27
v_mov_b32 v172, v28
v_mov_b32 v173, v29
v_mov_b32 v174, v30
v_mov_b32 v175, v31
LB_jd_25:
v_mov_b32 v176, v88
v_mov_b32 v177, v209
ds_write_b64 v241, v[176:177]
v_mov_b32 v183, v88
v_accvgpr_read_b32 v32, a0
v_accvgpr_read_b32 v33, a1
v_accvgpr_read_b32 v34, a2
v_accvgpr_read_b32 v35, a3
v_accvgpr_read_b32 v36, a4
v_accvgpr_read_b32 v37, a5
v_accvgpr_read_b32 v38, a6
v_accvgpr_read_b32 v39, a7
v_accvgpr_read_b32 v40, a8
v_accvgpr_read_b32 v41, a9
v_accvgpr_read_b32 v42, a10
v_accvgpr_read_b32 v43, a11
v_accvgpr_read_b32 v44, a12
v_accvgpr_read_b32 v45, a13
v_accvgpr_read_b32 v46, a14
v_accvgpr_read_b32 v47, a15
v_pk_mul_f32 v[32:33], v[32:33], v[128:129]
v_pk_mul_f32 v[34:35], v[34:35], v[128:129]
v_pk_mul_f32 v[36:37], v[36:37], v[128:129]
v_pk_mul_f32 v[38:39], v[38:39], v[128:129]
v_pk_mul_f32 v[40:41], v[40:41], v[128:129]
v_pk_mul_f32 v[42:43], v[42:43], v[128:129]
v_pk_mul_f32 v[44:45], v[44:45], v[128:129]
v_pk_mul_f32 v[46:47], v[46:47], v[128:129]
v_cvt_pk_bf16_f32 v64, v32, v33
v_cvt_pk_bf16_f32 v65, v34, v35
v_cvt_pk_bf16_f32 v66, v36, v37
v_cvt_pk_bf16_f32 v67, v38, v39
v_cvt_pk_bf16_f32 v68, v40, v41
v_cvt_pk_bf16_f32 v69, v42, v43
v_cvt_pk_bf16_f32 v70, v44, v45
v_cvt_pk_bf16_f32 v71, v46, v47
ds_write_b128 v238, v[64:67]
ds_write_b128 v238, v[68:71] offset:1024
v_accvgpr_read_b32 v48, a16
v_accvgpr_read_b32 v49, a17
v_accvgpr_read_b32 v50, a18
v_accvgpr_read_b32 v51, a19
v_accvgpr_read_b32 v52, a20
v_accvgpr_read_b32 v53, a21
v_accvgpr_read_b32 v54, a22
v_accvgpr_read_b32 v55, a23
v_accvgpr_read_b32 v56, a24
v_accvgpr_read_b32 v57, a25
v_accvgpr_read_b32 v58, a26
v_accvgpr_read_b32 v59, a27
v_accvgpr_read_b32 v60, a28
v_accvgpr_read_b32 v61, a29
v_accvgpr_read_b32 v62, a30
v_accvgpr_read_b32 v63, a31
v_pk_mul_f32 v[48:49], v[48:49], v[128:129]
v_pk_mul_f32 v[50:51], v[50:51], v[128:129]
v_pk_mul_f32 v[52:53], v[52:53], v[128:129]
v_pk_mul_f32 v[54:55], v[54:55], v[128:129]
v_pk_mul_f32 v[56:57], v[56:57], v[128:129]
v_pk_mul_f32 v[58:59], v[58:59], v[128:129]
v_pk_mul_f32 v[60:61], v[60:61], v[128:129]
v_pk_mul_f32 v[62:63], v[62:63], v[128:129]
v_cvt_pk_bf16_f32 v72, v48, v49
v_cvt_pk_bf16_f32 v73, v50, v51
v_cvt_pk_bf16_f32 v74, v52, v53
v_cvt_pk_bf16_f32 v75, v54, v55
v_cvt_pk_bf16_f32 v76, v56, v57
v_cvt_pk_bf16_f32 v77, v58, v59
v_cvt_pk_bf16_f32 v78, v60, v61
v_cvt_pk_bf16_f32 v79, v62, v63
ds_write_b128 v238, v[72:75] offset:2048
ds_write_b128 v238, v[76:79] offset:3072
v_accvgpr_read_b32 v32, a32
v_accvgpr_read_b32 v33, a33
v_accvgpr_read_b32 v34, a34
v_accvgpr_read_b32 v35, a35
v_accvgpr_read_b32 v36, a36
v_accvgpr_read_b32 v37, a37
v_accvgpr_read_b32 v38, a38
v_accvgpr_read_b32 v39, a39
v_accvgpr_read_b32 v40, a40
v_accvgpr_read_b32 v41, a41
v_accvgpr_read_b32 v42, a42
v_accvgpr_read_b32 v43, a43
v_accvgpr_read_b32 v44, a44
v_accvgpr_read_b32 v45, a45
v_accvgpr_read_b32 v46, a46
v_accvgpr_read_b32 v47, a47
v_pk_mul_f32 v[32:33], v[32:33], v[130:131]
v_pk_mul_f32 v[34:35], v[34:35], v[130:131]
v_pk_mul_f32 v[36:37], v[36:37], v[130:131]
v_pk_mul_f32 v[38:39], v[38:39], v[130:131]
v_pk_mul_f32 v[40:41], v[40:41], v[130:131]
v_pk_mul_f32 v[42:43], v[42:43], v[130:131]
v_pk_mul_f32 v[44:45], v[44:45], v[130:131]
v_pk_mul_f32 v[46:47], v[46:47], v[130:131]
v_cvt_pk_bf16_f32 v64, v32, v33
v_cvt_pk_bf16_f32 v65, v34, v35
v_cvt_pk_bf16_f32 v66, v36, v37
v_cvt_pk_bf16_f32 v67, v38, v39
v_cvt_pk_bf16_f32 v68, v40, v41
v_cvt_pk_bf16_f32 v69, v42, v43
v_cvt_pk_bf16_f32 v70, v44, v45
v_cvt_pk_bf16_f32 v71, v46, v47
ds_write_b128 v238, v[64:67] offset:4096
ds_write_b128 v238, v[68:71] offset:5120
v_accvgpr_read_b32 v48, a48
v_accvgpr_read_b32 v49, a49
v_accvgpr_read_b32 v50, a50
v_accvgpr_read_b32 v51, a51
v_accvgpr_read_b32 v52, a52
v_accvgpr_read_b32 v53, a53
v_accvgpr_read_b32 v54, a54
v_accvgpr_read_b32 v55, a55
v_accvgpr_read_b32 v56, a56
v_accvgpr_read_b32 v57, a57
v_accvgpr_read_b32 v58, a58
v_accvgpr_read_b32 v59, a59
v_accvgpr_read_b32 v60, a60
v_accvgpr_read_b32 v61, a61
v_accvgpr_read_b32 v62, a62
v_accvgpr_read_b32 v63, a63
v_pk_mul_f32 v[48:49], v[48:49], v[130:131]
v_pk_mul_f32 v[50:51], v[50:51], v[130:131]
v_pk_mul_f32 v[52:53], v[52:53], v[130:131]
v_pk_mul_f32 v[54:55], v[54:55], v[130:131]
v_pk_mul_f32 v[56:57], v[56:57], v[130:131]
v_pk_mul_f32 v[58:59], v[58:59], v[130:131]
v_pk_mul_f32 v[60:61], v[60:61], v[130:131]
v_pk_mul_f32 v[62:63], v[62:63], v[130:131]
v_cvt_pk_bf16_f32 v72, v48, v49
v_cvt_pk_bf16_f32 v73, v50, v51
v_cvt_pk_bf16_f32 v74, v52, v53
v_cvt_pk_bf16_f32 v75, v54, v55
v_cvt_pk_bf16_f32 v76, v56, v57
v_cvt_pk_bf16_f32 v77, v58, v59
v_cvt_pk_bf16_f32 v78, v60, v61
v_cvt_pk_bf16_f32 v79, v62, v63
ds_write_b128 v238, v[72:75] offset:6144
ds_write_b128 v238, v[76:79] offset:7168
v_accvgpr_read_b32 v32, a64
v_accvgpr_read_b32 v33, a65
v_accvgpr_read_b32 v34, a66
v_accvgpr_read_b32 v35, a67
v_accvgpr_read_b32 v36, a68
v_accvgpr_read_b32 v37, a69
v_accvgpr_read_b32 v38, a70
v_accvgpr_read_b32 v39, a71
v_accvgpr_read_b32 v40, a72
v_accvgpr_read_b32 v41, a73
v_accvgpr_read_b32 v42, a74
v_accvgpr_read_b32 v43, a75
v_accvgpr_read_b32 v44, a76
v_accvgpr_read_b32 v45, a77
v_accvgpr_read_b32 v46, a78
v_accvgpr_read_b32 v47, a79
v_pk_mul_f32 v[32:33], v[32:33], v[132:133]
v_pk_mul_f32 v[34:35], v[34:35], v[132:133]
v_pk_mul_f32 v[36:37], v[36:37], v[132:133]
v_pk_mul_f32 v[38:39], v[38:39], v[132:133]
v_pk_mul_f32 v[40:41], v[40:41], v[132:133]
v_pk_mul_f32 v[42:43], v[42:43], v[132:133]
v_pk_mul_f32 v[44:45], v[44:45], v[132:133]
v_pk_mul_f32 v[46:47], v[46:47], v[132:133]
v_cvt_pk_bf16_f32 v64, v32, v33
v_cvt_pk_bf16_f32 v65, v34, v35
v_cvt_pk_bf16_f32 v66, v36, v37
v_cvt_pk_bf16_f32 v67, v38, v39
v_cvt_pk_bf16_f32 v68, v40, v41
v_cvt_pk_bf16_f32 v69, v42, v43
v_cvt_pk_bf16_f32 v70, v44, v45
v_cvt_pk_bf16_f32 v71, v46, v47
ds_write_b128 v238, v[64:67] offset:8192
ds_write_b128 v238, v[68:71] offset:9216
v_accvgpr_read_b32 v48, a80
v_accvgpr_read_b32 v49, a81
v_accvgpr_read_b32 v50, a82
v_accvgpr_read_b32 v51, a83
v_accvgpr_read_b32 v52, a84
v_accvgpr_read_b32 v53, a85
v_accvgpr_read_b32 v54, a86
v_accvgpr_read_b32 v55, a87
v_accvgpr_read_b32 v56, a88
v_accvgpr_read_b32 v57, a89
v_accvgpr_read_b32 v58, a90
v_accvgpr_read_b32 v59, a91
v_accvgpr_read_b32 v60, a92
v_accvgpr_read_b32 v61, a93
v_accvgpr_read_b32 v62, a94
v_accvgpr_read_b32 v63, a95
v_pk_mul_f32 v[48:49], v[48:49], v[132:133]
v_pk_mul_f32 v[50:51], v[50:51], v[132:133]
v_pk_mul_f32 v[52:53], v[52:53], v[132:133]
v_pk_mul_f32 v[54:55], v[54:55], v[132:133]
v_pk_mul_f32 v[56:57], v[56:57], v[132:133]
v_pk_mul_f32 v[58:59], v[58:59], v[132:133]
v_pk_mul_f32 v[60:61], v[60:61], v[132:133]
v_pk_mul_f32 v[62:63], v[62:63], v[132:133]
v_cvt_pk_bf16_f32 v72, v48, v49
v_cvt_pk_bf16_f32 v73, v50, v51
v_cvt_pk_bf16_f32 v74, v52, v53
v_cvt_pk_bf16_f32 v75, v54, v55
v_cvt_pk_bf16_f32 v76, v56, v57
v_cvt_pk_bf16_f32 v77, v58, v59
v_cvt_pk_bf16_f32 v78, v60, v61
v_cvt_pk_bf16_f32 v79, v62, v63
ds_write_b128 v238, v[72:75] offset:10240
ds_write_b128 v238, v[76:79] offset:11264
v_accvgpr_read_b32 v32, a96
v_accvgpr_read_b32 v33, a97
v_accvgpr_read_b32 v34, a98
v_accvgpr_read_b32 v35, a99
v_accvgpr_read_b32 v36, a100
v_accvgpr_read_b32 v37, a101
v_accvgpr_read_b32 v38, a102
v_accvgpr_read_b32 v39, a103
v_accvgpr_read_b32 v40, a104
v_accvgpr_read_b32 v41, a105
v_accvgpr_read_b32 v42, a106
v_accvgpr_read_b32 v43, a107
v_accvgpr_read_b32 v44, a108
v_accvgpr_read_b32 v45, a109
v_accvgpr_read_b32 v46, a110
v_accvgpr_read_b32 v47, a111
v_pk_mul_f32 v[32:33], v[32:33], v[134:135]
v_pk_mul_f32 v[34:35], v[34:35], v[134:135]
v_pk_mul_f32 v[36:37], v[36:37], v[134:135]
v_pk_mul_f32 v[38:39], v[38:39], v[134:135]
v_pk_mul_f32 v[40:41], v[40:41], v[134:135]
v_pk_mul_f32 v[42:43], v[42:43], v[134:135]
v_pk_mul_f32 v[44:45], v[44:45], v[134:135]
v_pk_mul_f32 v[46:47], v[46:47], v[134:135]
v_cvt_pk_bf16_f32 v64, v32, v33
v_cvt_pk_bf16_f32 v65, v34, v35
v_cvt_pk_bf16_f32 v66, v36, v37
v_cvt_pk_bf16_f32 v67, v38, v39
v_cvt_pk_bf16_f32 v68, v40, v41
v_cvt_pk_bf16_f32 v69, v42, v43
v_cvt_pk_bf16_f32 v70, v44, v45
v_cvt_pk_bf16_f32 v71, v46, v47
ds_write_b128 v238, v[64:67] offset:12288
ds_write_b128 v238, v[68:71] offset:13312
v_accvgpr_read_b32 v48, a112
v_accvgpr_read_b32 v49, a113
v_accvgpr_read_b32 v50, a114
v_accvgpr_read_b32 v51, a115
v_accvgpr_read_b32 v52, a116
v_accvgpr_read_b32 v53, a117
v_accvgpr_read_b32 v54, a118
v_accvgpr_read_b32 v55, a119
v_accvgpr_read_b32 v56, a120
v_accvgpr_read_b32 v57, a121
v_accvgpr_read_b32 v58, a122
v_accvgpr_read_b32 v59, a123
v_accvgpr_read_b32 v60, a124
v_accvgpr_read_b32 v61, a125
v_accvgpr_read_b32 v62, a126
v_accvgpr_read_b32 v63, a127
v_pk_mul_f32 v[48:49], v[48:49], v[134:135]
v_pk_mul_f32 v[50:51], v[50:51], v[134:135]
v_pk_mul_f32 v[52:53], v[52:53], v[134:135]
v_pk_mul_f32 v[54:55], v[54:55], v[134:135]
v_pk_mul_f32 v[56:57], v[56:57], v[134:135]
v_pk_mul_f32 v[58:59], v[58:59], v[134:135]
v_pk_mul_f32 v[60:61], v[60:61], v[134:135]
v_pk_mul_f32 v[62:63], v[62:63], v[134:135]
v_cvt_pk_bf16_f32 v72, v48, v49
v_cvt_pk_bf16_f32 v73, v50, v51
v_cvt_pk_bf16_f32 v74, v52, v53
v_cvt_pk_bf16_f32 v75, v54, v55
v_cvt_pk_bf16_f32 v76, v56, v57
v_cvt_pk_bf16_f32 v77, v58, v59
v_cvt_pk_bf16_f32 v78, v60, v61
v_cvt_pk_bf16_f32 v79, v62, v63
ds_write_b128 v238, v[72:75] offset:14336
ds_write_b128 v238, v[76:79] offset:15360
v_and_b32 v253, 1, v235
v_lshl_add_u32 v253, v253, 2, v233
v_lshrrev_b32 v254, 1, v235
v_mul_u32_u24 v252, 3072, v254
v_lshl_add_u32 v252, v253, 7, v252
v_lshl_add_u32 v252, v234, 3, v252
v_lshrrev_b32 v253, 1, v253
s_xor_b32 s12, s5, 0
s_mul_i32 s12, s12, 3
s_mul_i32 s8, s4, 6
s_add_u32 s12, s12, s8
s_add_u32 s8, s12, 0
s_and_b32 s9, s8, 3
s_lshr_b32 s8, s8, 2
s_lshl_b32 s8, s8, 10
s_add_u32 s8, s8, 135168
v_xor_b32 v254, s9, v253
v_lshl_add_u32 v254, v254, 5, v252
v_add_u32 v221, s8, v254
s_add_u32 s8, s12, 1
s_and_b32 s9, s8, 3
s_lshr_b32 s8, s8, 2
s_lshl_b32 s8, s8, 10
s_add_u32 s8, s8, 135168
v_xor_b32 v254, s9, v253
v_lshl_add_u32 v254, v254, 5, v252
v_add_u32 v222, s8, v254
s_add_u32 s8, s12, 2
s_and_b32 s9, s8, 3
s_lshr_b32 s8, s8, 2
s_lshl_b32 s8, s8, 10
s_add_u32 s8, s8, 135168
v_xor_b32 v254, s9, v253
v_lshl_add_u32 v254, v254, 5, v252
v_add_u32 v223, s8, v254
s_mul_i32 s8, s12, 16384
s_mul_i32 s9, s5, 1179648
s_add_u32 s8, s8, s9
s_lshl_b32 s9, s7, 10
s_add_u32 s8, s8, s9
v_add_u32 v229, s8, v237
s_mul_i32 s8, s12, 8192
s_add_u32 s8, s8, 2359296
s_lshl_b32 s9, s7, 9
s_add_u32 s8, s8, s9
v_lshlrev_b32 v255, 3, v251
v_add_u32 v231, s8, v255
s_xor_b32 s12, s5, 1
s_mul_i32 s12, s12, 3
s_mul_i32 s8, s4, 6
s_add_u32 s12, s12, s8
s_add_u32 s8, s12, 0
s_and_b32 s9, s8, 3
s_lshr_b32 s8, s8, 2
s_lshl_b32 s8, s8, 10
s_add_u32 s8, s8, 135168
v_xor_b32 v254, s9, v253
v_lshl_add_u32 v254, v254, 5, v252
v_add_u32 v224, s8, v254
s_add_u32 s8, s12, 1
s_and_b32 s9, s8, 3
s_lshr_b32 s8, s8, 2
s_lshl_b32 s8, s8, 10
s_add_u32 s8, s8, 135168
v_xor_b32 v254, s9, v253
v_lshl_add_u32 v254, v254, 5, v252
v_add_u32 v225, s8, v254
s_add_u32 s8, s12, 2
s_and_b32 s9, s8, 3
s_lshr_b32 s8, s8, 2
s_lshl_b32 s8, s8, 10
s_add_u32 s8, s8, 135168
v_xor_b32 v254, s9, v253
v_lshl_add_u32 v254, v254, 5, v252
v_add_u32 v226, s8, v254
s_mul_i32 s8, s12, 16384
s_mul_i32 s9, s5, 1179648
s_add_u32 s8, s8, s9
s_lshl_b32 s9, s7, 10
s_add_u32 s8, s8, s9
v_add_u32 v230, s8, v237
s_lshl_b32 s8, s5, 14
s_add_u32 s8, s8, 69632
v_add_u32 v227, s8, v237
v_add_u32 v228, 61440, v237
s_waitcnt lgkmcnt(0)
s_waitcnt vmcnt(9)
s_barrier
ds_read_b64_tr_b16 a[128:129], v221
ds_read_b64_tr_b16 a[130:131], v221 offset:6144
ds_read_b64_tr_b16 a[132:133], v222
ds_read_b64_tr_b16 a[134:135], v222 offset:6144
ds_read_b64_tr_b16 a[136:137], v223
ds_read_b64_tr_b16 a[138:139], v223 offset:6144
ds_read_b128 v[136:139], v227
s_waitcnt lgkmcnt(0)
ds_read_b128 v[140:143], v227 offset:4096
ds_read_b128 v[144:147], v227 offset:8192
ds_read_b128 v[148:151], v227 offset:12288
v_mfma_f32_16x16x32_bf16 v[0:3], a[128:131], v[136:139], 0
ds_read_b64_tr_b16 v[124:125], v224
ds_read_b64 v[178:179], v242
ds_read_b128 v[184:187], v240
ds_read_b128 v[188:191], v240 offset:1024
ds_read_b128 v[192:195], v240 offset:2048
ds_read_b128 v[196:199], v240 offset:3072
s_waitcnt lgkmcnt(4)
v_min_f32 v180, v183, v178
v_mfma_f32_16x16x32_bf16 v[4:7], a[128:131], v[140:143], 0
ds_read_b64_tr_b16 v[126:127], v224 offset:6144
v_sub_f32 v181, v180, v183
v_sub_f32 v182, v180, v178
v_exp_f32 v181, v181
v_exp_f32 v182, v182
v_mfma_f32_16x16x32_bf16 v[8:11], a[128:131], v[144:147], 0
v_mov_b32 v180, v209
v_mul_f32 v211, v181, v180
v_fmac_f32 v211, v182, v179
v_rcp_f32 v211, v211
v_mov_b32 v180, 0
v_mfma_f32_16x16x32_bf16 v[12:15], a[128:131], v[148:151], 0
ds_read_b64_tr_b16 v[128:129], v225
v_mul_f32 v181, v181, v211
v_mul_f32 v182, v182, v211
v_mul_f32 v160, v160, v181
s_waitcnt lgkmcnt(1)
v_fmac_f32 v160, v184, v182
v_mfma_f32_16x16x32_bf16 v[16:19], a[132:135], v[136:139], 0
v_mul_f32 v161, v161, v181
v_fmac_f32 v161, v185, v182
v_mul_f32 v162, v162, v181
v_fmac_f32 v162, v186, v182
v_mul_f32 v163, v163, v181
v_mfma_f32_16x16x32_bf16 v[20:23], a[132:135], v[140:143], 0
ds_read_b64_tr_b16 v[130:131], v225 offset:6144
v_fmac_f32 v163, v187, v182
v_mul_f32 v164, v164, v181
v_fmac_f32 v164, v188, v182
v_mul_f32 v165, v165, v181
v_mfma_f32_16x16x32_bf16 v[24:27], a[132:135], v[144:147], 0
v_fmac_f32 v165, v189, v182
v_mul_f32 v166, v166, v181
v_fmac_f32 v166, v190, v182
v_mul_f32 v167, v167, v181
v_fmac_f32 v167, v191, v182
v_mfma_f32_16x16x32_bf16 v[28:31], a[132:135], v[148:151], 0
ds_read_b64_tr_b16 v[132:133], v226
v_mul_f32 v168, v168, v181
v_fmac_f32 v168, v192, v182
v_mul_f32 v169, v169, v181
v_fmac_f32 v169, v193, v182
v_mfma_f32_16x16x32_bf16 v[32:35], a[136:139], v[136:139], 0
v_mul_f32 v170, v170, v181
v_fmac_f32 v170, v194, v182
v_mul_f32 v171, v171, v181
v_fmac_f32 v171, v195, v182
v_mul_f32 v172, v172, v181
v_mfma_f32_16x16x32_bf16 v[36:39], a[136:139], v[140:143], 0
ds_read_b64_tr_b16 v[134:135], v226 offset:6144
v_fmac_f32 v172, v196, v182
v_mul_f32 v173, v173, v181
v_fmac_f32 v173, v197, v182
v_mul_f32 v174, v174, v181
v_mfma_f32_16x16x32_bf16 v[40:43], a[136:139], v[144:147], 0
v_fmac_f32 v174, v198, v182
v_mul_f32 v175, v175, v181
v_fmac_f32 v175, v199, v182
v_cvt_pk_bf16_f32 v184, v160, v161
v_cvt_pk_bf16_f32 v185, v162, v163
v_mfma_f32_16x16x32_bf16 v[44:47], a[136:139], v[148:151], 0
v_cvt_pk_bf16_f32 v186, v164, v165
v_cvt_pk_bf16_f32 v187, v166, v167
v_cvt_pk_bf16_f32 v188, v168, v169
v_cvt_pk_bf16_f32 v189, v170, v171
v_mfma_f32_16x16x32_bf16 v[48:51], v[124:127], v[136:139], 0
v_cvt_pk_bf16_f32 v190, v172, v173
v_cvt_pk_bf16_f32 v191, v174, v175
ds_write_b128 v243, v[184:187]
ds_write_b128 v243, v[188:191] offset:1024
v_mfma_f32_16x16x32_bf16 v[52:55], v[124:127], v[140:143], 0
v_add_u32 v221, 12288, v221
ds_read_b64_tr_b16 a[140:141], v221
v_mfma_f32_16x16x32_bf16 v[56:59], v[124:127], v[144:147], 0
ds_read_b128 a[160:163], v227 offset:1024
v_add_u32 v222, 12288, v222
v_mfma_f32_16x16x32_bf16 v[60:63], v[124:127], v[148:151], 0
s_waitcnt lgkmcnt(4)
ds_read_b64_tr_b16 a[142:143], v221 offset:6144
ds_read_b64_tr_b16 a[144:145], v222
v_mfma_f32_16x16x32_bf16 v[64:67], v[128:131], v[136:139], 0
ds_read_b128 a[164:167], v227 offset:5120
v_add_u32 v223, 12288, v223
v_mfma_f32_16x16x32_bf16 v[68:71], v[128:131], v[140:143], 0
ds_read_b128 a[168:171], v227 offset:9216
v_add_u32 v224, 12288, v224
v_mfma_f32_16x16x32_bf16 v[72:75], v[128:131], v[144:147], 0
ds_read_b128 a[172:175], v227 offset:13312
v_add_u32 v225, 12288, v225
v_mfma_f32_16x16x32_bf16 v[76:79], v[128:131], v[148:151], 0
s_waitcnt lgkmcnt(0)
s_waitcnt vmcnt(6)
s_barrier
ds_read_b128 a[176:179], v228
ds_read_b128 a[180:183], v228 offset:1024
v_mfma_f32_16x16x32_bf16 v[80:83], v[132:135], v[136:139], 0
ds_read_b64_tr_b16 a[146:147], v222 offset:6144
s_add_u32 m0, s82, 36864
s_mov_b32 s10, 184320
buffer_load_dwordx4 v218, s[60:63], s10 offen lds
v_mfma_f32_16x16x32_bf16 v[84:87], v[132:135], v[140:143], 0
ds_read_b64_tr_b16 a[148:149], v223
ds_read_b64_tr_b16 a[150:151], v223 offset:6144
v_mfma_f32_16x16x32_bf16 v[88:91], v[132:135], v[144:147], 0
ds_read_b64_tr_b16 v[124:125], v224
ds_read_b64_tr_b16 v[126:127], v224 offset:6144
v_mfma_f32_16x16x32_bf16 v[92:95], v[132:135], v[148:151], 0
s_waitcnt lgkmcnt(5)
ds_read_b64_tr_b16 v[128:129], v225
ds_read_b64_tr_b16 v[130:131], v225 offset:6144
v_mfma_f32_16x16x32_bf16 v[96:99], a[128:131], a[176:179], 0
v_add_u32 v226, 12288, v226
ds_read_b64_tr_b16 v[132:133], v226
v_mfma_f32_16x16x32_bf16 v[100:103], a[132:135], a[176:179], 0
ds_read_b64_tr_b16 v[134:135], v226 offset:6144
v_add_u32 v221, 4294819840, v221
v_mfma_f32_16x16x32_bf16 v[104:107], a[136:139], a[176:179], 0
ds_read_b64_tr_b16 a[128:129], v221
buffer_load_dwordx4 v219, s[60:63], s10 offen offset:1024 lds
v_mfma_f32_16x16x32_bf16 v[0:3], a[140:143], a[160:163], v[0:3]
ds_read_b128 v[136:139], v227 offset:2048
v_add_u32 v222, 4294819840, v222
v_mfma_f32_16x16x32_bf16 v[4:7], a[140:143], a[164:167], v[4:7]
ds_read_b64_tr_b16 a[130:131], v221 offset:6144
ds_read_b64_tr_b16 a[132:133], v222
v_mfma_f32_16x16x32_bf16 v[8:11], a[140:143], a[168:171], v[8:11]
ds_read_b128 v[140:143], v227 offset:6144
v_add_u32 v223, 4294819840, v223
v_mfma_f32_16x16x32_bf16 v[12:15], a[140:143], a[172:175], v[12:15]
ds_read_b128 v[144:147], v227 offset:10240
v_add_u32 v224, 4294819840, v224
v_mfma_f32_16x16x32_bf16 v[96:99], a[140:143], a[180:183], v[96:99]
s_waitcnt lgkmcnt(5)
ds_read_b128 v[148:151], v227 offset:14336
v_add_u32 v225, 4294819840, v225
v_mfma_f32_16x16x32_bf16 v[16:19], a[144:147], a[160:163], v[16:19]
ds_read_b128 a[176:179], v228 offset:2048
buffer_load_dwordx4 v220, s[60:63], s10 offen offset:2048 lds
v_mfma_f32_16x16x32_bf16 v[20:23], a[144:147], a[164:167], v[20:23]
ds_read_b64_tr_b16 a[134:135], v222 offset:6144
ds_read_b64_tr_b16 a[136:137], v223
v_mfma_f32_16x16x32_bf16 v[24:27], a[144:147], a[168:171], v[24:27]
ds_read_b64_tr_b16 a[138:139], v223 offset:6144
v_add_u32 v226, 4294819840, v226
v_mfma_f32_16x16x32_bf16 v[28:31], a[144:147], a[172:175], v[28:31]
v_add_u32 v221, 12288, v221
v_add_u32 v222, 12288, v222
v_mfma_f32_16x16x32_bf16 v[100:103], a[144:147], a[180:183], v[100:103]
v_add_u32 v223, 12288, v223
v_mfma_f32_16x16x32_bf16 v[32:35], a[148:151], a[160:163], v[32:35]
s_waitcnt vmcnt(6)
s_barrier
ds_read_b64_tr_b16 a[140:141], v221
v_mfma_f32_16x16x32_bf16 v[36:39], a[148:151], a[164:167], v[36:39]
ds_read_b64_tr_b16 a[142:143], v221 offset:6144
s_add_u32 m0, s82, 135168
s_mov_b32 s10, 221184
buffer_load_dwordx4 v218, s[60:63], s10 offen lds
v_mfma_f32_16x16x32_bf16 v[40:43], a[148:151], a[168:171], v[40:43]
ds_read_b64_tr_b16 a[144:145], v222
ds_read_b64_tr_b16 a[146:147], v222 offset:6144
v_mfma_f32_16x16x32_bf16 v[44:47], a[148:151], a[172:175], v[44:47]
v_add_u32 v221, 12288, v221
v_add_u32 v222, 12288, v222
v_mfma_f32_16x16x32_bf16 v[104:107], a[148:151], a[180:183], v[104:107]
ds_read_b128 a[180:183], v228 offset:3072
v_mfma_f32_16x16x32_bf16 v[48:51], v[124:127], a[160:163], v[48:51]
ds_read_b64_tr_b16 a[148:149], v223
ds_read_b64_tr_b16 a[150:151], v223 offset:6144
v_mfma_f32_16x16x32_bf16 v[52:55], v[124:127], a[164:167], v[52:55]
v_add_u32 v223, 12288, v223
v_mfma_f32_16x16x32_bf16 v[56:59], v[124:127], a[168:171], v[56:59]
buffer_load_dwordx4 v219, s[60:63], s10 offen offset:1024 lds
v_mfma_f32_16x16x32_bf16 v[60:63], v[124:127], a[172:175], v[60:63]
ds_read_b64_tr_b16 v[124:125], v224
ds_read_b64_tr_b16 v[126:127], v224 offset:6144
v_mfma_f32_16x16x32_bf16 v[64:67], v[128:131], a[160:163], v[64:67]
v_add_u32 v224, 12288, v224
v_mfma_f32_16x16x32_bf16 v[68:71], v[128:131], a[164:167], v[68:71]
v_mfma_f32_16x16x32_bf16 v[72:75], v[128:131], a[168:171], v[72:75]
v_mfma_f32_16x16x32_bf16 v[76:79], v[128:131], a[172:175], v[76:79]
ds_read_b64_tr_b16 v[128:129], v225
ds_read_b64_tr_b16 v[130:131], v225 offset:6144
v_mfma_f32_16x16x32_bf16 v[80:83], v[132:135], a[160:163], v[80:83]
ds_read_b128 a[160:163], v227 offset:3072
buffer_load_dwordx4 v220, s[60:63], s10 offen offset:2048 lds
v_mfma_f32_16x16x32_bf16 v[84:87], v[132:135], a[164:167], v[84:87]
ds_read_b128 a[164:167], v227 offset:7168
v_add_u32 v225, 12288, v225
v_mfma_f32_16x16x32_bf16 v[88:91], v[132:135], a[168:171], v[88:91]
ds_read_b128 a[168:171], v227 offset:11264
v_mfma_f32_16x16x32_bf16 v[92:95], v[132:135], a[172:175], v[92:95]
s_waitcnt lgkmcnt(5)
ds_read_b64_tr_b16 v[132:133], v226
ds_read_b64_tr_b16 v[134:135], v226 offset:6144
v_mfma_f32_16x16x32_bf16 v[0:3], a[128:131], v[136:139], v[0:3]
ds_read_b128 a[172:175], v227 offset:15360
v_add_u32 v226, 12288, v226
v_mfma_f32_16x16x32_bf16 v[4:7], a[128:131], v[140:143], v[4:7]
v_mfma_f32_16x16x32_bf16 v[8:11], a[128:131], v[144:147], v[8:11]
v_mfma_f32_16x16x32_bf16 v[12:15], a[128:131], v[148:151], v[12:15]
v_mfma_f32_16x16x32_bf16 v[96:99], a[128:131], a[176:179], v[96:99]
v_mfma_f32_16x16x32_bf16 v[16:19], a[132:135], v[136:139], v[16:19]
v_mfma_f32_16x16x32_bf16 v[20:23], a[132:135], v[140:143], v[20:23]
v_mfma_f32_16x16x32_bf16 v[24:27], a[132:135], v[144:147], v[24:27]
v_mfma_f32_16x16x32_bf16 v[28:31], a[132:135], v[148:151], v[28:31]
v_mfma_f32_16x16x32_bf16 v[100:103], a[132:135], a[176:179], v[100:103]
v_mfma_f32_16x16x32_bf16 v[32:35], a[136:139], v[136:139], v[32:35]
s_waitcnt vmcnt(6)
s_barrier
ds_read_b64_tr_b16 a[128:129], v221
v_mfma_f32_16x16x32_bf16 v[36:39], a[136:139], v[140:143], v[36:39]
ds_read_b64_tr_b16 a[130:131], v221 offset:6144
s_add_u32 m0, s82, 147456
s_mov_b32 s10, 258048
buffer_load_dwordx4 v218, s[60:63], s10 offen lds
v_mfma_f32_16x16x32_bf16 v[40:43], a[136:139], v[144:147], v[40:43]
ds_read_b64_tr_b16 a[132:133], v222
ds_read_b64_tr_b16 a[134:135], v222 offset:6144
v_mfma_f32_16x16x32_bf16 v[44:47], a[136:139], v[148:151], v[44:47]
v_add_u32 v221, 12288, v221
v_add_u32 v222, 12288, v222
v_mfma_f32_16x16x32_bf16 v[104:107], a[136:139], a[176:179], v[104:107]
ds_read_b128 a[176:179], v228 offset:4096
v_mfma_f32_16x16x32_bf16 v[48:51], v[124:127], v[136:139], v[48:51]
ds_read_b64_tr_b16 a[136:137], v223
ds_read_b64_tr_b16 a[138:139], v223 offset:6144
v_mfma_f32_16x16x32_bf16 v[52:55], v[124:127], v[140:143], v[52:55]
v_add_u32 v223, 12288, v223
v_mfma_f32_16x16x32_bf16 v[56:59], v[124:127], v[144:147], v[56:59]
buffer_load_dwordx4 v219, s[60:63], s10 offen offset:1024 lds
v_mfma_f32_16x16x32_bf16 v[60:63], v[124:127], v[148:151], v[60:63]
s_waitcnt lgkmcnt(3)
ds_read_b64_tr_b16 v[124:125], v224
ds_read_b64_tr_b16 v[126:127], v224 offset:6144
v_mfma_f32_16x16x32_bf16 v[64:67], v[128:131], v[136:139], v[64:67]
v_add_u32 v224, 12288, v224
v_mfma_f32_16x16x32_bf16 v[68:71], v[128:131], v[140:143], v[68:71]
v_mfma_f32_16x16x32_bf16 v[72:75], v[128:131], v[144:147], v[72:75]
v_mfma_f32_16x16x32_bf16 v[76:79], v[128:131], v[148:151], v[76:79]
ds_read_b64_tr_b16 v[128:129], v225
ds_read_b64_tr_b16 v[130:131], v225 offset:6144
v_mfma_f32_16x16x32_bf16 v[80:83], v[132:135], v[136:139], v[80:83]
ds_read_b128 v[136:139], v227 offset:32768
buffer_load_dwordx4 v220, s[60:63], s10 offen offset:2048 lds
v_mfma_f32_16x16x32_bf16 v[84:87], v[132:135], v[140:143], v[84:87]
ds_read_b128 v[140:143], v227 offset:36864
v_add_u32 v225, 12288, v225
v_mfma_f32_16x16x32_bf16 v[88:91], v[132:135], v[144:147], v[88:91]
ds_read_b128 v[144:147], v227 offset:40960
v_mfma_f32_16x16x32_bf16 v[92:95], v[132:135], v[148:151], v[92:95]
ds_read_b64_tr_b16 v[132:133], v226
ds_read_b64_tr_b16 v[134:135], v226 offset:6144
v_mfma_f32_16x16x32_bf16 v[0:3], a[140:143], a[160:163], v[0:3]
ds_read_b128 v[148:151], v227 offset:45056
v_add_u32 v226, 12288, v226
v_mfma_f32_16x16x32_bf16 v[4:7], a[140:143], a[164:167], v[4:7]
v_mfma_f32_16x16x32_bf16 v[8:11], a[140:143], a[168:171], v[8:11]
v_mfma_f32_16x16x32_bf16 v[12:15], a[140:143], a[172:175], v[12:15]
v_mfma_f32_16x16x32_bf16 v[96:99], a[140:143], a[180:183], v[96:99]
v_mfma_f32_16x16x32_bf16 v[16:19], a[144:147], a[160:163], v[16:19]
v_mfma_f32_16x16x32_bf16 v[20:23], a[144:147], a[164:167], v[20:23]
v_mfma_f32_16x16x32_bf16 v[24:27], a[144:147], a[168:171], v[24:27]
v_mfma_f32_16x16x32_bf16 v[28:31], a[144:147], a[172:175], v[28:31]
v_mfma_f32_16x16x32_bf16 v[100:103], a[144:147], a[180:183], v[100:103]
v_mfma_f32_16x16x32_bf16 v[32:35], a[148:151], a[160:163], v[32:35]
s_waitcnt vmcnt(6)
s_barrier
ds_read_b64_tr_b16 a[140:141], v221
v_mfma_f32_16x16x32_bf16 v[36:39], a[148:151], a[164:167], v[36:39]
ds_read_b64_tr_b16 a[142:143], v221 offset:6144
s_add_u32 m0, s82, 0
s_mov_b32 s10, 384
buffer_load_dwordx4 v218, s[60:63], s10 offen lds
v_mfma_f32_16x16x32_bf16 v[40:43], a[148:151], a[168:171], v[40:43]
ds_read_b64_tr_b16 a[144:145], v222
ds_read_b64_tr_b16 a[146:147], v222 offset:6144
v_mfma_f32_16x16x32_bf16 v[44:47], a[148:151], a[172:175], v[44:47]
v_add_u32 v221, 98304, v221
v_add_u32 v222, 98304, v222
v_mfma_f32_16x16x32_bf16 v[104:107], a[148:151], a[180:183], v[104:107]
s_waitcnt lgkmcnt(4)
ds_read_b128 a[180:183], v228 offset:5120
v_mfma_f32_16x16x32_bf16 v[48:51], v[124:127], a[160:163], v[48:51]
ds_read_b64_tr_b16 a[148:149], v223
ds_read_b64_tr_b16 a[150:151], v223 offset:6144
v_mfma_f32_16x16x32_bf16 v[52:55], v[124:127], a[164:167], v[52:55]
v_add_u32 v223, 98304, v223
v_mfma_f32_16x16x32_bf16 v[56:59], v[124:127], a[168:171], v[56:59]
buffer_load_dwordx4 v219, s[60:63], s10 offen offset:1024 lds
v_mfma_f32_16x16x32_bf16 v[60:63], v[124:127], a[172:175], v[60:63]
ds_read_b64_tr_b16 v[124:125], v224
ds_read_b64_tr_b16 v[126:127], v224 offset:6144
v_mfma_f32_16x16x32_bf16 v[64:67], v[128:131], a[160:163], v[64:67]
v_add_u32 v224, 12288, v224
v_mfma_f32_16x16x32_bf16 v[68:71], v[128:131], a[164:167], v[68:71]
v_mfma_f32_16x16x32_bf16 v[72:75], v[128:131], a[168:171], v[72:75]
v_mfma_f32_16x16x32_bf16 v[76:79], v[128:131], a[172:175], v[76:79]
ds_read_b64_tr_b16 v[128:129], v225
ds_read_b64_tr_b16 v[130:131], v225 offset:6144
v_mfma_f32_16x16x32_bf16 v[80:83], v[132:135], a[160:163], v[80:83]
ds_read_b128 a[160:163], v227 offset:33792
buffer_load_dwordx4 v220, s[60:63], s10 offen offset:2048 lds
v_mfma_f32_16x16x32_bf16 v[84:87], v[132:135], a[164:167], v[84:87]
ds_read_b128 a[164:167], v227 offset:37888
v_add_u32 v225, 12288, v225
v_mfma_f32_16x16x32_bf16 v[88:91], v[132:135], a[168:171], v[88:91]
ds_read_b128 a[168:171], v227 offset:41984
v_mfma_f32_16x16x32_bf16 v[92:95], v[132:135], a[172:175], v[92:95]
ds_read_b64_tr_b16 v[132:133], v226
ds_read_b64_tr_b16 v[134:135], v226 offset:6144
v_mfma_f32_16x16x32_bf16 v[0:3], a[128:131], v[136:139], v[0:3]
ds_read_b128 a[172:175], v227 offset:46080
v_add_u32 v226, 12288, v226
v_mfma_f32_16x16x32_bf16 v[4:7], a[128:131], v[140:143], v[4:7]
v_mfma_f32_16x16x32_bf16 v[8:11], a[128:131], v[144:147], v[8:11]
v_mfma_f32_16x16x32_bf16 v[12:15], a[128:131], v[148:151], v[12:15]
v_mfma_f32_16x16x32_bf16 v[96:99], a[128:131], a[176:179], v[96:99]
v_mfma_f32_16x16x32_bf16 v[16:19], a[132:135], v[136:139], v[16:19]
v_mfma_f32_16x16x32_bf16 v[20:23], a[132:135], v[140:143], v[20:23]
v_mfma_f32_16x16x32_bf16 v[24:27], a[132:135], v[144:147], v[24:27]
v_mfma_f32_16x16x32_bf16 v[28:31], a[132:135], v[148:151], v[28:31]
v_mfma_f32_16x16x32_bf16 v[100:103], a[132:135], a[176:179], v[100:103]
v_mfma_f32_16x16x32_bf16 v[32:35], a[136:139], v[136:139], v[32:35]
s_waitcnt vmcnt(6)
s_barrier
ds_read_b64_tr_b16 a[128:129], v221
v_mfma_f32_16x16x32_bf16 v[36:39], a[136:139], v[140:143], v[36:39]
ds_read_b64_tr_b16 a[130:131], v221 offset:6144
s_add_u32 m0, s82, 12288
s_mov_b32 s10, 37248
buffer_load_dwordx4 v218, s[60:63], s10 offen lds
v_mfma_f32_16x16x32_bf16 v[40:43], a[136:139], v[144:147], v[40:43]
ds_read_b64_tr_b16 a[132:133], v222
ds_read_b64_tr_b16 a[134:135], v222 offset:6144
v_mfma_f32_16x16x32_bf16 v[44:47], a[136:139], v[148:151], v[44:47]
v_add_u32 v221, 12288, v221
v_add_u32 v222, 12288, v222
v_mfma_f32_16x16x32_bf16 v[104:107], a[136:139], a[176:179], v[104:107]
s_waitcnt lgkmcnt(4)
ds_read_b128 a[176:179], v228 offset:6144
v_mfma_f32_16x16x32_bf16 v[48:51], v[124:127], v[136:139], v[48:51]
ds_read_b64_tr_b16 a[136:137], v223
ds_read_b64_tr_b16 a[138:139], v223 offset:6144
v_mfma_f32_16x16x32_bf16 v[52:55], v[124:127], v[140:143], v[52:55]
v_add_u32 v223, 12288, v223
v_mfma_f32_16x16x32_bf16 v[56:59], v[124:127], v[144:147], v[56:59]
buffer_load_dwordx4 v219, s[60:63], s10 offen offset:1024 lds
v_mfma_f32_16x16x32_bf16 v[60:63], v[124:127], v[148:151], v[60:63]
ds_read_b64_tr_b16 v[124:125], v224
ds_read_b64_tr_b16 v[126:127], v224 offset:6144
v_mfma_f32_16x16x32_bf16 v[64:67], v[128:131], v[136:139], v[64:67]
v_add_u32 v224, 98304, v224
v_mfma_f32_16x16x32_bf16 v[68:71], v[128:131], v[140:143], v[68:71]
v_mfma_f32_16x16x32_bf16 v[72:75], v[128:131], v[144:147], v[72:75]
v_mfma_f32_16x16x32_bf16 v[76:79], v[128:131], v[148:151], v[76:79]
ds_read_b64_tr_b16 v[128:129], v225
ds_read_b64_tr_b16 v[130:131], v225 offset:6144
v_mfma_f32_16x16x32_bf16 v[80:83], v[132:135], v[136:139], v[80:83]
ds_read_b128 v[136:139], v227 offset:34816
buffer_load_dwordx4 v220, s[60:63], s10 offen offset:2048 lds
v_mfma_f32_16x16x32_bf16 v[84:87], v[132:135], v[140:143], v[84:87]
ds_read_b128 v[140:143], v227 offset:38912
v_add_u32 v225, 98304, v225
v_mfma_f32_16x16x32_bf16 v[88:91], v[132:135], v[144:147], v[88:91]
ds_read_b128 v[144:147], v227 offset:43008
v_mfma_f32_16x16x32_bf16 v[92:95], v[132:135], v[148:151], v[92:95]
ds_read_b64_tr_b16 v[132:133], v226
ds_read_b64_tr_b16 v[134:135], v226 offset:6144
v_mfma_f32_16x16x32_bf16 v[0:3], a[140:143], a[160:163], v[0:3]
ds_read_b128 v[148:151], v227 offset:47104
v_add_u32 v226, 98304, v226
v_mfma_f32_16x16x32_bf16 v[4:7], a[140:143], a[164:167], v[4:7]
v_mfma_f32_16x16x32_bf16 v[8:11], a[140:143], a[168:171], v[8:11]
v_mfma_f32_16x16x32_bf16 v[12:15], a[140:143], a[172:175], v[12:15]
v_mfma_f32_16x16x32_bf16 v[96:99], a[140:143], a[180:183], v[96:99]
v_mfma_f32_16x16x32_bf16 v[16:19], a[144:147], a[160:163], v[16:19]
v_mfma_f32_16x16x32_bf16 v[20:23], a[144:147], a[164:167], v[20:23]
v_mfma_f32_16x16x32_bf16 v[24:27], a[144:147], a[168:171], v[24:27]
v_mfma_f32_16x16x32_bf16 v[28:31], a[144:147], a[172:175], v[28:31]
v_mfma_f32_16x16x32_bf16 v[100:103], a[144:147], a[180:183], v[100:103]
v_mfma_f32_16x16x32_bf16 v[32:35], a[148:151], a[160:163], v[32:35]
s_waitcnt vmcnt(6)
s_barrier
ds_read_b64_tr_b16 a[140:141], v221
v_mfma_f32_16x16x32_bf16 v[36:39], a[148:151], a[164:167], v[36:39]
ds_read_b64_tr_b16 a[142:143], v221 offset:6144
s_add_u32 m0, s82, 24576
s_mov_b32 s10, 74112
buffer_load_dwordx4 v218, s[60:63], s10 offen lds
v_mfma_f32_16x16x32_bf16 v[40:43], a[148:151], a[168:171], v[40:43]
ds_read_b64_tr_b16 a[144:145], v222
ds_read_b64_tr_b16 a[146:147], v222 offset:6144
v_mfma_f32_16x16x32_bf16 v[44:47], a[148:151], a[172:175], v[44:47]
v_add_u32 v221, 4294819840, v221
v_add_u32 v222, 4294819840, v222
v_mfma_f32_16x16x32_bf16 v[104:107], a[148:151], a[180:183], v[104:107]
s_waitcnt lgkmcnt(4)
ds_read_b128 a[180:183], v228 offset:7168
v_mfma_f32_16x16x32_bf16 v[48:51], v[124:127], a[160:163], v[48:51]
ds_read_b64_tr_b16 a[148:149], v223
ds_read_b64_tr_b16 a[150:151], v223 offset:6144
v_mfma_f32_16x16x32_bf16 v[52:55], v[124:127], a[164:167], v[52:55]
v_add_u32 v223, 4294819840, v223
v_mfma_f32_16x16x32_bf16 v[56:59], v[124:127], a[168:171], v[56:59]
buffer_load_dwordx4 v219, s[60:63], s10 offen offset:1024 lds
v_mfma_f32_16x16x32_bf16 v[60:63], v[124:127], a[172:175], v[60:63]
ds_read_b64_tr_b16 v[124:125], v224
ds_read_b64_tr_b16 v[126:127], v224 offset:6144
v_mfma_f32_16x16x32_bf16 v[64:67], v[128:131], a[160:163], v[64:67]
v_add_u32 v224, 12288, v224
v_mfma_f32_16x16x32_bf16 v[68:71], v[128:131], a[164:167], v[68:71]
v_mfma_f32_16x16x32_bf16 v[72:75], v[128:131], a[168:171], v[72:75]
v_mfma_f32_16x16x32_bf16 v[76:79], v[128:131], a[172:175], v[76:79]
ds_read_b64_tr_b16 v[128:129], v225
ds_read_b64_tr_b16 v[130:131], v225 offset:6144
v_mfma_f32_16x16x32_bf16 v[80:83], v[132:135], a[160:163], v[80:83]
ds_read_b128 a[160:163], v227 offset:35840
buffer_load_dwordx4 v220, s[60:63], s10 offen offset:2048 lds
v_mfma_f32_16x16x32_bf16 v[84:87], v[132:135], a[164:167], v[84:87]
ds_read_b128 a[164:167], v227 offset:39936
v_add_u32 v225, 12288, v225
v_mfma_f32_16x16x32_bf16 v[88:91], v[132:135], a[168:171], v[88:91]
ds_read_b128 a[168:171], v227 offset:44032
v_mfma_f32_16x16x32_bf16 v[92:95], v[132:135], a[172:175], v[92:95]
ds_read_b64_tr_b16 v[132:133], v226
ds_read_b64_tr_b16 v[134:135], v226 offset:6144
v_mfma_f32_16x16x32_bf16 v[0:3], a[128:131], v[136:139], v[0:3]
ds_read_b128 a[172:175], v227 offset:48128
v_add_u32 v226, 12288, v226
v_mfma_f32_16x16x32_bf16 v[4:7], a[128:131], v[140:143], v[4:7]
v_mfma_f32_16x16x32_bf16 v[8:11], a[128:131], v[144:147], v[8:11]
v_mfma_f32_16x16x32_bf16 v[12:15], a[128:131], v[148:151], v[12:15]
v_mfma_f32_16x16x32_bf16 v[96:99], a[128:131], a[176:179], v[96:99]
v_mfma_f32_16x16x32_bf16 v[16:19], a[132:135], v[136:139], v[16:19]
v_mfma_f32_16x16x32_bf16 v[20:23], a[132:135], v[140:143], v[20:23]
v_mfma_f32_16x16x32_bf16 v[24:27], a[132:135], v[144:147], v[24:27]
v_mfma_f32_16x16x32_bf16 v[28:31], a[132:135], v[148:151], v[28:31]
v_mfma_f32_16x16x32_bf16 v[100:103], a[132:135], a[176:179], v[100:103]
v_mfma_f32_16x16x32_bf16 v[32:35], a[136:139], v[136:139], v[32:35]
s_waitcnt vmcnt(6)
s_barrier
ds_read_b64_tr_b16 a[128:129], v221
v_mfma_f32_16x16x32_bf16 v[36:39], a[136:139], v[140:143], v[36:39]
ds_read_b64_tr_b16 a[130:131], v221 offset:6144
s_add_u32 m0, s82, 36864
s_mov_b32 s10, 110976
buffer_load_dwordx4 v218, s[60:63], s10 offen lds
v_mfma_f32_16x16x32_bf16 v[40:43], a[136:139], v[144:147], v[40:43]
ds_read_b64_tr_b16 a[132:133], v222
ds_read_b64_tr_b16 a[134:135], v222 offset:6144
v_mfma_f32_16x16x32_bf16 v[44:47], a[136:139], v[148:151], v[44:47]
v_add_u32 v221, 12288, v221
v_add_u32 v222, 12288, v222
v_mfma_f32_16x16x32_bf16 v[104:107], a[136:139], a[176:179], v[104:107]
s_waitcnt lgkmcnt(4)
ds_read_b128 a[176:179], v228
v_mfma_f32_16x16x32_bf16 v[48:51], v[124:127], v[136:139], v[48:51]
ds_read_b64_tr_b16 a[136:137], v223
ds_read_b64_tr_b16 a[138:139], v223 offset:6144
v_mfma_f32_16x16x32_bf16 v[52:55], v[124:127], v[140:143], v[52:55]
v_add_u32 v223, 12288, v223
v_mfma_f32_16x16x32_bf16 v[56:59], v[124:127], v[144:147], v[56:59]
buffer_load_dwordx4 v219, s[60:63], s10 offen offset:1024 lds
v_mfma_f32_16x16x32_bf16 v[60:63], v[124:127], v[148:151], v[60:63]
ds_read_b64_tr_b16 v[124:125], v224
ds_read_b64_tr_b16 v[126:127], v224 offset:6144
v_mfma_f32_16x16x32_bf16 v[64:67], v[128:131], v[136:139], v[64:67]
v_add_u32 v224, 4294819840, v224
v_mfma_f32_16x16x32_bf16 v[68:71], v[128:131], v[140:143], v[68:71]
v_mfma_f32_16x16x32_bf16 v[72:75], v[128:131], v[144:147], v[72:75]
v_mfma_f32_16x16x32_bf16 v[76:79], v[128:131], v[148:151], v[76:79]
ds_read_b64_tr_b16 v[128:129], v225
ds_read_b64_tr_b16 v[130:131], v225 offset:6144
v_mfma_f32_16x16x32_bf16 v[80:83], v[132:135], v[136:139], v[80:83]
ds_read_b128 v[136:139], v227
buffer_load_dwordx4 v220, s[60:63], s10 offen offset:2048 lds
v_mfma_f32_16x16x32_bf16 v[84:87], v[132:135], v[140:143], v[84:87]
ds_read_b128 v[140:143], v227 offset:4096
v_add_u32 v225, 4294819840, v225
v_mfma_f32_16x16x32_bf16 v[88:91], v[132:135], v[144:147], v[88:91]
ds_read_b128 v[144:147], v227 offset:8192
v_mfma_f32_16x16x32_bf16 v[92:95], v[132:135], v[148:151], v[92:95]
ds_read_b64_tr_b16 v[132:133], v226
ds_read_b64_tr_b16 v[134:135], v226 offset:6144
v_mfma_f32_16x16x32_bf16 v[0:3], a[140:143], a[160:163], v[0:3]
ds_read_b128 v[148:151], v227 offset:12288
v_add_u32 v226, 4294819840, v226
v_mfma_f32_16x16x32_bf16 v[4:7], a[140:143], a[164:167], v[4:7]
v_mfma_f32_16x16x32_bf16 v[8:11], a[140:143], a[168:171], v[8:11]
v_mfma_f32_16x16x32_bf16 v[12:15], a[140:143], a[172:175], v[12:15]
v_mfma_f32_16x16x32_bf16 v[96:99], a[140:143], a[180:183], v[96:99]
v_mfma_f32_16x16x32_bf16 v[16:19], a[144:147], a[160:163], v[16:19]
v_mfma_f32_16x16x32_bf16 v[20:23], a[144:147], a[164:167], v[20:23]
v_mfma_f32_16x16x32_bf16 v[24:27], a[144:147], a[168:171], v[24:27]
v_mfma_f32_16x16x32_bf16 v[28:31], a[144:147], a[172:175], v[28:31]
v_mfma_f32_16x16x32_bf16 v[100:103], a[144:147], a[180:183], v[100:103]
v_mfma_f32_16x16x32_bf16 v[32:35], a[148:151], a[160:163], v[32:35]
s_waitcnt vmcnt(6)
s_barrier
ds_read_b64_tr_b16 a[140:141], v221
v_mfma_f32_16x16x32_bf16 v[36:39], a[148:151], a[164:167], v[36:39]
ds_read_b64_tr_b16 a[142:143], v221 offset:6144
s_add_u32 m0, s82, 135168
s_mov_b32 s10, 147840
buffer_load_dwordx4 v218, s[60:63], s10 offen lds
v_mfma_f32_16x16x32_bf16 v[40:43], a[148:151], a[168:171], v[40:43]
ds_read_b64_tr_b16 a[144:145], v222
ds_read_b64_tr_b16 a[146:147], v222 offset:6144
v_mfma_f32_16x16x32_bf16 v[44:47], a[148:151], a[172:175], v[44:47]
v_add_u32 v221, 12288, v221
v_add_u32 v222, 12288, v222
v_mfma_f32_16x16x32_bf16 v[104:107], a[148:151], a[180:183], v[104:107]
s_waitcnt lgkmcnt(4)
ds_read_b128 a[180:183], v228 offset:1024
v_mfma_f32_16x16x32_bf16 v[48:51], v[124:127], a[160:163], v[48:51]
ds_read_b64_tr_b16 a[148:149], v223
ds_read_b64_tr_b16 a[150:151], v223 offset:6144
v_mfma_f32_16x16x32_bf16 v[52:55], v[124:127], a[164:167], v[52:55]
v_add_u32 v223, 12288, v223
v_mfma_f32_16x16x32_bf16 v[56:59], v[124:127], a[168:171], v[56:59]
buffer_load_dwordx4 v219, s[60:63], s10 offen offset:1024 lds
v_mfma_f32_16x16x32_bf16 v[60:63], v[124:127], a[172:175], v[60:63]
ds_read_b64_tr_b16 v[124:125], v224
ds_read_b64_tr_b16 v[126:127], v224 offset:6144
v_mfma_f32_16x16x32_bf16 v[64:67], v[128:131], a[160:163], v[64:67]
v_add_u32 v224, 12288, v224
v_mfma_f32_16x16x32_bf16 v[68:71], v[128:131], a[164:167], v[68:71]
v_mfma_f32_16x16x32_bf16 v[72:75], v[128:131], a[168:171], v[72:75]
v_mfma_f32_16x16x32_bf16 v[76:79], v[128:131], a[172:175], v[76:79]
ds_read_b64_tr_b16 v[128:129], v225
ds_read_b64_tr_b16 v[130:131], v225 offset:6144
v_mfma_f32_16x16x32_bf16 v[80:83], v[132:135], a[160:163], v[80:83]
ds_read_b128 a[160:163], v227 offset:1024
buffer_load_dwordx4 v220, s[60:63], s10 offen offset:2048 lds
v_mfma_f32_16x16x32_bf16 v[84:87], v[132:135], a[164:167], v[84:87]
ds_read_b128 a[164:167], v227 offset:5120
v_add_u32 v225, 12288, v225
v_mfma_f32_16x16x32_bf16 v[88:91], v[132:135], a[168:171], v[88:91]
ds_read_b128 a[168:171], v227 offset:9216
v_mfma_f32_16x16x32_bf16 v[92:95], v[132:135], a[172:175], v[92:95]
ds_read_b64_tr_b16 v[132:133], v226
ds_read_b64_tr_b16 v[134:135], v226 offset:6144
v_mfma_f32_16x16x32_bf16 a[0:3], a[128:131], v[136:139], 0
ds_read_b128 a[172:175], v227 offset:13312
v_add_u32 v226, 12288, v226
v_mfma_f32_16x16x32_bf16 a[4:7], a[128:131], v[140:143], 0
v_mfma_f32_16x16x32_bf16 a[8:11], a[128:131], v[144:147], 0
v_mfma_f32_16x16x32_bf16 a[12:15], a[128:131], v[148:151], 0
v_mfma_f32_16x16x32_bf16 a[96:99], a[128:131], a[176:179], 0
v_mfma_f32_16x16x32_bf16 a[16:19], a[132:135], v[136:139], 0
v_cvt_pk_bf16_f32 v176, v0, v1
v_mfma_f32_16x16x32_bf16 a[20:23], a[132:135], v[140:143], 0
v_cvt_pk_bf16_f32 v177, v2, v3
v_mfma_f32_16x16x32_bf16 a[24:27], a[132:135], v[144:147], 0
v_cvt_pk_bf16_f32 v178, v4, v5
v_mfma_f32_16x16x32_bf16 a[28:31], a[132:135], v[148:151], 0
v_cvt_pk_bf16_f32 v179, v6, v7
v_mfma_f32_16x16x32_bf16 a[100:103], a[132:135], a[176:179], 0
s_mov_b32 s11, 0
buffer_store_dwordx4 v[176:179], v229, s[64:67], s11 offen sc1
v_mfma_f32_16x16x32_bf16 a[32:35], a[136:139], v[136:139], 0
s_waitcnt vmcnt(7)
s_barrier
ds_read_b64_tr_b16 a[128:129], v221
v_mfma_f32_16x16x32_bf16 a[36:39], a[136:139], v[140:143], 0
ds_read_b64_tr_b16 a[130:131], v221 offset:6144
s_add_u32 m0, s82, 147456
s_mov_b32 s10, 184704
buffer_load_dwordx4 v218, s[60:63], s10 offen lds
v_mfma_f32_16x16x32_bf16 a[40:43], a[136:139], v[144:147], 0
ds_read_b64_tr_b16 a[132:133], v222
ds_read_b64_tr_b16 a[134:135], v222 offset:6144
v_mfma_f32_16x16x32_bf16 a[44:47], a[136:139], v[148:151], 0
v_add_u32 v221, 12288, v221
v_add_u32 v222, 12288, v222
v_mfma_f32_16x16x32_bf16 a[104:107], a[136:139], a[176:179], 0
s_waitcnt lgkmcnt(4)
ds_read_b128 a[176:179], v228 offset:2048
v_mfma_f32_16x16x32_bf16 a[48:51], v[124:127], v[136:139], 0
ds_read_b64_tr_b16 a[136:137], v223
ds_read_b64_tr_b16 a[138:139], v223 offset:6144
v_mfma_f32_16x16x32_bf16 a[52:55], v[124:127], v[140:143], 0
v_add_u32 v223, 12288, v223
v_cvt_pk_bf16_f32 v180, v8, v9
v_mfma_f32_16x16x32_bf16 a[56:59], v[124:127], v[144:147], 0
buffer_load_dwordx4 v219, s[60:63], s10 offen offset:1024 lds
v_mfma_f32_16x16x32_bf16 a[60:63], v[124:127], v[148:151], 0
ds_read_b64_tr_b16 v[124:125], v224
ds_read_b64_tr_b16 v[126:127], v224 offset:6144
v_mfma_f32_16x16x32_bf16 a[64:67], v[128:131], v[136:139], 0
v_add_u32 v224, 12288, v224
v_cvt_pk_bf16_f32 v181, v10, v11
v_mfma_f32_16x16x32_bf16 a[68:71], v[128:131], v[140:143], 0
v_cvt_pk_bf16_f32 v182, v12, v13
v_mfma_f32_16x16x32_bf16 a[72:75], v[128:131], v[144:147], 0
v_cvt_pk_bf16_f32 v183, v14, v15
v_mfma_f32_16x16x32_bf16 a[76:79], v[128:131], v[148:151], 0
ds_read_b64_tr_b16 v[128:129], v225
ds_read_b64_tr_b16 v[130:131], v225 offset:6144
v_mfma_f32_16x16x32_bf16 a[80:83], v[132:135], v[136:139], 0
ds_read_b128 v[136:139], v227 offset:2048
buffer_load_dwordx4 v220, s[60:63], s10 offen offset:2048 lds
v_mfma_f32_16x16x32_bf16 a[84:87], v[132:135], v[140:143], 0
ds_read_b128 v[140:143], v227 offset:6144
v_add_u32 v225, 12288, v225
v_mfma_f32_16x16x32_bf16 a[88:91], v[132:135], v[144:147], 0
ds_read_b128 v[144:147], v227 offset:10240
v_mfma_f32_16x16x32_bf16 a[92:95], v[132:135], v[148:151], 0
ds_read_b64_tr_b16 v[132:133], v226
ds_read_b64_tr_b16 v[134:135], v226 offset:6144
v_mfma_f32_16x16x32_bf16 a[0:3], a[140:143], a[160:163], a[0:3]
ds_read_b128 v[148:151], v227 offset:14336
v_add_u32 v226, 12288, v226
v_mfma_f32_16x16x32_bf16 a[4:7], a[140:143], a[164:167], a[4:7]
s_mov_b32 s11, 589824
buffer_store_dwordx4 v[180:183], v229, s[64:67], s11 offen sc1
v_mfma_f32_16x16x32_bf16 a[8:11], a[140:143], a[168:171], a[8:11]
v_cvt_pk_bf16_f32 v200, v16, v17
v_mfma_f32_16x16x32_bf16 a[12:15], a[140:143], a[172:175], a[12:15]
v_cvt_pk_bf16_f32 v201, v18, v19
v_mfma_f32_16x16x32_bf16 a[96:99], a[140:143], a[180:183], a[96:99]
v_cvt_pk_bf16_f32 v202, v20, v21
v_mfma_f32_16x16x32_bf16 a[16:19], a[144:147], a[160:163], a[16:19]
v_cvt_pk_bf16_f32 v203, v22, v23
v_mfma_f32_16x16x32_bf16 a[20:23], a[144:147], a[164:167], a[20:23]
v_mfma_f32_16x16x32_bf16 a[24:27], a[144:147], a[168:171], a[24:27]
s_mov_b32 s11, 16384
buffer_store_dwordx4 v[200:203], v229, s[64:67], s11 offen sc1
v_mfma_f32_16x16x32_bf16 a[28:31], a[144:147], a[172:175], a[28:31]
v_cvt_pk_bf16_f32 v204, v24, v25
v_mfma_f32_16x16x32_bf16 a[100:103], a[144:147], a[180:183], a[100:103]
v_cvt_pk_bf16_f32 v205, v26, v27
v_mfma_f32_16x16x32_bf16 a[32:35], a[148:151], a[160:163], a[32:35]
s_waitcnt vmcnt(9)
s_barrier
ds_read_b64_tr_b16 a[140:141], v221
v_mfma_f32_16x16x32_bf16 a[36:39], a[148:151], a[164:167], a[36:39]
ds_read_b64_tr_b16 a[142:143], v221 offset:6144
s_add_u32 m0, s82, 0
s_mov_b32 s10, 221568
buffer_load_dwordx4 v218, s[60:63], s10 offen lds
v_mfma_f32_16x16x32_bf16 a[40:43], a[148:151], a[168:171], a[40:43]
ds_read_b64_tr_b16 a[144:145], v222
ds_read_b64_tr_b16 a[146:147], v222 offset:6144
v_mfma_f32_16x16x32_bf16 a[44:47], a[148:151], a[172:175], a[44:47]
v_add_u32 v221, 98304, v221
v_add_u32 v222, 98304, v222
v_mfma_f32_16x16x32_bf16 a[104:107], a[148:151], a[180:183], a[104:107]
s_waitcnt lgkmcnt(3)
ds_read_b128 a[180:183], v228 offset:3072
v_cvt_pk_bf16_f32 v206, v28, v29
v_mfma_f32_16x16x32_bf16 a[48:51], v[124:127], a[160:163], a[48:51]
ds_read_b64_tr_b16 a[148:149], v223
ds_read_b64_tr_b16 a[150:151], v223 offset:6144
v_mfma_f32_16x16x32_bf16 a[52:55], v[124:127], a[164:167], a[52:55]
v_add_u32 v223, 98304, v223
v_mfma_f32_16x16x32_bf16 a[56:59], v[124:127], a[168:171], a[56:59]
buffer_load_dwordx4 v219, s[60:63], s10 offen offset:1024 lds
v_cvt_pk_bf16_f32 v207, v30, v31
v_mfma_f32_16x16x32_bf16 a[60:63], v[124:127], a[172:175], a[60:63]
ds_read_b64_tr_b16 v[124:125], v224
ds_read_b64_tr_b16 v[126:127], v224 offset:6144
v_mfma_f32_16x16x32_bf16 a[64:67], v[128:131], a[160:163], a[64:67]
v_add_u32 v224, 12288, v224
v_mfma_f32_16x16x32_bf16 a[68:71], v[128:131], a[164:167], a[68:71]
s_mov_b32 s11, 606208
buffer_store_dwordx4 v[204:207], v229, s[64:67], s11 offen sc1
v_mfma_f32_16x16x32_bf16 a[72:75], v[128:131], a[168:171], a[72:75]
v_mfma_f32_16x16x32_bf16 a[76:79], v[128:131], a[172:175], a[76:79]
ds_read_b64_tr_b16 v[128:129], v225
ds_read_b64_tr_b16 v[130:131], v225 offset:6144
v_cvt_pk_bf16_f32 v176, v32, v33
v_mfma_f32_16x16x32_bf16 a[80:83], v[132:135], a[160:163], a[80:83]
ds_read_b128 a[160:163], v227 offset:3072
buffer_load_dwordx4 v220, s[60:63], s10 offen offset:2048 lds
v_mfma_f32_16x16x32_bf16 a[84:87], v[132:135], a[164:167], a[84:87]
ds_read_b128 a[164:167], v227 offset:7168
v_add_u32 v225, 12288, v225
v_mfma_f32_16x16x32_bf16 a[88:91], v[132:135], a[168:171], a[88:91]
ds_read_b128 a[168:171], v227 offset:11264
v_mfma_f32_16x16x32_bf16 a[92:95], v[132:135], a[172:175], a[92:95]
ds_read_b64_tr_b16 v[132:133], v226
ds_read_b64_tr_b16 v[134:135], v226 offset:6144
v_mfma_f32_16x16x32_bf16 a[0:3], a[128:131], v[136:139], a[0:3]
ds_read_b128 a[172:175], v227 offset:15360
v_add_u32 v226, 12288, v226
v_mfma_f32_16x16x32_bf16 a[4:7], a[128:131], v[140:143], a[4:7]
v_cvt_pk_bf16_f32 v177, v34, v35
v_mfma_f32_16x16x32_bf16 a[8:11], a[128:131], v[144:147], a[8:11]
v_cvt_pk_bf16_f32 v178, v36, v37
v_mfma_f32_16x16x32_bf16 a[12:15], a[128:131], v[148:151], a[12:15]
v_cvt_pk_bf16_f32 v179, v38, v39
v_mfma_f32_16x16x32_bf16 a[96:99], a[128:131], a[176:179], a[96:99]
s_mov_b32 s11, 32768
buffer_store_dwordx4 v[176:179], v229, s[64:67], s11 offen sc1
v_mfma_f32_16x16x32_bf16 a[16:19], a[132:135], v[136:139], a[16:19]
v_mfma_f32_16x16x32_bf16 a[20:23], a[132:135], v[140:143], a[20:23]
v_cvt_pk_bf16_f32 v180, v40, v41
v_mfma_f32_16x16x32_bf16 a[24:27], a[132:135], v[144:147], a[24:27]
v_cvt_pk_bf16_f32 v181, v42, v43
v_mfma_f32_16x16x32_bf16 a[28:31], a[132:135], v[148:151], a[28:31]
v_cvt_pk_bf16_f32 v182, v44, v45
v_mfma_f32_16x16x32_bf16 a[100:103], a[132:135], a[176:179], a[100:103]
v_cvt_pk_bf16_f32 v183, v46, v47
v_mfma_f32_16x16x32_bf16 a[32:35], a[136:139], v[136:139], a[32:35]
s_waitcnt vmcnt(11)
s_barrier
ds_read_b64_tr_b16 a[128:129], v221
v_mfma_f32_16x16x32_bf16 a[36:39], a[136:139], v[140:143], a[36:39]
ds_read_b64_tr_b16 a[130:131], v221 offset:6144
s_add_u32 m0, s82, 12288
s_mov_b32 s10, 258432
buffer_load_dwordx4 v218, s[60:63], s10 offen lds
v_mfma_f32_16x16x32_bf16 a[40:43], a[136:139], v[144:147], a[40:43]
ds_read_b64_tr_b16 a[132:133], v222
ds_read_b64_tr_b16 a[134:135], v222 offset:6144
v_mfma_f32_16x16x32_bf16 a[44:47], a[136:139], v[148:151], a[44:47]
v_add_u32 v221, 12288, v221
v_add_u32 v222, 12288, v222
v_mfma_f32_16x16x32_bf16 a[104:107], a[136:139], a[176:179], a[104:107]
s_waitcnt lgkmcnt(3)
ds_read_b128 a[176:179], v228 offset:4096
s_mov_b32 s11, 622592
buffer_store_dwordx4 v[180:183], v229, s[64:67], s11 offen sc1
v_mfma_f32_16x16x32_bf16 a[48:51], v[124:127], v[136:139], a[48:51]
ds_read_b64_tr_b16 a[136:137], v223
ds_read_b64_tr_b16 a[138:139], v223 offset:6144
v_mfma_f32_16x16x32_bf16 a[52:55], v[124:127], v[140:143], a[52:55]
v_add_u32 v223, 12288, v223
v_mfma_f32_16x16x32_bf16 a[56:59], v[124:127], v[144:147], a[56:59]
buffer_load_dwordx4 v219, s[60:63], s10 offen offset:1024 lds
v_cvt_pk_bf16_f32 v200, v48, v49
v_mfma_f32_16x16x32_bf16 a[60:63], v[124:127], v[148:151], a[60:63]
ds_read_b64_tr_b16 v[124:125], v224
ds_read_b64_tr_b16 v[126:127], v224 offset:6144
v_mfma_f32_16x16x32_bf16 a[64:67], v[128:131], v[136:139], a[64:67]
v_add_u32 v224, 98304, v224
v_mfma_f32_16x16x32_bf16 a[68:71], v[128:131], v[140:143], a[68:71]
v_cvt_pk_bf16_f32 v201, v50, v51
v_mfma_f32_16x16x32_bf16 a[72:75], v[128:131], v[144:147], a[72:75]
v_cvt_pk_bf16_f32 v202, v52, v53
v_mfma_f32_16x16x32_bf16 a[76:79], v[128:131], v[148:151], a[76:79]
ds_read_b64_tr_b16 v[128:129], v225
ds_read_b64_tr_b16 v[130:131], v225 offset:6144
v_mfma_f32_16x16x32_bf16 a[80:83], v[132:135], v[136:139], a[80:83]
ds_read_b128 v[136:139], v227 offset:32768
buffer_load_dwordx4 v220, s[60:63], s10 offen offset:2048 lds
v_mfma_f32_16x16x32_bf16 a[84:87], v[132:135], v[140:143], a[84:87]
ds_read_b128 v[140:143], v227 offset:36864
v_add_u32 v225, 98304, v225
v_mfma_f32_16x16x32_bf16 a[88:91], v[132:135], v[144:147], a[88:91]
ds_read_b128 v[144:147], v227 offset:40960
v_cvt_pk_bf16_f32 v203, v54, v55
v_mfma_f32_16x16x32_bf16 a[92:95], v[132:135], v[148:151], a[92:95]
ds_read_b64_tr_b16 v[132:133], v226
ds_read_b64_tr_b16 v[134:135], v226 offset:6144
v_mfma_f32_16x16x32_bf16 a[0:3], a[140:143], a[160:163], a[0:3]
ds_read_b128 v[148:151], v227 offset:45056
v_add_u32 v226, 98304, v226
v_mfma_f32_16x16x32_bf16 a[4:7], a[140:143], a[164:167], a[4:7]
v_mfma_f32_16x16x32_bf16 a[8:11], a[140:143], a[168:171], a[8:11]
s_mov_b32 s11, 0
buffer_store_dwordx4 v[200:203], v230, s[64:67], s11 offen sc1
v_mfma_f32_16x16x32_bf16 a[12:15], a[140:143], a[172:175], a[12:15]
v_cvt_pk_bf16_f32 v204, v56, v57
v_mfma_f32_16x16x32_bf16 a[96:99], a[140:143], a[180:183], a[96:99]
v_cvt_pk_bf16_f32 v205, v58, v59
v_mfma_f32_16x16x32_bf16 a[16:19], a[144:147], a[160:163], a[16:19]
v_cvt_pk_bf16_f32 v206, v60, v61
v_mfma_f32_16x16x32_bf16 a[20:23], a[144:147], a[164:167], a[20:23]
v_cvt_pk_bf16_f32 v207, v62, v63
v_mfma_f32_16x16x32_bf16 a[24:27], a[144:147], a[168:171], a[24:27]
s_mov_b32 s11, 589824
buffer_store_dwordx4 v[204:207], v230, s[64:67], s11 offen sc1
v_mfma_f32_16x16x32_bf16 a[28:31], a[144:147], a[172:175], a[28:31]
v_mfma_f32_16x16x32_bf16 a[100:103], a[144:147], a[180:183], a[100:103]
v_cvt_pk_bf16_f32 v176, v64, v65
v_mfma_f32_16x16x32_bf16 a[32:35], a[148:151], a[160:163], a[32:35]
s_waitcnt vmcnt(13)
s_barrier
ds_read_b64_tr_b16 a[140:141], v221
v_mfma_f32_16x16x32_bf16 a[36:39], a[148:151], a[164:167], a[36:39]
ds_read_b64_tr_b16 a[142:143], v221 offset:6144
s_add_u32 m0, s82, 24576
s_mov_b32 s10, 768
buffer_load_dwordx4 v218, s[60:63], s10 offen lds
v_mfma_f32_16x16x32_bf16 a[40:43], a[148:151], a[168:171], a[40:43]
ds_read_b64_tr_b16 a[144:145], v222
ds_read_b64_tr_b16 a[146:147], v222 offset:6144
v_mfma_f32_16x16x32_bf16 a[44:47], a[148:151], a[172:175], a[44:47]
v_add_u32 v221, 4294819840, v221
v_add_u32 v222, 4294819840, v222
v_cvt_pk_bf16_f32 v177, v66, v67
v_mfma_f32_16x16x32_bf16 a[104:107], a[148:151], a[180:183], a[104:107]
s_waitcnt lgkmcnt(3)
ds_read_b128 a[180:183], v228 offset:5120
v_mfma_f32_16x16x32_bf16 a[48:51], v[124:127], a[160:163], a[48:51]
ds_read_b64_tr_b16 a[148:149], v223
ds_read_b64_tr_b16 a[150:151], v223 offset:6144
v_mfma_f32_16x16x32_bf16 a[52:55], v[124:127], a[164:167], a[52:55]
v_add_u32 v223, 4294819840, v223
v_cvt_pk_bf16_f32 v178, v68, v69
v_mfma_f32_16x16x32_bf16 a[56:59], v[124:127], a[168:171], a[56:59]
buffer_load_dwordx4 v219, s[60:63], s10 offen offset:1024 lds
v_mfma_f32_16x16x32_bf16 a[60:63], v[124:127], a[172:175], a[60:63]
ds_read_b64_tr_b16 v[124:125], v224
ds_read_b64_tr_b16 v[126:127], v224 offset:6144
v_mfma_f32_16x16x32_bf16 a[64:67], v[128:131], a[160:163], a[64:67]
v_add_u32 v224, 12288, v224
v_cvt_pk_bf16_f32 v179, v70, v71
v_mfma_f32_16x16x32_bf16 a[68:71], v[128:131], a[164:167], a[68:71]
v_mfma_f32_16x16x32_bf16 a[72:75], v[128:131], a[168:171], a[72:75]
s_mov_b32 s11, 16384
buffer_store_dwordx4 v[176:179], v230, s[64:67], s11 offen sc1
v_mfma_f32_16x16x32_bf16 a[76:79], v[128:131], a[172:175], a[76:79]
ds_read_b64_tr_b16 v[128:129], v225
ds_read_b64_tr_b16 v[130:131], v225 offset:6144
v_mfma_f32_16x16x32_bf16 a[80:83], v[132:135], a[160:163], a[80:83]
ds_read_b128 a[160:163], v227 offset:33792
buffer_load_dwordx4 v220, s[60:63], s10 offen offset:2048 lds
v_mfma_f32_16x16x32_bf16 a[84:87], v[132:135], a[164:167], a[84:87]
ds_read_b128 a[164:167], v227 offset:37888
v_add_u32 v225, 12288, v225
v_mfma_f32_16x16x32_bf16 a[88:91], v[132:135], a[168:171], a[88:91]
ds_read_b128 a[168:171], v227 offset:41984
v_cvt_pk_bf16_f32 v180, v72, v73
v_mfma_f32_16x16x32_bf16 a[92:95], v[132:135], a[172:175], a[92:95]
ds_read_b64_tr_b16 v[132:133], v226
ds_read_b64_tr_b16 v[134:135], v226 offset:6144
v_mfma_f32_16x16x32_bf16 a[0:3], a[128:131], v[136:139], a[0:3]
ds_read_b128 a[172:175], v227 offset:46080
v_add_u32 v226, 12288, v226
v_mfma_f32_16x16x32_bf16 a[4:7], a[128:131], v[140:143], a[4:7]
v_cvt_pk_bf16_f32 v181, v74, v75
v_mfma_f32_16x16x32_bf16 a[8:11], a[128:131], v[144:147], a[8:11]
v_cvt_pk_bf16_f32 v182, v76, v77
v_mfma_f32_16x16x32_bf16 a[12:15], a[128:131], v[148:151], a[12:15]
v_cvt_pk_bf16_f32 v183, v78, v79
v_mfma_f32_16x16x32_bf16 a[96:99], a[128:131], a[176:179], a[96:99]
v_mfma_f32_16x16x32_bf16 a[16:19], a[132:135], v[136:139], a[16:19]
s_mov_b32 s11, 606208
buffer_store_dwordx4 v[180:183], v230, s[64:67], s11 offen sc1
v_mfma_f32_16x16x32_bf16 a[20:23], a[132:135], v[140:143], a[20:23]
v_cvt_pk_bf16_f32 v200, v80, v81
v_mfma_f32_16x16x32_bf16 a[24:27], a[132:135], v[144:147], a[24:27]
v_cvt_pk_bf16_f32 v201, v82, v83
v_mfma_f32_16x16x32_bf16 a[28:31], a[132:135], v[148:151], a[28:31]
v_cvt_pk_bf16_f32 v202, v84, v85
v_mfma_f32_16x16x32_bf16 a[100:103], a[132:135], a[176:179], a[100:103]
v_cvt_pk_bf16_f32 v203, v86, v87
v_mfma_f32_16x16x32_bf16 a[32:35], a[136:139], v[136:139], a[32:35]
s_waitcnt vmcnt(12)
s_barrier
ds_read_b64_tr_b16 a[128:129], v221
v_mfma_f32_16x16x32_bf16 a[36:39], a[136:139], v[140:143], a[36:39]
ds_read_b64_tr_b16 a[130:131], v221 offset:6144
s_add_u32 m0, s82, 36864
s_mov_b32 s10, 37632
buffer_load_dwordx4 v218, s[60:63], s10 offen lds
v_mfma_f32_16x16x32_bf16 a[40:43], a[136:139], v[144:147], a[40:43]
ds_read_b64_tr_b16 a[132:133], v222
ds_read_b64_tr_b16 a[134:135], v222 offset:6144
v_mfma_f32_16x16x32_bf16 a[44:47], a[136:139], v[148:151], a[44:47]
v_add_u32 v221, 12288, v221
v_add_u32 v222, 12288, v222
v_mfma_f32_16x16x32_bf16 a[104:107], a[136:139], a[176:179], a[104:107]
s_waitcnt lgkmcnt(4)
ds_read_b128 a[176:179], v228 offset:6144
v_mfma_f32_16x16x32_bf16 a[48:51], v[124:127], v[136:139], a[48:51]
ds_read_b64_tr_b16 a[136:137], v223
ds_read_b64_tr_b16 a[138:139], v223 offset:6144
v_mfma_f32_16x16x32_bf16 a[52:55], v[124:127], v[140:143], a[52:55]
v_add_u32 v223, 12288, v223
s_mov_b32 s11, 32768
buffer_store_dwordx4 v[200:203], v230, s[64:67], s11 offen sc1
v_mfma_f32_16x16x32_bf16 a[56:59], v[124:127], v[144:147], a[56:59]
buffer_load_dwordx4 v219, s[60:63], s10 offen offset:1024 lds
v_mfma_f32_16x16x32_bf16 a[60:63], v[124:127], v[148:151], a[60:63]
ds_read_b64_tr_b16 v[124:125], v224
ds_read_b64_tr_b16 v[126:127], v224 offset:6144
v_mfma_f32_16x16x32_bf16 a[64:67], v[128:131], v[136:139], a[64:67]
v_add_u32 v224, 4294819840, v224
v_mfma_f32_16x16x32_bf16 a[68:71], v[128:131], v[140:143], a[68:71]
v_cvt_pk_bf16_f32 v204, v88, v89
v_mfma_f32_16x16x32_bf16 a[72:75], v[128:131], v[144:147], a[72:75]
v_cvt_pk_bf16_f32 v205, v90, v91
v_mfma_f32_16x16x32_bf16 a[76:79], v[128:131], v[148:151], a[76:79]
ds_read_b64_tr_b16 v[128:129], v225
ds_read_b64_tr_b16 v[130:131], v225 offset:6144
v_cvt_pk_bf16_f32 v206, v92, v93
v_mfma_f32_16x16x32_bf16 a[80:83], v[132:135], v[136:139], a[80:83]
ds_read_b128 v[136:139], v227 offset:34816
buffer_load_dwordx4 v220, s[60:63], s10 offen offset:2048 lds
v_mfma_f32_16x16x32_bf16 a[84:87], v[132:135], v[140:143], a[84:87]
ds_read_b128 v[140:143], v227 offset:38912
v_add_u32 v225, 4294819840, v225
v_mfma_f32_16x16x32_bf16 a[88:91], v[132:135], v[144:147], a[88:91]
ds_read_b128 v[144:147], v227 offset:43008
v_mfma_f32_16x16x32_bf16 a[92:95], v[132:135], v[148:151], a[92:95]
ds_read_b64_tr_b16 v[132:133], v226
ds_read_b64_tr_b16 v[134:135], v226 offset:6144
v_mfma_f32_16x16x32_bf16 a[0:3], a[140:143], a[160:163], a[0:3]
ds_read_b128 v[148:151], v227 offset:47104
v_add_u32 v226, 4294819840, v226
v_mfma_f32_16x16x32_bf16 a[4:7], a[140:143], a[164:167], a[4:7]
v_cvt_pk_bf16_f32 v207, v94, v95
v_mfma_f32_16x16x32_bf16 a[8:11], a[140:143], a[168:171], a[8:11]
s_mov_b32 s11, 622592
buffer_store_dwordx4 v[204:207], v230, s[64:67], s11 offen sc1
v_mfma_f32_16x16x32_bf16 a[12:15], a[140:143], a[172:175], a[12:15]
v_mfma_f32_16x16x32_bf16 a[96:99], a[140:143], a[180:183], a[96:99]
v_cvt_pk_bf16_f32 v176, v96, v97
v_mfma_f32_16x16x32_bf16 a[16:19], a[144:147], a[160:163], a[16:19]
v_cvt_pk_bf16_f32 v177, v98, v99
v_mfma_f32_16x16x32_bf16 a[20:23], a[144:147], a[164:167], a[20:23]
s_mov_b32 s11, 0
buffer_store_dwordx2 v[176:177], v231, s[64:67], s11 offen sc1
v_mfma_f32_16x16x32_bf16 a[24:27], a[144:147], a[168:171], a[24:27]
v_mfma_f32_16x16x32_bf16 a[28:31], a[144:147], a[172:175], a[28:31]
v_cvt_pk_bf16_f32 v178, v100, v101
v_mfma_f32_16x16x32_bf16 a[100:103], a[144:147], a[180:183], a[100:103]
v_cvt_pk_bf16_f32 v179, v102, v103
v_mfma_f32_16x16x32_bf16 a[32:35], a[148:151], a[160:163], a[32:35]
s_waitcnt vmcnt(13)
s_barrier
ds_read_b64_tr_b16 a[140:141], v221
v_mfma_f32_16x16x32_bf16 a[36:39], a[148:151], a[164:167], a[36:39]
ds_read_b64_tr_b16 a[142:143], v221 offset:6144
s_add_u32 m0, s82, 135168
s_mov_b32 s10, 74496
buffer_load_dwordx4 v218, s[60:63], s10 offen lds
v_mfma_f32_16x16x32_bf16 a[40:43], a[148:151], a[168:171], a[40:43]
ds_read_b64_tr_b16 a[144:145], v222
ds_read_b64_tr_b16 a[146:147], v222 offset:6144
v_mfma_f32_16x16x32_bf16 a[44:47], a[148:151], a[172:175], a[44:47]
v_add_u32 v221, 12288, v221
v_add_u32 v222, 12288, v222
v_mfma_f32_16x16x32_bf16 a[104:107], a[148:151], a[180:183], a[104:107]
s_waitcnt lgkmcnt(3)
ds_read_b128 a[180:183], v228 offset:7168
s_mov_b32 s11, 8192
buffer_store_dwordx2 v[178:179], v231, s[64:67], s11 offen sc1
v_mfma_f32_16x16x32_bf16 a[48:51], v[124:127], a[160:163], a[48:51]
ds_read_b64_tr_b16 a[148:149], v223
ds_read_b64_tr_b16 a[150:151], v223 offset:6144
v_mfma_f32_16x16x32_bf16 a[52:55], v[124:127], a[164:167], a[52:55]
v_add_u32 v223, 12288, v223
v_mfma_f32_16x16x32_bf16 a[56:59], v[124:127], a[168:171], a[56:59]
buffer_load_dwordx4 v219, s[60:63], s10 offen offset:1024 lds
v_cvt_pk_bf16_f32 v180, v104, v105
v_mfma_f32_16x16x32_bf16 a[60:63], v[124:127], a[172:175], a[60:63]
ds_read_b64_tr_b16 v[124:125], v224
ds_read_b64_tr_b16 v[126:127], v224 offset:6144
v_mfma_f32_16x16x32_bf16 a[64:67], v[128:131], a[160:163], a[64:67]
v_add_u32 v224, 12288, v224
v_mfma_f32_16x16x32_bf16 a[68:71], v[128:131], a[164:167], a[68:71]
v_cvt_pk_bf16_f32 v181, v106, v107
v_mfma_f32_16x16x32_bf16 a[72:75], v[128:131], a[168:171], a[72:75]
s_mov_b32 s11, 16384
buffer_store_dwordx2 v[180:181], v231, s[64:67], s11 offen sc1
v_mfma_f32_16x16x32_bf16 a[76:79], v[128:131], a[172:175], a[76:79]
ds_read_b64_tr_b16 v[128:129], v225
ds_read_b64_tr_b16 v[130:131], v225 offset:6144
v_mfma_f32_16x16x32_bf16 a[80:83], v[132:135], a[160:163], a[80:83]
ds_read_b128 a[160:163], v227 offset:35840
buffer_load_dwordx4 v220, s[60:63], s10 offen offset:2048 lds
v_mfma_f32_16x16x32_bf16 a[84:87], v[132:135], a[164:167], a[84:87]
ds_read_b128 a[164:167], v227 offset:39936
v_add_u32 v225, 12288, v225
v_mfma_f32_16x16x32_bf16 a[88:91], v[132:135], a[168:171], a[88:91]
ds_read_b128 a[168:171], v227 offset:44032
v_mfma_f32_16x16x32_bf16 a[92:95], v[132:135], a[172:175], a[92:95]
ds_read_b64_tr_b16 v[132:133], v226
ds_read_b64_tr_b16 v[134:135], v226 offset:6144
v_mfma_f32_16x16x32_bf16 a[0:3], a[128:131], v[136:139], a[0:3]
ds_read_b128 a[172:175], v227 offset:48128
v_add_u32 v226, 12288, v226
v_mfma_f32_16x16x32_bf16 a[4:7], a[128:131], v[140:143], a[4:7]
v_mfma_f32_16x16x32_bf16 a[8:11], a[128:131], v[144:147], a[8:11]
v_mfma_f32_16x16x32_bf16 a[12:15], a[128:131], v[148:151], a[12:15]
v_mfma_f32_16x16x32_bf16 a[96:99], a[128:131], a[176:179], a[96:99]
v_mfma_f32_16x16x32_bf16 a[16:19], a[132:135], v[136:139], a[16:19]
v_mfma_f32_16x16x32_bf16 a[20:23], a[132:135], v[140:143], a[20:23]
v_mfma_f32_16x16x32_bf16 a[24:27], a[132:135], v[144:147], a[24:27]
v_mfma_f32_16x16x32_bf16 a[28:31], a[132:135], v[148:151], a[28:31]
v_mfma_f32_16x16x32_bf16 a[100:103], a[132:135], a[176:179], a[100:103]
v_mfma_f32_16x16x32_bf16 a[32:35], a[136:139], v[136:139], a[32:35]
s_waitcnt vmcnt(12)
s_barrier
ds_read_b64_tr_b16 a[128:129], v221
v_mfma_f32_16x16x32_bf16 a[36:39], a[136:139], v[140:143], a[36:39]
ds_read_b64_tr_b16 a[130:131], v221 offset:6144
s_add_u32 m0, s82, 147456
s_mov_b32 s10, 111360
buffer_load_dwordx4 v218, s[60:63], s10 offen lds
v_mfma_f32_16x16x32_bf16 a[40:43], a[136:139], v[144:147], a[40:43]
ds_read_b64_tr_b16 a[132:133], v222
ds_read_b64_tr_b16 a[134:135], v222 offset:6144
v_mfma_f32_16x16x32_bf16 a[44:47], a[136:139], v[148:151], a[44:47]
v_add_u32 v221, 12288, v221
v_add_u32 v222, 12288, v222
v_mfma_f32_16x16x32_bf16 a[104:107], a[136:139], a[176:179], a[104:107]
s_waitcnt lgkmcnt(4)
ds_read_b128 a[176:179], v228
v_mfma_f32_16x16x32_bf16 a[48:51], v[124:127], v[136:139], a[48:51]
ds_read_b64_tr_b16 a[136:137], v223
ds_read_b64_tr_b16 a[138:139], v223 offset:6144
v_mfma_f32_16x16x32_bf16 a[52:55], v[124:127], v[140:143], a[52:55]
v_add_u32 v223, 12288, v223
v_mfma_f32_16x16x32_bf16 a[56:59], v[124:127], v[144:147], a[56:59]
buffer_load_dwordx4 v219, s[60:63], s10 offen offset:1024 lds
v_mfma_f32_16x16x32_bf16 a[60:63], v[124:127], v[148:151], a[60:63]
ds_read_b64_tr_b16 v[124:125], v224
ds_read_b64_tr_b16 v[126:127], v224 offset:6144
v_mfma_f32_16x16x32_bf16 a[64:67], v[128:131], v[136:139], a[64:67]
v_add_u32 v224, 12288, v224
v_mfma_f32_16x16x32_bf16 a[68:71], v[128:131], v[140:143], a[68:71]
v_mfma_f32_16x16x32_bf16 a[72:75], v[128:131], v[144:147], a[72:75]
v_mfma_f32_16x16x32_bf16 a[76:79], v[128:131], v[148:151], a[76:79]
ds_read_b64_tr_b16 v[128:129], v225
ds_read_b64_tr_b16 v[130:131], v225 offset:6144
v_mfma_f32_16x16x32_bf16 a[80:83], v[132:135], v[136:139], a[80:83]
ds_read_b128 v[136:139], v227
buffer_load_dwordx4 v220, s[60:63], s10 offen offset:2048 lds
v_mfma_f32_16x16x32_bf16 a[84:87], v[132:135], v[140:143], a[84:87]
ds_read_b128 v[140:143], v227 offset:4096
v_add_u32 v225, 12288, v225
v_mfma_f32_16x16x32_bf16 a[88:91], v[132:135], v[144:147], a[88:91]
ds_read_b128 v[144:147], v227 offset:8192
v_mfma_f32_16x16x32_bf16 a[92:95], v[132:135], v[148:151], a[92:95]
ds_read_b64_tr_b16 v[132:133], v226
ds_read_b64_tr_b16 v[134:135], v226 offset:6144
v_mfma_f32_16x16x32_bf16 a[0:3], a[140:143], a[160:163], a[0:3]
ds_read_b128 v[148:151], v227 offset:12288
v_add_u32 v226, 12288, v226
v_mfma_f32_16x16x32_bf16 a[4:7], a[140:143], a[164:167], a[4:7]
v_mfma_f32_16x16x32_bf16 a[8:11], a[140:143], a[168:171], a[8:11]
v_mfma_f32_16x16x32_bf16 a[12:15], a[140:143], a[172:175], a[12:15]
v_mfma_f32_16x16x32_bf16 a[96:99], a[140:143], a[180:183], a[96:99]
v_mfma_f32_16x16x32_bf16 a[16:19], a[144:147], a[160:163], a[16:19]
v_mfma_f32_16x16x32_bf16 a[20:23], a[144:147], a[164:167], a[20:23]
v_mfma_f32_16x16x32_bf16 a[24:27], a[144:147], a[168:171], a[24:27]
v_mfma_f32_16x16x32_bf16 a[28:31], a[144:147], a[172:175], a[28:31]
v_mfma_f32_16x16x32_bf16 a[100:103], a[144:147], a[180:183], a[100:103]
v_mfma_f32_16x16x32_bf16 a[32:35], a[148:151], a[160:163], a[32:35]
s_waitcnt vmcnt(10)
s_barrier
ds_read_b64_tr_b16 a[140:141], v221
v_mfma_f32_16x16x32_bf16 a[36:39], a[148:151], a[164:167], a[36:39]
ds_read_b64_tr_b16 a[142:143], v221 offset:6144
s_add_u32 m0, s82, 0
s_mov_b32 s10, 148224
buffer_load_dwordx4 v218, s[60:63], s10 offen lds
v_mfma_f32_16x16x32_bf16 a[40:43], a[148:151], a[168:171], a[40:43]
ds_read_b64_tr_b16 a[144:145], v222
ds_read_b64_tr_b16 a[146:147], v222 offset:6144
v_mfma_f32_16x16x32_bf16 a[44:47], a[148:151], a[172:175], a[44:47]
v_add_u32 v221, 98304, v221
v_add_u32 v222, 98304, v222
v_mfma_f32_16x16x32_bf16 a[104:107], a[148:151], a[180:183], a[104:107]
s_waitcnt lgkmcnt(4)
ds_read_b128 a[180:183], v228 offset:1024
v_mfma_f32_16x16x32_bf16 a[48:51], v[124:127], a[160:163], a[48:51]
ds_read_b64_tr_b16 a[148:149], v223
ds_read_b64_tr_b16 a[150:151], v223 offset:6144
v_mfma_f32_16x16x32_bf16 a[52:55], v[124:127], a[164:167], a[52:55]
v_add_u32 v223, 98304, v223
v_mfma_f32_16x16x32_bf16 a[56:59], v[124:127], a[168:171], a[56:59]
buffer_load_dwordx4 v219, s[60:63], s10 offen offset:1024 lds
v_mfma_f32_16x16x32_bf16 a[60:63], v[124:127], a[172:175], a[60:63]
ds_read_b64_tr_b16 v[124:125], v224
ds_read_b64_tr_b16 v[126:127], v224 offset:6144
v_mfma_f32_16x16x32_bf16 a[64:67], v[128:131], a[160:163], a[64:67]
v_add_u32 v224, 12288, v224
v_mfma_f32_16x16x32_bf16 a[68:71], v[128:131], a[164:167], a[68:71]
v_mfma_f32_16x16x32_bf16 a[72:75], v[128:131], a[168:171], a[72:75]
v_mfma_f32_16x16x32_bf16 a[76:79], v[128:131], a[172:175], a[76:79]
ds_read_b64_tr_b16 v[128:129], v225
ds_read_b64_tr_b16 v[130:131], v225 offset:6144
v_mfma_f32_16x16x32_bf16 a[80:83], v[132:135], a[160:163], a[80:83]
ds_read_b128 a[160:163], v227 offset:1024
buffer_load_dwordx4 v220, s[60:63], s10 offen offset:2048 lds
v_mfma_f32_16x16x32_bf16 a[84:87], v[132:135], a[164:167], a[84:87]
ds_read_b128 a[164:167], v227 offset:5120
v_add_u32 v225, 12288, v225
v_mfma_f32_16x16x32_bf16 a[88:91], v[132:135], a[168:171], a[88:91]
ds_read_b128 a[168:171], v227 offset:9216
v_mfma_f32_16x16x32_bf16 a[92:95], v[132:135], a[172:175], a[92:95]
ds_read_b64_tr_b16 v[132:133], v226
ds_read_b64_tr_b16 v[134:135], v226 offset:6144
v_mfma_f32_16x16x32_bf16 v[0:3], a[128:131], v[136:139], 0
ds_read_b128 a[172:175], v227 offset:13312
v_add_u32 v226, 12288, v226
v_mfma_f32_16x16x32_bf16 v[4:7], a[128:131], v[140:143], 0
v_mfma_f32_16x16x32_bf16 v[8:11], a[128:131], v[144:147], 0
v_mfma_f32_16x16x32_bf16 v[12:15], a[128:131], v[148:151], 0
v_mfma_f32_16x16x32_bf16 v[96:99], a[128:131], a[176:179], 0
v_mfma_f32_16x16x32_bf16 v[16:19], a[132:135], v[136:139], 0
v_accvgpr_read_b32 v160, a0
v_accvgpr_read_b32 v161, a1
v_mfma_f32_16x16x32_bf16 v[20:23], a[132:135], v[140:143], 0
v_accvgpr_read_b32 v162, a2
v_accvgpr_read_b32 v163, a3
v_mfma_f32_16x16x32_bf16 v[24:27], a[132:135], v[144:147], 0
v_cvt_pk_bf16_f32 v176, v160, v161
v_cvt_pk_bf16_f32 v177, v162, v163
v_mfma_f32_16x16x32_bf16 v[28:31], a[132:135], v[148:151], 0
v_accvgpr_read_b32 v164, a4
v_accvgpr_read_b32 v165, a5
v_accvgpr_read_b32 v166, a6
v_mfma_f32_16x16x32_bf16 v[100:103], a[132:135], a[176:179], 0
v_accvgpr_read_b32 v167, a7
v_cvt_pk_bf16_f32 v178, v164, v165
v_mfma_f32_16x16x32_bf16 v[32:35], a[136:139], v[136:139], 0
s_waitcnt vmcnt(6)
s_barrier
ds_read_b64_tr_b16 a[128:129], v221
v_mfma_f32_16x16x32_bf16 v[36:39], a[136:139], v[140:143], 0
ds_read_b64_tr_b16 a[130:131], v221 offset:6144
s_add_u32 m0, s82, 12288
s_mov_b32 s10, 185088
buffer_load_dwordx4 v218, s[60:63], s10 offen lds
v_mfma_f32_16x16x32_bf16 v[40:43], a[136:139], v[144:147], 0
ds_read_b64_tr_b16 a[132:133], v222
ds_read_b64_tr_b16 a[134:135], v222 offset:6144
v_cvt_pk_bf16_f32 v179, v166, v167
v_mfma_f32_16x16x32_bf16 v[44:47], a[136:139], v[148:151], 0
v_add_u32 v221, 12288, v221
v_add_u32 v222, 12288, v222
v_mfma_f32_16x16x32_bf16 v[104:107], a[136:139], a[176:179], 0
s_waitcnt lgkmcnt(3)
ds_read_b128 a[176:179], v228 offset:2048
v_mfma_f32_16x16x32_bf16 v[48:51], v[124:127], v[136:139], 0
ds_read_b64_tr_b16 a[136:137], v223
ds_read_b64_tr_b16 a[138:139], v223 offset:6144
s_mov_b32 s11, 196608
buffer_store_dwordx4 v[176:179], v229, s[64:67], s11 offen sc1
v_mfma_f32_16x16x32_bf16 v[52:55], v[124:127], v[140:143], 0
v_add_u32 v223, 12288, v223
v_mfma_f32_16x16x32_bf16 v[56:59], v[124:127], v[144:147], 0
buffer_load_dwordx4 v219, s[60:63], s10 offen offset:1024 lds
v_accvgpr_read_b32 v168, a8
v_mfma_f32_16x16x32_bf16 v[60:63], v[124:127], v[148:151], 0
ds_read_b64_tr_b16 v[124:125], v224
ds_read_b64_tr_b16 v[126:127], v224 offset:6144
v_mfma_f32_16x16x32_bf16 v[64:67], v[128:131], v[136:139], 0
v_add_u32 v224, 98304, v224
v_accvgpr_read_b32 v169, a9
v_accvgpr_read_b32 v170, a10
v_mfma_f32_16x16x32_bf16 v[68:71], v[128:131], v[140:143], 0
v_accvgpr_read_b32 v171, a11
v_cvt_pk_bf16_f32 v180, v168, v169
v_mfma_f32_16x16x32_bf16 v[72:75], v[128:131], v[144:147], 0
v_cvt_pk_bf16_f32 v181, v170, v171
v_accvgpr_read_b32 v172, a12
v_mfma_f32_16x16x32_bf16 v[76:79], v[128:131], v[148:151], 0
ds_read_b64_tr_b16 v[128:129], v225
ds_read_b64_tr_b16 v[130:131], v225 offset:6144
v_mfma_f32_16x16x32_bf16 v[80:83], v[132:135], v[136:139], 0
ds_read_b128 v[136:139], v227 offset:2048
buffer_load_dwordx4 v220, s[60:63], s10 offen offset:2048 lds
v_mfma_f32_16x16x32_bf16 v[84:87], v[132:135], v[140:143], 0
ds_read_b128 v[140:143], v227 offset:6144
v_add_u32 v225, 98304, v225
v_mfma_f32_16x16x32_bf16 v[88:91], v[132:135], v[144:147], 0
ds_read_b128 v[144:147], v227 offset:10240
v_accvgpr_read_b32 v173, a13
v_mfma_f32_16x16x32_bf16 v[92:95], v[132:135], v[148:151], 0
ds_read_b64_tr_b16 v[132:133], v226
ds_read_b64_tr_b16 v[134:135], v226 offset:6144
v_accvgpr_read_b32 v174, a14
v_mfma_f32_16x16x32_bf16 v[0:3], a[140:143], a[160:163], v[0:3]
ds_read_b128 v[148:151], v227 offset:14336
v_add_u32 v226, 98304, v226
v_mfma_f32_16x16x32_bf16 v[4:7], a[140:143], a[164:167], v[4:7]
v_accvgpr_read_b32 v175, a15
v_cvt_pk_bf16_f32 v182, v172, v173
v_mfma_f32_16x16x32_bf16 v[8:11], a[140:143], a[168:171], v[8:11]
v_cvt_pk_bf16_f32 v183, v174, v175
s_mov_b32 s11, 786432
buffer_store_dwordx4 v[180:183], v229, s[64:67], s11 offen sc1
v_mfma_f32_16x16x32_bf16 v[12:15], a[140:143], a[172:175], v[12:15]
v_accvgpr_read_b32 v184, a16
v_mfma_f32_16x16x32_bf16 v[96:99], a[140:143], a[180:183], v[96:99]
v_accvgpr_read_b32 v185, a17
v_accvgpr_read_b32 v186, a18
v_mfma_f32_16x16x32_bf16 v[16:19], a[144:147], a[160:163], v[16:19]
v_accvgpr_read_b32 v187, a19
v_cvt_pk_bf16_f32 v200, v184, v185
v_cvt_pk_bf16_f32 v201, v186, v187
v_mfma_f32_16x16x32_bf16 v[20:23], a[144:147], a[164:167], v[20:23]
v_accvgpr_read_b32 v188, a20
v_accvgpr_read_b32 v189, a21
v_mfma_f32_16x16x32_bf16 v[24:27], a[144:147], a[168:171], v[24:27]
v_accvgpr_read_b32 v190, a22
v_accvgpr_read_b32 v191, a23
v_mfma_f32_16x16x32_bf16 v[28:31], a[144:147], a[172:175], v[28:31]
v_cvt_pk_bf16_f32 v202, v188, v189
v_cvt_pk_bf16_f32 v203, v190, v191
v_mfma_f32_16x16x32_bf16 v[100:103], a[144:147], a[180:183], v[100:103]
s_mov_b32 s11, 212992
buffer_store_dwordx4 v[200:203], v229, s[64:67], s11 offen sc1
v_mfma_f32_16x16x32_bf16 v[32:35], a[148:151], a[160:163], v[32:35]
s_waitcnt vmcnt(9)
s_barrier
ds_read_b64_tr_b16 a[140:141], v221
v_accvgpr_read_b32 v192, a24
v_mfma_f32_16x16x32_bf16 v[36:39], a[148:151], a[164:167], v[36:39]
ds_read_b64_tr_b16 a[142:143], v221 offset:6144
s_add_u32 m0, s82, 24576
s_mov_b32 s10, 221952
buffer_load_dwordx4 v218, s[60:63], s10 offen lds
v_mfma_f32_16x16x32_bf16 v[40:43], a[148:151], a[168:171], v[40:43]
ds_read_b64_tr_b16 a[144:145], v222
ds_read_b64_tr_b16 a[146:147], v222 offset:6144
v_mfma_f32_16x16x32_bf16 v[44:47], a[148:151], a[172:175], v[44:47]
v_add_u32 v221, 4294819840, v221
v_add_u32 v222, 4294819840, v222
v_mfma_f32_16x16x32_bf16 v[104:107], a[148:151], a[180:183], v[104:107]
s_waitcnt lgkmcnt(3)
ds_read_b128 a[180:183], v228 offset:3072
v_accvgpr_read_b32 v193, a25
v_mfma_f32_16x16x32_bf16 v[48:51], v[124:127], a[160:163], v[48:51]
ds_read_b64_tr_b16 a[148:149], v223
ds_read_b64_tr_b16 a[150:151], v223 offset:6144
v_mfma_f32_16x16x32_bf16 v[52:55], v[124:127], a[164:167], v[52:55]
v_add_u32 v223, 4294819840, v223
v_accvgpr_read_b32 v194, a26
v_accvgpr_read_b32 v195, a27
v_mfma_f32_16x16x32_bf16 v[56:59], v[124:127], a[168:171], v[56:59]
buffer_load_dwordx4 v219, s[60:63], s10 offen offset:1024 lds
v_cvt_pk_bf16_f32 v204, v192, v193
v_mfma_f32_16x16x32_bf16 v[60:63], v[124:127], a[172:175], v[60:63]
ds_read_b64_tr_b16 v[124:125], v224
ds_read_b64_tr_b16 v[126:127], v224 offset:6144
v_mfma_f32_16x16x32_bf16 v[64:67], v[128:131], a[160:163], v[64:67]
v_add_u32 v224, 12288, v224
v_cvt_pk_bf16_f32 v205, v194, v195
v_mfma_f32_16x16x32_bf16 v[68:71], v[128:131], a[164:167], v[68:71]
v_accvgpr_read_b32 v196, a28
v_accvgpr_read_b32 v197, a29
v_mfma_f32_16x16x32_bf16 v[72:75], v[128:131], a[168:171], v[72:75]
v_accvgpr_read_b32 v198, a30
v_accvgpr_read_b32 v199, a31
v_mfma_f32_16x16x32_bf16 v[76:79], v[128:131], a[172:175], v[76:79]
ds_read_b64_tr_b16 v[128:129], v225
ds_read_b64_tr_b16 v[130:131], v225 offset:6144
v_mfma_f32_16x16x32_bf16 v[80:83], v[132:135], a[160:163], v[80:83]
ds_read_b128 a[160:163], v227 offset:3072
buffer_load_dwordx4 v220, s[60:63], s10 offen offset:2048 lds
v_cvt_pk_bf16_f32 v206, v196, v197
v_mfma_f32_16x16x32_bf16 v[84:87], v[132:135], a[164:167], v[84:87]
ds_read_b128 a[164:167], v227 offset:7168
v_add_u32 v225, 12288, v225
v_mfma_f32_16x16x32_bf16 v[88:91], v[132:135], a[168:171], v[88:91]
ds_read_b128 a[168:171], v227 offset:11264
v_cvt_pk_bf16_f32 v207, v198, v199
v_mfma_f32_16x16x32_bf16 v[92:95], v[132:135], a[172:175], v[92:95]
ds_read_b64_tr_b16 v[132:133], v226
ds_read_b64_tr_b16 v[134:135], v226 offset:6144
v_mfma_f32_16x16x32_bf16 v[0:3], a[128:131], v[136:139], v[0:3]
ds_read_b128 a[172:175], v227 offset:15360
v_add_u32 v226, 12288, v226
v_mfma_f32_16x16x32_bf16 v[4:7], a[128:131], v[140:143], v[4:7]
s_mov_b32 s11, 802816
buffer_store_dwordx4 v[204:207], v229, s[64:67], s11 offen sc1
v_mfma_f32_16x16x32_bf16 v[8:11], a[128:131], v[144:147], v[8:11]
v_accvgpr_read_b32 v160, a32
v_accvgpr_read_b32 v161, a33
v_mfma_f32_16x16x32_bf16 v[12:15], a[128:131], v[148:151], v[12:15]
v_accvgpr_read_b32 v162, a34
v_accvgpr_read_b32 v163, a35
v_cvt_pk_bf16_f32 v176, v160, v161
v_mfma_f32_16x16x32_bf16 v[96:99], a[128:131], a[176:179], v[96:99]
v_cvt_pk_bf16_f32 v177, v162, v163
v_accvgpr_read_b32 v164, a36
v_mfma_f32_16x16x32_bf16 v[16:19], a[132:135], v[136:139], v[16:19]
v_accvgpr_read_b32 v165, a37
v_accvgpr_read_b32 v166, a38
v_mfma_f32_16x16x32_bf16 v[20:23], a[132:135], v[140:143], v[20:23]
v_accvgpr_read_b32 v167, a39
v_cvt_pk_bf16_f32 v178, v164, v165
v_mfma_f32_16x16x32_bf16 v[24:27], a[132:135], v[144:147], v[24:27]
v_cvt_pk_bf16_f32 v179, v166, v167
s_mov_b32 s11, 229376
buffer_store_dwordx4 v[176:179], v229, s[64:67], s11 offen sc1
v_mfma_f32_16x16x32_bf16 v[28:31], a[132:135], v[148:151], v[28:31]
v_accvgpr_read_b32 v168, a40
v_mfma_f32_16x16x32_bf16 v[100:103], a[132:135], a[176:179], v[100:103]
v_accvgpr_read_b32 v169, a41
v_accvgpr_read_b32 v170, a42
v_mfma_f32_16x16x32_bf16 v[32:35], a[136:139], v[136:139], v[32:35]
s_waitcnt vmcnt(11)
s_barrier
ds_read_b64_tr_b16 a[128:129], v221
v_accvgpr_read_b32 v171, a43
v_mfma_f32_16x16x32_bf16 v[36:39], a[136:139], v[140:143], v[36:39]
ds_read_b64_tr_b16 a[130:131], v221 offset:6144
s_add_u32 m0, s82, 36864
s_mov_b32 s10, 258816
buffer_load_dwordx4 v218, s[60:63], s10 offen lds
v_mfma_f32_16x16x32_bf16 v[40:43], a[136:139], v[144:147], v[40:43]
ds_read_b64_tr_b16 a[132:133], v222
ds_read_b64_tr_b16 a[134:135], v222 offset:6144
v_mfma_f32_16x16x32_bf16 v[44:47], a[136:139], v[148:151], v[44:47]
v_add_u32 v221, 12288, v221
v_add_u32 v222, 12288, v222
v_mfma_f32_16x16x32_bf16 v[104:107], a[136:139], a[176:179], v[104:107]
s_waitcnt lgkmcnt(3)
ds_read_b128 a[176:179], v228 offset:4096
v_cvt_pk_bf16_f32 v180, v168, v169
v_cvt_pk_bf16_f32 v181, v170, v171
v_mfma_f32_16x16x32_bf16 v[48:51], v[124:127], v[136:139], v[48:51]
ds_read_b64_tr_b16 a[136:137], v223
ds_read_b64_tr_b16 a[138:139], v223 offset:6144
v_mfma_f32_16x16x32_bf16 v[52:55], v[124:127], v[140:143], v[52:55]
v_add_u32 v223, 12288, v223
v_accvgpr_read_b32 v172, a44
v_mfma_f32_16x16x32_bf16 v[56:59], v[124:127], v[144:147], v[56:59]
buffer_load_dwordx4 v219, s[60:63], s10 offen offset:1024 lds
v_accvgpr_read_b32 v173, a45
v_mfma_f32_16x16x32_bf16 v[60:63], v[124:127], v[148:151], v[60:63]
ds_read_b64_tr_b16 v[124:125], v224
ds_read_b64_tr_b16 v[126:127], v224 offset:6144
v_mfma_f32_16x16x32_bf16 v[64:67], v[128:131], v[136:139], v[64:67]
v_add_u32 v224, 4294819840, v224
v_accvgpr_read_b32 v174, a46
v_mfma_f32_16x16x32_bf16 v[68:71], v[128:131], v[140:143], v[68:71]
v_accvgpr_read_b32 v175, a47
v_cvt_pk_bf16_f32 v182, v172, v173
v_mfma_f32_16x16x32_bf16 v[72:75], v[128:131], v[144:147], v[72:75]
v_cvt_pk_bf16_f32 v183, v174, v175
s_mov_b32 s11, 819200
buffer_store_dwordx4 v[180:183], v229, s[64:67], s11 offen sc1
v_mfma_f32_16x16x32_bf16 v[76:79], v[128:131], v[148:151], v[76:79]
ds_read_b64_tr_b16 v[128:129], v225
ds_read_b64_tr_b16 v[130:131], v225 offset:6144
v_mfma_f32_16x16x32_bf16 v[80:83], v[132:135], v[136:139], v[80:83]
ds_read_b128 v[136:139], v227 offset:32768
buffer_load_dwordx4 v220, s[60:63], s10 offen offset:2048 lds
v_mfma_f32_16x16x32_bf16 v[84:87], v[132:135], v[140:143], v[84:87]
ds_read_b128 v[140:143], v227 offset:36864
v_add_u32 v225, 4294819840, v225
v_mfma_f32_16x16x32_bf16 v[88:91], v[132:135], v[144:147], v[88:91]
ds_read_b128 v[144:147], v227 offset:40960
v_accvgpr_read_b32 v184, a48
v_mfma_f32_16x16x32_bf16 v[92:95], v[132:135], v[148:151], v[92:95]
ds_read_b64_tr_b16 v[132:133], v226
ds_read_b64_tr_b16 v[134:135], v226 offset:6144
v_mfma_f32_16x16x32_bf16 v[0:3], a[140:143], a[160:163], v[0:3]
ds_read_b128 v[148:151], v227 offset:45056
v_add_u32 v226, 4294819840, v226
v_accvgpr_read_b32 v185, a49
v_mfma_f32_16x16x32_bf16 v[4:7], a[140:143], a[164:167], v[4:7]
v_accvgpr_read_b32 v186, a50
v_accvgpr_read_b32 v187, a51
v_mfma_f32_16x16x32_bf16 v[8:11], a[140:143], a[168:171], v[8:11]
v_cvt_pk_bf16_f32 v200, v184, v185
v_cvt_pk_bf16_f32 v201, v186, v187
v_mfma_f32_16x16x32_bf16 v[12:15], a[140:143], a[172:175], v[12:15]
v_accvgpr_read_b32 v188, a52
v_accvgpr_read_b32 v189, a53
v_mfma_f32_16x16x32_bf16 v[96:99], a[140:143], a[180:183], v[96:99]
v_accvgpr_read_b32 v190, a54
v_accvgpr_read_b32 v191, a55
v_mfma_f32_16x16x32_bf16 v[16:19], a[144:147], a[160:163], v[16:19]
v_cvt_pk_bf16_f32 v202, v188, v189
v_cvt_pk_bf16_f32 v203, v190, v191
v_mfma_f32_16x16x32_bf16 v[20:23], a[144:147], a[164:167], v[20:23]
s_mov_b32 s11, 196608
buffer_store_dwordx4 v[200:203], v230, s[64:67], s11 offen sc1
v_mfma_f32_16x16x32_bf16 v[24:27], a[144:147], a[168:171], v[24:27]
v_accvgpr_read_b32 v192, a56
v_accvgpr_read_b32 v193, a57
v_accvgpr_read_b32 v194, a58
v_mfma_f32_16x16x32_bf16 v[28:31], a[144:147], a[172:175], v[28:31]
v_accvgpr_read_b32 v195, a59
v_cvt_pk_bf16_f32 v204, v192, v193
v_mfma_f32_16x16x32_bf16 v[100:103], a[144:147], a[180:183], v[100:103]
v_cvt_pk_bf16_f32 v205, v194, v195
v_accvgpr_read_b32 v196, a60
v_mfma_f32_16x16x32_bf16 v[32:35], a[148:151], a[160:163], v[32:35]
s_waitcnt vmcnt(12)
s_barrier
ds_read_b64_tr_b16 a[140:141], v221
v_mfma_f32_16x16x32_bf16 v[36:39], a[148:151], a[164:167], v[36:39]
ds_read_b64_tr_b16 a[142:143], v221 offset:6144
ds_read_b64_tr_b16 a[144:145], v222
v_accvgpr_read_b32 v197, a61
v_mfma_f32_16x16x32_bf16 v[40:43], a[148:151], a[168:171], v[40:43]
ds_read_b64_tr_b16 a[146:147], v222 offset:6144
v_add_u32 v221, 12288, v221
v_mfma_f32_16x16x32_bf16 v[44:47], a[148:151], a[172:175], v[44:47]
v_add_u32 v222, 12288, v222
v_accvgpr_read_b32 v198, a62
v_mfma_f32_16x16x32_bf16 v[104:107], a[148:151], a[180:183], v[104:107]
s_waitcnt lgkmcnt(4)
ds_read_b128 a[180:183], v228 offset:5120
v_accvgpr_read_b32 v199, a63
v_mfma_f32_16x16x32_bf16 v[48:51], v[124:127], a[160:163], v[48:51]
ds_read_b64_tr_b16 a[148:149], v223
ds_read_b64_tr_b16 a[150:151], v223 offset:6144
v_mfma_f32_16x16x32_bf16 v[52:55], v[124:127], a[164:167], v[52:55]
v_add_u32 v223, 12288, v223
v_cvt_pk_bf16_f32 v206, v196, v197
v_mfma_f32_16x16x32_bf16 v[56:59], v[124:127], a[168:171], v[56:59]
v_cvt_pk_bf16_f32 v207, v198, v199
s_mov_b32 s11, 786432
buffer_store_dwordx4 v[204:207], v230, s[64:67], s11 offen sc1
v_mfma_f32_16x16x32_bf16 v[60:63], v[124:127], a[172:175], v[60:63]
ds_read_b64_tr_b16 v[124:125], v224
ds_read_b64_tr_b16 v[126:127], v224 offset:6144
v_mfma_f32_16x16x32_bf16 v[64:67], v[128:131], a[160:163], v[64:67]
v_add_u32 v224, 12288, v224
v_accvgpr_read_b32 v160, a64
v_mfma_f32_16x16x32_bf16 v[68:71], v[128:131], a[164:167], v[68:71]
v_accvgpr_read_b32 v161, a65
v_accvgpr_read_b32 v162, a66
v_mfma_f32_16x16x32_bf16 v[72:75], v[128:131], a[168:171], v[72:75]
v_accvgpr_read_b32 v163, a67
v_cvt_pk_bf16_f32 v176, v160, v161
v_mfma_f32_16x16x32_bf16 v[76:79], v[128:131], a[172:175], v[76:79]
ds_read_b64_tr_b16 v[128:129], v225
ds_read_b64_tr_b16 v[130:131], v225 offset:6144
v_mfma_f32_16x16x32_bf16 v[80:83], v[132:135], a[160:163], v[80:83]
ds_read_b128 a[160:163], v227 offset:33792
v_add_u32 v225, 12288, v225
v_mfma_f32_16x16x32_bf16 v[84:87], v[132:135], a[164:167], v[84:87]
ds_read_b128 a[164:167], v227 offset:37888
v_cvt_pk_bf16_f32 v177, v162, v163
v_accvgpr_read_b32 v164, a68
v_mfma_f32_16x16x32_bf16 v[88:91], v[132:135], a[168:171], v[88:91]
ds_read_b128 a[168:171], v227 offset:41984
v_accvgpr_read_b32 v165, a69
v_mfma_f32_16x16x32_bf16 v[92:95], v[132:135], a[172:175], v[92:95]
ds_read_b64_tr_b16 v[132:133], v226
ds_read_b64_tr_b16 v[134:135], v226 offset:6144
v_mfma_f32_16x16x32_bf16 v[0:3], a[128:131], v[136:139], v[0:3]
ds_read_b128 a[172:175], v227 offset:46080
v_add_u32 v226, 12288, v226
v_mfma_f32_16x16x32_bf16 v[4:7], a[128:131], v[140:143], v[4:7]
v_accvgpr_read_b32 v166, a70
v_accvgpr_read_b32 v167, a71
v_mfma_f32_16x16x32_bf16 v[8:11], a[128:131], v[144:147], v[8:11]
v_cvt_pk_bf16_f32 v178, v164, v165
v_cvt_pk_bf16_f32 v179, v166, v167
v_mfma_f32_16x16x32_bf16 v[12:15], a[128:131], v[148:151], v[12:15]
s_mov_b32 s11, 212992
buffer_store_dwordx4 v[176:179], v230, s[64:67], s11 offen sc1
v_mfma_f32_16x16x32_bf16 v[96:99], a[128:131], a[176:179], v[96:99]
v_accvgpr_read_b32 v168, a72
v_accvgpr_read_b32 v169, a73
v_accvgpr_read_b32 v170, a74
v_mfma_f32_16x16x32_bf16 v[16:19], a[132:135], v[136:139], v[16:19]
v_accvgpr_read_b32 v171, a75
v_cvt_pk_bf16_f32 v180, v168, v169
v_mfma_f32_16x16x32_bf16 v[20:23], a[132:135], v[140:143], v[20:23]
v_cvt_pk_bf16_f32 v181, v170, v171
v_accvgpr_read_b32 v172, a76
v_mfma_f32_16x16x32_bf16 v[24:27], a[132:135], v[144:147], v[24:27]
v_accvgpr_read_b32 v173, a77
v_accvgpr_read_b32 v174, a78
v_mfma_f32_16x16x32_bf16 v[28:31], a[132:135], v[148:151], v[28:31]
v_accvgpr_read_b32 v175, a79
v_cvt_pk_bf16_f32 v182, v172, v173
v_mfma_f32_16x16x32_bf16 v[100:103], a[132:135], a[176:179], v[100:103]
v_cvt_pk_bf16_f32 v183, v174, v175
s_mov_b32 s11, 802816
buffer_store_dwordx4 v[180:183], v230, s[64:67], s11 offen sc1
v_mfma_f32_16x16x32_bf16 v[32:35], a[136:139], v[136:139], v[32:35]
s_waitcnt vmcnt(10)
s_barrier
ds_read_b64_tr_b16 a[128:129], v221
v_mfma_f32_16x16x32_bf16 v[36:39], a[136:139], v[140:143], v[36:39]
ds_read_b64_tr_b16 a[130:131], v221 offset:6144
ds_read_b64_tr_b16 a[132:133], v222
v_mfma_f32_16x16x32_bf16 v[40:43], a[136:139], v[144:147], v[40:43]
ds_read_b64_tr_b16 a[134:135], v222 offset:6144
v_add_u32 v221, 12288, v221
v_mfma_f32_16x16x32_bf16 v[44:47], a[136:139], v[148:151], v[44:47]
v_add_u32 v222, 12288, v222
v_accvgpr_read_b32 v184, a80
v_mfma_f32_16x16x32_bf16 v[104:107], a[136:139], a[176:179], v[104:107]
s_waitcnt lgkmcnt(4)
ds_read_b128 a[176:179], v228 offset:6144
v_accvgpr_read_b32 v185, a81
v_accvgpr_read_b32 v186, a82
v_mfma_f32_16x16x32_bf16 v[48:51], v[124:127], v[136:139], v[48:51]
ds_read_b64_tr_b16 a[136:137], v223
ds_read_b64_tr_b16 a[138:139], v223 offset:6144
v_mfma_f32_16x16x32_bf16 v[52:55], v[124:127], v[140:143], v[52:55]
v_add_u32 v223, 12288, v223
v_accvgpr_read_b32 v187, a83
v_mfma_f32_16x16x32_bf16 v[56:59], v[124:127], v[144:147], v[56:59]
v_cvt_pk_bf16_f32 v200, v184, v185
v_cvt_pk_bf16_f32 v201, v186, v187
v_mfma_f32_16x16x32_bf16 v[60:63], v[124:127], v[148:151], v[60:63]
ds_read_b64_tr_b16 v[124:125], v224
ds_read_b64_tr_b16 v[126:127], v224 offset:6144
v_mfma_f32_16x16x32_bf16 v[64:67], v[128:131], v[136:139], v[64:67]
v_add_u32 v224, 12288, v224
v_accvgpr_read_b32 v188, a84
v_mfma_f32_16x16x32_bf16 v[68:71], v[128:131], v[140:143], v[68:71]
v_accvgpr_read_b32 v189, a85
v_accvgpr_read_b32 v190, a86
v_mfma_f32_16x16x32_bf16 v[72:75], v[128:131], v[144:147], v[72:75]
v_accvgpr_read_b32 v191, a87
v_cvt_pk_bf16_f32 v202, v188, v189
v_cvt_pk_bf16_f32 v203, v190, v191
v_mfma_f32_16x16x32_bf16 v[76:79], v[128:131], v[148:151], v[76:79]
ds_read_b64_tr_b16 v[128:129], v225
ds_read_b64_tr_b16 v[130:131], v225 offset:6144
v_mfma_f32_16x16x32_bf16 v[80:83], v[132:135], v[136:139], v[80:83]
ds_read_b128 v[136:139], v227 offset:34816
v_add_u32 v225, 12288, v225
v_mfma_f32_16x16x32_bf16 v[84:87], v[132:135], v[140:143], v[84:87]
ds_read_b128 v[140:143], v227 offset:38912
s_mov_b32 s11, 229376
buffer_store_dwordx4 v[200:203], v230, s[64:67], s11 offen sc1
v_mfma_f32_16x16x32_bf16 v[88:91], v[132:135], v[144:147], v[88:91]
ds_read_b128 v[144:147], v227 offset:43008
v_mfma_f32_16x16x32_bf16 v[92:95], v[132:135], v[148:151], v[92:95]
ds_read_b64_tr_b16 v[132:133], v226
ds_read_b64_tr_b16 v[134:135], v226 offset:6144
v_mfma_f32_16x16x32_bf16 v[0:3], a[140:143], a[160:163], v[0:3]
ds_read_b128 v[148:151], v227 offset:47104
v_add_u32 v226, 12288, v226
v_accvgpr_read_b32 v192, a88
v_mfma_f32_16x16x32_bf16 v[4:7], a[140:143], a[164:167], v[4:7]
v_accvgpr_read_b32 v193, a89
v_accvgpr_read_b32 v194, a90
v_mfma_f32_16x16x32_bf16 v[8:11], a[140:143], a[168:171], v[8:11]
v_accvgpr_read_b32 v195, a91
v_cvt_pk_bf16_f32 v204, v192, v193
v_mfma_f32_16x16x32_bf16 v[12:15], a[140:143], a[172:175], v[12:15]
v_cvt_pk_bf16_f32 v205, v194, v195
v_accvgpr_read_b32 v196, a92
v_mfma_f32_16x16x32_bf16 v[96:99], a[140:143], a[180:183], v[96:99]
v_accvgpr_read_b32 v197, a93
v_accvgpr_read_b32 v198, a94
v_mfma_f32_16x16x32_bf16 v[16:19], a[144:147], a[160:163], v[16:19]
v_accvgpr_read_b32 v199, a95
v_cvt_pk_bf16_f32 v206, v196, v197
v_mfma_f32_16x16x32_bf16 v[20:23], a[144:147], a[164:167], v[20:23]
v_cvt_pk_bf16_f32 v207, v198, v199
s_mov_b32 s11, 819200
buffer_store_dwordx4 v[204:207], v230, s[64:67], s11 offen sc1
v_mfma_f32_16x16x32_bf16 v[24:27], a[144:147], a[168:171], v[24:27]
v_accvgpr_read_b32 v160, a96
v_accvgpr_read_b32 v161, a97
v_mfma_f32_16x16x32_bf16 v[28:31], a[144:147], a[172:175], v[28:31]
v_accvgpr_read_b32 v162, a98
v_accvgpr_read_b32 v163, a99
v_mfma_f32_16x16x32_bf16 v[100:103], a[144:147], a[180:183], v[100:103]
v_cvt_pk_bf16_f32 v176, v160, v161
v_cvt_pk_bf16_f32 v177, v162, v163
v_mfma_f32_16x16x32_bf16 v[32:35], a[148:151], a[160:163], v[32:35]
s_waitcnt vmcnt(6)
s_barrier
ds_read_b64_tr_b16 a[140:141], v221
v_mfma_f32_16x16x32_bf16 v[36:39], a[148:151], a[164:167], v[36:39]
ds_read_b64_tr_b16 a[142:143], v221 offset:6144
ds_read_b64_tr_b16 a[144:145], v222
v_mfma_f32_16x16x32_bf16 v[40:43], a[148:151], a[168:171], v[40:43]
ds_read_b64_tr_b16 a[146:147], v222 offset:6144
s_mov_b32 s11, 98304
buffer_store_dwordx2 v[176:177], v231, s[64:67], s11 offen sc1
v_mfma_f32_16x16x32_bf16 v[44:47], a[148:151], a[172:175], v[44:47]
v_accvgpr_read_b32 v164, a100
v_accvgpr_read_b32 v165, a101
v_mfma_f32_16x16x32_bf16 v[104:107], a[148:151], a[180:183], v[104:107]
s_waitcnt lgkmcnt(4)
ds_read_b128 a[180:183], v228 offset:7168
v_accvgpr_read_b32 v166, a102
v_mfma_f32_16x16x32_bf16 v[48:51], v[124:127], a[160:163], v[48:51]
ds_read_b64_tr_b16 a[148:149], v223
ds_read_b64_tr_b16 a[150:151], v223 offset:6144
v_mfma_f32_16x16x32_bf16 v[52:55], v[124:127], a[164:167], v[52:55]
v_accvgpr_read_b32 v167, a103
v_cvt_pk_bf16_f32 v178, v164, v165
v_mfma_f32_16x16x32_bf16 v[56:59], v[124:127], a[168:171], v[56:59]
v_cvt_pk_bf16_f32 v179, v166, v167
s_mov_b32 s11, 106496
buffer_store_dwordx2 v[178:179], v231, s[64:67], s11 offen sc1
v_mfma_f32_16x16x32_bf16 v[60:63], v[124:127], a[172:175], v[60:63]
ds_read_b64_tr_b16 v[124:125], v224
ds_read_b64_tr_b16 v[126:127], v224 offset:6144
v_mfma_f32_16x16x32_bf16 v[64:67], v[128:131], a[160:163], v[64:67]
v_add_u32 v224, 12288, v224
v_accvgpr_read_b32 v168, a104
v_mfma_f32_16x16x32_bf16 v[68:71], v[128:131], a[164:167], v[68:71]
v_accvgpr_read_b32 v169, a105
v_accvgpr_read_b32 v170, a106
v_mfma_f32_16x16x32_bf16 v[72:75], v[128:131], a[168:171], v[72:75]
v_accvgpr_read_b32 v171, a107
v_cvt_pk_bf16_f32 v180, v168, v169
v_mfma_f32_16x16x32_bf16 v[76:79], v[128:131], a[172:175], v[76:79]
ds_read_b64_tr_b16 v[128:129], v225
ds_read_b64_tr_b16 v[130:131], v225 offset:6144
v_mfma_f32_16x16x32_bf16 v[80:83], v[132:135], a[160:163], v[80:83]
ds_read_b128 a[160:163], v227 offset:35840
v_add_u32 v225, 12288, v225
v_mfma_f32_16x16x32_bf16 v[84:87], v[132:135], a[164:167], v[84:87]
ds_read_b128 a[164:167], v227 offset:39936
v_cvt_pk_bf16_f32 v181, v170, v171
v_mfma_f32_16x16x32_bf16 v[88:91], v[132:135], a[168:171], v[88:91]
ds_read_b128 a[168:171], v227 offset:44032
s_mov_b32 s11, 114688
buffer_store_dwordx2 v[180:181], v231, s[64:67], s11 offen sc1
v_mfma_f32_16x16x32_bf16 v[92:95], v[132:135], a[172:175], v[92:95]
ds_read_b64_tr_b16 v[132:133], v226
ds_read_b64_tr_b16 v[134:135], v226 offset:6144
v_mfma_f32_16x16x32_bf16 v[0:3], a[128:131], v[136:139], v[0:3]
ds_read_b128 a[172:175], v227 offset:48128
v_add_u32 v226, 12288, v226
v_mfma_f32_16x16x32_bf16 v[4:7], a[128:131], v[140:143], v[4:7]
v_mfma_f32_16x16x32_bf16 v[8:11], a[128:131], v[144:147], v[8:11]
v_mfma_f32_16x16x32_bf16 v[12:15], a[128:131], v[148:151], v[12:15]
v_mfma_f32_16x16x32_bf16 v[96:99], a[128:131], a[176:179], v[96:99]
v_mfma_f32_16x16x32_bf16 v[16:19], a[132:135], v[136:139], v[16:19]
v_mfma_f32_16x16x32_bf16 v[20:23], a[132:135], v[140:143], v[20:23]
v_mfma_f32_16x16x32_bf16 v[24:27], a[132:135], v[144:147], v[24:27]
v_mfma_f32_16x16x32_bf16 v[28:31], a[132:135], v[148:151], v[28:31]
v_mfma_f32_16x16x32_bf16 v[100:103], a[132:135], a[176:179], v[100:103]
v_mfma_f32_16x16x32_bf16 v[32:35], a[136:139], v[136:139], v[32:35]
s_barrier
v_mfma_f32_16x16x32_bf16 v[36:39], a[136:139], v[140:143], v[36:39]
v_mfma_f32_16x16x32_bf16 v[40:43], a[136:139], v[144:147], v[40:43]
v_mfma_f32_16x16x32_bf16 v[44:47], a[136:139], v[148:151], v[44:47]
v_mfma_f32_16x16x32_bf16 v[104:107], a[136:139], a[176:179], v[104:107]
s_waitcnt lgkmcnt(0)
v_mfma_f32_16x16x32_bf16 v[48:51], v[124:127], v[136:139], v[48:51]
v_mfma_f32_16x16x32_bf16 v[52:55], v[124:127], v[140:143], v[52:55]
v_mfma_f32_16x16x32_bf16 v[56:59], v[124:127], v[144:147], v[56:59]
v_mfma_f32_16x16x32_bf16 v[60:63], v[124:127], v[148:151], v[60:63]
ds_read_b64_tr_b16 v[124:125], v224
ds_read_b64_tr_b16 v[126:127], v224 offset:6144
v_mfma_f32_16x16x32_bf16 v[64:67], v[128:131], v[136:139], v[64:67]
v_mfma_f32_16x16x32_bf16 v[68:71], v[128:131], v[140:143], v[68:71]
v_mfma_f32_16x16x32_bf16 v[72:75], v[128:131], v[144:147], v[72:75]
v_mfma_f32_16x16x32_bf16 v[76:79], v[128:131], v[148:151], v[76:79]
ds_read_b64_tr_b16 v[128:129], v225
ds_read_b64_tr_b16 v[130:131], v225 offset:6144
v_mfma_f32_16x16x32_bf16 v[80:83], v[132:135], v[136:139], v[80:83]
v_mfma_f32_16x16x32_bf16 v[84:87], v[132:135], v[140:143], v[84:87]
v_mfma_f32_16x16x32_bf16 v[88:91], v[132:135], v[144:147], v[88:91]
v_mfma_f32_16x16x32_bf16 v[92:95], v[132:135], v[148:151], v[92:95]
ds_read_b64_tr_b16 v[132:133], v226
ds_read_b64_tr_b16 v[134:135], v226 offset:6144
v_mfma_f32_16x16x32_bf16 v[0:3], a[140:143], a[160:163], v[0:3]
v_mfma_f32_16x16x32_bf16 v[4:7], a[140:143], a[164:167], v[4:7]
v_mfma_f32_16x16x32_bf16 v[8:11], a[140:143], a[168:171], v[8:11]
v_mfma_f32_16x16x32_bf16 v[12:15], a[140:143], a[172:175], v[12:15]
v_mfma_f32_16x16x32_bf16 v[96:99], a[140:143], a[180:183], v[96:99]
v_mfma_f32_16x16x32_bf16 v[16:19], a[144:147], a[160:163], v[16:19]
v_mfma_f32_16x16x32_bf16 v[20:23], a[144:147], a[164:167], v[20:23]
v_mfma_f32_16x16x32_bf16 v[24:27], a[144:147], a[168:171], v[24:27]
v_mfma_f32_16x16x32_bf16 v[28:31], a[144:147], a[172:175], v[28:31]
v_mfma_f32_16x16x32_bf16 v[100:103], a[144:147], a[180:183], v[100:103]
v_mfma_f32_16x16x32_bf16 v[32:35], a[148:151], a[160:163], v[32:35]
v_cvt_pk_bf16_f32 v176, v0, v1
v_cvt_pk_bf16_f32 v177, v2, v3
v_cvt_pk_bf16_f32 v178, v4, v5
v_cvt_pk_bf16_f32 v179, v6, v7
v_mfma_f32_16x16x32_bf16 v[36:39], a[148:151], a[164:167], v[36:39]
s_mov_b32 s11, 393216
buffer_store_dwordx4 v[176:179], v229, s[64:67], s11 offen sc1
v_cvt_pk_bf16_f32 v180, v8, v9
v_cvt_pk_bf16_f32 v181, v10, v11
v_cvt_pk_bf16_f32 v182, v12, v13
v_mfma_f32_16x16x32_bf16 v[40:43], a[148:151], a[168:171], v[40:43]
v_cvt_pk_bf16_f32 v183, v14, v15
s_mov_b32 s11, 983040
buffer_store_dwordx4 v[180:183], v229, s[64:67], s11 offen sc1
v_mfma_f32_16x16x32_bf16 v[44:47], a[148:151], a[172:175], v[44:47]
v_mfma_f32_16x16x32_bf16 v[104:107], a[148:151], a[180:183], v[104:107]
s_waitcnt lgkmcnt(0)
v_mfma_f32_16x16x32_bf16 v[48:51], v[124:127], a[160:163], v[48:51]
v_cvt_pk_bf16_f32 v200, v16, v17
v_cvt_pk_bf16_f32 v201, v18, v19
v_cvt_pk_bf16_f32 v202, v20, v21
v_cvt_pk_bf16_f32 v203, v22, v23
s_mov_b32 s11, 409600
buffer_store_dwordx4 v[200:203], v229, s[64:67], s11 offen sc1
v_cvt_pk_bf16_f32 v204, v24, v25
v_cvt_pk_bf16_f32 v205, v26, v27
v_cvt_pk_bf16_f32 v206, v28, v29
v_cvt_pk_bf16_f32 v207, v30, v31
s_mov_b32 s11, 999424
buffer_store_dwordx4 v[204:207], v229, s[64:67], s11 offen sc1
v_mfma_f32_16x16x32_bf16 v[52:55], v[124:127], a[164:167], v[52:55]
v_mfma_f32_16x16x32_bf16 v[56:59], v[124:127], a[168:171], v[56:59]
v_mfma_f32_16x16x32_bf16 v[60:63], v[124:127], a[172:175], v[60:63]
v_mfma_f32_16x16x32_bf16 v[64:67], v[128:131], a[160:163], v[64:67]
v_mfma_f32_16x16x32_bf16 v[68:71], v[128:131], a[164:167], v[68:71]
v_cvt_pk_bf16_f32 v176, v32, v33
v_cvt_pk_bf16_f32 v177, v34, v35
v_cvt_pk_bf16_f32 v178, v36, v37
v_cvt_pk_bf16_f32 v179, v38, v39
s_mov_b32 s11, 425984
buffer_store_dwordx4 v[176:179], v229, s[64:67], s11 offen sc1
v_cvt_pk_bf16_f32 v180, v40, v41
v_cvt_pk_bf16_f32 v181, v42, v43
v_cvt_pk_bf16_f32 v182, v44, v45
v_cvt_pk_bf16_f32 v183, v46, v47
s_mov_b32 s11, 1015808
buffer_store_dwordx4 v[180:183], v229, s[64:67], s11 offen sc1
v_mfma_f32_16x16x32_bf16 v[72:75], v[128:131], a[168:171], v[72:75]
v_mfma_f32_16x16x32_bf16 v[76:79], v[128:131], a[172:175], v[76:79]
v_mfma_f32_16x16x32_bf16 v[80:83], v[132:135], a[160:163], v[80:83]
v_mfma_f32_16x16x32_bf16 v[84:87], v[132:135], a[164:167], v[84:87]
v_cvt_pk_bf16_f32 v200, v48, v49
v_cvt_pk_bf16_f32 v201, v50, v51
v_cvt_pk_bf16_f32 v202, v52, v53
v_cvt_pk_bf16_f32 v203, v54, v55
s_mov_b32 s11, 393216
buffer_store_dwordx4 v[200:203], v230, s[64:67], s11 offen sc1
v_cvt_pk_bf16_f32 v204, v56, v57
v_cvt_pk_bf16_f32 v205, v58, v59
v_cvt_pk_bf16_f32 v206, v60, v61
v_cvt_pk_bf16_f32 v207, v62, v63
s_mov_b32 s11, 983040
buffer_store_dwordx4 v[204:207], v230, s[64:67], s11 offen sc1
v_mfma_f32_16x16x32_bf16 v[88:91], v[132:135], a[168:171], v[88:91]
v_mfma_f32_16x16x32_bf16 v[92:95], v[132:135], a[172:175], v[92:95]
v_cvt_pk_bf16_f32 v176, v64, v65
v_cvt_pk_bf16_f32 v177, v66, v67
v_cvt_pk_bf16_f32 v178, v68, v69
v_cvt_pk_bf16_f32 v179, v70, v71
s_mov_b32 s11, 409600
buffer_store_dwordx4 v[176:179], v230, s[64:67], s11 offen sc1
v_cvt_pk_bf16_f32 v180, v72, v73
v_cvt_pk_bf16_f32 v181, v74, v75
v_cvt_pk_bf16_f32 v182, v76, v77
v_cvt_pk_bf16_f32 v183, v78, v79
s_mov_b32 s11, 999424
buffer_store_dwordx4 v[180:183], v230, s[64:67], s11 offen sc1
v_cvt_pk_bf16_f32 v200, v80, v81
v_cvt_pk_bf16_f32 v201, v82, v83
v_cvt_pk_bf16_f32 v202, v84, v85
v_cvt_pk_bf16_f32 v203, v86, v87
s_mov_b32 s11, 425984
buffer_store_dwordx4 v[200:203], v230, s[64:67], s11 offen sc1
v_cvt_pk_bf16_f32 v204, v88, v89
v_cvt_pk_bf16_f32 v205, v90, v91
v_cvt_pk_bf16_f32 v206, v92, v93
v_cvt_pk_bf16_f32 v207, v94, v95
s_mov_b32 s11, 1015808
buffer_store_dwordx4 v[204:207], v230, s[64:67], s11 offen sc1
v_cvt_pk_bf16_f32 v176, v96, v97
v_cvt_pk_bf16_f32 v177, v98, v99
s_mov_b32 s11, 196608
buffer_store_dwordx2 v[176:177], v231, s[64:67], s11 offen sc1
v_cvt_pk_bf16_f32 v178, v100, v101
v_cvt_pk_bf16_f32 v179, v102, v103
s_mov_b32 s11, 204800
buffer_store_dwordx2 v[178:179], v231, s[64:67], s11 offen sc1
v_cvt_pk_bf16_f32 v180, v104, v105
v_cvt_pk_bf16_f32 v181, v106, v107
s_mov_b32 s11, 212992
buffer_store_dwordx2 v[180:181], v231, s[64:67], s11 offen sc1
s_endpgm
LB_H0:
s_nop 15
s_nop 15
s_waitcnt lgkmcnt(0)
v_max_f32 v211, v0, v1
v_max3_f32 v211, v211, v2, v3
v_max3_f32 v211, v211, v4, v5
v_max3_f32 v211, v211, v6, v7
ds_bpermute_b32 v213, v217, v211
s_waitcnt lgkmcnt(0)
v_max_f32 v211, v211, v213
ds_bpermute_b32 v213, v216, v211
s_waitcnt lgkmcnt(0)
v_max_f32 v211, v211, v213
v_max_f32 v211, 0, v211
v_sub_f32 v212, 0, v211
v_exp_f32 v212, v212
s_nop 0
v_mul_f32 v205, v205, v212
v_accvgpr_read_b32 v213, a0
v_mul_f32 v213, v213, v212
v_accvgpr_write_b32 a0, v213
v_accvgpr_read_b32 v214, a1
v_mul_f32 v214, v214, v212
v_accvgpr_write_b32 a1, v214
v_accvgpr_read_b32 v213, a2
v_mul_f32 v213, v213, v212
v_accvgpr_write_b32 a2, v213
v_accvgpr_read_b32 v214, a3
v_mul_f32 v214, v214, v212
v_accvgpr_write_b32 a3, v214
v_accvgpr_read_b32 v213, a4
v_mul_f32 v213, v213, v212
v_accvgpr_write_b32 a4, v213
v_accvgpr_read_b32 v214, a5
v_mul_f32 v214, v214, v212
v_accvgpr_write_b32 a5, v214
v_accvgpr_read_b32 v213, a6
v_mul_f32 v213, v213, v212
v_accvgpr_write_b32 a6, v213
v_accvgpr_read_b32 v214, a7
v_mul_f32 v214, v214, v212
v_accvgpr_write_b32 a7, v214
v_accvgpr_read_b32 v213, a8
v_mul_f32 v213, v213, v212
v_accvgpr_write_b32 a8, v213
v_accvgpr_read_b32 v214, a9
v_mul_f32 v214, v214, v212
v_accvgpr_write_b32 a9, v214
v_accvgpr_read_b32 v213, a10
v_mul_f32 v213, v213, v212
v_accvgpr_write_b32 a10, v213
v_accvgpr_read_b32 v214, a11
v_mul_f32 v214, v214, v212
v_accvgpr_write_b32 a11, v214
v_accvgpr_read_b32 v213, a12
v_mul_f32 v213, v213, v212
v_accvgpr_write_b32 a12, v213
v_accvgpr_read_b32 v214, a13
v_mul_f32 v214, v214, v212
v_accvgpr_write_b32 a13, v214
v_accvgpr_read_b32 v213, a14
v_mul_f32 v213, v213, v212
v_accvgpr_write_b32 a14, v213
v_accvgpr_read_b32 v214, a15
v_mul_f32 v214, v214, v212
v_accvgpr_write_b32 a15, v214
v_accvgpr_read_b32 v213, a16
v_mul_f32 v213, v213, v212
v_accvgpr_write_b32 a16, v213
v_accvgpr_read_b32 v214, a17
v_mul_f32 v214, v214, v212
v_accvgpr_write_b32 a17, v214
v_accvgpr_read_b32 v213, a18
v_mul_f32 v213, v213, v212
v_accvgpr_write_b32 a18, v213
v_accvgpr_read_b32 v214, a19
v_mul_f32 v214, v214, v212
v_accvgpr_write_b32 a19, v214
v_accvgpr_read_b32 v213, a20
v_mul_f32 v213, v213, v212
v_accvgpr_write_b32 a20, v213
v_accvgpr_read_b32 v214, a21
v_mul_f32 v214, v214, v212
v_accvgpr_write_b32 a21, v214
v_accvgpr_read_b32 v213, a22
v_mul_f32 v213, v213, v212
v_accvgpr_write_b32 a22, v213
v_accvgpr_read_b32 v214, a23
v_mul_f32 v214, v214, v212
v_accvgpr_write_b32 a23, v214
v_accvgpr_read_b32 v213, a24
v_mul_f32 v213, v213, v212
v_accvgpr_write_b32 a24, v213
v_accvgpr_read_b32 v214, a25
v_mul_f32 v214, v214, v212
v_accvgpr_write_b32 a25, v214
v_accvgpr_read_b32 v213, a26
v_mul_f32 v213, v213, v212
v_accvgpr_write_b32 a26, v213
v_accvgpr_read_b32 v214, a27
v_mul_f32 v214, v214, v212
v_accvgpr_write_b32 a27, v214
v_accvgpr_read_b32 v213, a28
v_mul_f32 v213, v213, v212
v_accvgpr_write_b32 a28, v213
v_accvgpr_read_b32 v214, a29
v_mul_f32 v214, v214, v212
v_accvgpr_write_b32 a29, v214
v_accvgpr_read_b32 v213, a30
v_mul_f32 v213, v213, v212
v_accvgpr_write_b32 a30, v213
v_accvgpr_read_b32 v214, a31
v_mul_f32 v214, v214, v212
v_accvgpr_write_b32 a31, v214
v_sub_f32 v72, v72, v211
v_sub_f32 v73, v73, v211
v_sub_f32 v74, v74, v211
v_sub_f32 v75, v75, v211
v_sub_f32 v32, v32, v211
v_sub_f32 v0, v0, v211
v_sub_f32 v33, v33, v211
v_sub_f32 v1, v1, v211
v_sub_f32 v34, v34, v211
v_sub_f32 v2, v2, v211
v_sub_f32 v35, v35, v211
v_sub_f32 v3, v3, v211
v_sub_f32 v36, v36, v211
v_sub_f32 v4, v4, v211
v_sub_f32 v37, v37, v211
v_sub_f32 v5, v5, v211
v_sub_f32 v38, v38, v211
v_sub_f32 v6, v6, v211
v_sub_f32 v39, v39, v211
v_sub_f32 v7, v7, v211
v_exp_f32 v213, v0
v_exp_f32 v214, v1
s_nop 0
v_add_f32 v144, v213, v214
v_cvt_pk_bf16_f32 v92, v213, v214
v_exp_f32 v213, v2
v_exp_f32 v214, v3
s_nop 0
v_add_f32 v144, v144, v213
v_add_f32 v144, v144, v214
v_cvt_pk_bf16_f32 v93, v213, v214
v_exp_f32 v213, v4
v_exp_f32 v214, v5
s_nop 0
v_add_f32 v144, v144, v213
v_add_f32 v144, v144, v214
v_cvt_pk_bf16_f32 v94, v213, v214
v_exp_f32 v213, v6
v_exp_f32 v214, v7
s_nop 0
v_add_f32 v144, v144, v213
v_add_f32 v144, v144, v214
v_cvt_pk_bf16_f32 v95, v213, v214
ds_bpermute_b32 v213, v217, v144
s_waitcnt lgkmcnt(0)
v_add_f32 v144, v144, v213
ds_bpermute_b32 v213, v216, v144
s_waitcnt lgkmcnt(0)
v_add_f32 v144, v144, v213
v_max_f32 v211, v8, v9
v_max3_f32 v211, v211, v10, v11
v_max3_f32 v211, v211, v12, v13
v_max3_f32 v211, v211, v14, v15
ds_bpermute_b32 v213, v217, v211
s_waitcnt lgkmcnt(0)
v_max_f32 v211, v211, v213
ds_bpermute_b32 v213, v216, v211
s_waitcnt lgkmcnt(0)
v_max_f32 v211, v211, v213
v_max_f32 v211, 0, v211
v_sub_f32 v212, 0, v211
v_exp_f32 v212, v212
s_nop 0
v_mul_f32 v206, v206, v212
v_accvgpr_read_b32 v213, a32
v_mul_f32 v213, v213, v212
v_accvgpr_write_b32 a32, v213
v_accvgpr_read_b32 v214, a33
v_mul_f32 v214, v214, v212
v_accvgpr_write_b32 a33, v214
v_accvgpr_read_b32 v213, a34
v_mul_f32 v213, v213, v212
v_accvgpr_write_b32 a34, v213
v_accvgpr_read_b32 v214, a35
v_mul_f32 v214, v214, v212
v_accvgpr_write_b32 a35, v214
v_accvgpr_read_b32 v213, a36
v_mul_f32 v213, v213, v212
v_accvgpr_write_b32 a36, v213
v_accvgpr_read_b32 v214, a37
v_mul_f32 v214, v214, v212
v_accvgpr_write_b32 a37, v214
v_accvgpr_read_b32 v213, a38
v_mul_f32 v213, v213, v212
v_accvgpr_write_b32 a38, v213
v_accvgpr_read_b32 v214, a39
v_mul_f32 v214, v214, v212
v_accvgpr_write_b32 a39, v214
v_accvgpr_read_b32 v213, a40
v_mul_f32 v213, v213, v212
v_accvgpr_write_b32 a40, v213
v_accvgpr_read_b32 v214, a41
v_mul_f32 v214, v214, v212
v_accvgpr_write_b32 a41, v214
v_accvgpr_read_b32 v213, a42
v_mul_f32 v213, v213, v212
v_accvgpr_write_b32 a42, v213
v_accvgpr_read_b32 v214, a43
v_mul_f32 v214, v214, v212
v_accvgpr_write_b32 a43, v214
v_accvgpr_read_b32 v213, a44
v_mul_f32 v213, v213, v212
v_accvgpr_write_b32 a44, v213
v_accvgpr_read_b32 v214, a45
v_mul_f32 v214, v214, v212
v_accvgpr_write_b32 a45, v214
v_accvgpr_read_b32 v213, a46
v_mul_f32 v213, v213, v212
v_accvgpr_write_b32 a46, v213
v_accvgpr_read_b32 v214, a47
v_mul_f32 v214, v214, v212
v_accvgpr_write_b32 a47, v214
v_accvgpr_read_b32 v213, a48
v_mul_f32 v213, v213, v212
v_accvgpr_write_b32 a48, v213
v_accvgpr_read_b32 v214, a49
v_mul_f32 v214, v214, v212
v_accvgpr_write_b32 a49, v214
v_accvgpr_read_b32 v213, a50
v_mul_f32 v213, v213, v212
v_accvgpr_write_b32 a50, v213
v_accvgpr_read_b32 v214, a51
v_mul_f32 v214, v214, v212
v_accvgpr_write_b32 a51, v214
v_accvgpr_read_b32 v213, a52
v_mul_f32 v213, v213, v212
v_accvgpr_write_b32 a52, v213
v_accvgpr_read_b32 v214, a53
v_mul_f32 v214, v214, v212
v_accvgpr_write_b32 a53, v214
v_accvgpr_read_b32 v213, a54
v_mul_f32 v213, v213, v212
v_accvgpr_write_b32 a54, v213
v_accvgpr_read_b32 v214, a55
v_mul_f32 v214, v214, v212
v_accvgpr_write_b32 a55, v214
v_accvgpr_read_b32 v213, a56
v_mul_f32 v213, v213, v212
v_accvgpr_write_b32 a56, v213
v_accvgpr_read_b32 v214, a57
v_mul_f32 v214, v214, v212
v_accvgpr_write_b32 a57, v214
v_accvgpr_read_b32 v213, a58
v_mul_f32 v213, v213, v212
v_accvgpr_write_b32 a58, v213
v_accvgpr_read_b32 v214, a59
v_mul_f32 v214, v214, v212
v_accvgpr_write_b32 a59, v214
v_accvgpr_read_b32 v213, a60
v_mul_f32 v213, v213, v212
v_accvgpr_write_b32 a60, v213
v_accvgpr_read_b32 v214, a61
v_mul_f32 v214, v214, v212
v_accvgpr_write_b32 a61, v214
v_accvgpr_read_b32 v213, a62
v_mul_f32 v213, v213, v212
v_accvgpr_write_b32 a62, v213
v_accvgpr_read_b32 v214, a63
v_mul_f32 v214, v214, v212
v_accvgpr_write_b32 a63, v214
v_sub_f32 v76, v76, v211
v_sub_f32 v77, v77, v211
v_sub_f32 v78, v78, v211
v_sub_f32 v79, v79, v211
v_sub_f32 v40, v40, v211
v_sub_f32 v8, v8, v211
v_sub_f32 v41, v41, v211
v_sub_f32 v9, v9, v211
v_sub_f32 v42, v42, v211
v_sub_f32 v10, v10, v211
v_sub_f32 v43, v43, v211
v_sub_f32 v11, v11, v211
v_sub_f32 v44, v44, v211
v_sub_f32 v12, v12, v211
v_sub_f32 v45, v45, v211
v_sub_f32 v13, v13, v211
v_sub_f32 v46, v46, v211
v_sub_f32 v14, v14, v211
v_sub_f32 v47, v47, v211
v_sub_f32 v15, v15, v211
v_exp_f32 v213, v8
v_exp_f32 v214, v9
s_nop 0
v_add_f32 v148, v213, v214
v_cvt_pk_bf16_f32 v96, v213, v214
v_exp_f32 v213, v10
v_exp_f32 v214, v11
s_nop 0
v_add_f32 v148, v148, v213
v_add_f32 v148, v148, v214
v_cvt_pk_bf16_f32 v97, v213, v214
v_exp_f32 v213, v12
v_exp_f32 v214, v13
s_nop 0
v_add_f32 v148, v148, v213
v_add_f32 v148, v148, v214
v_cvt_pk_bf16_f32 v98, v213, v214
v_exp_f32 v213, v14
v_exp_f32 v214, v15
s_nop 0
v_add_f32 v148, v148, v213
v_add_f32 v148, v148, v214
v_cvt_pk_bf16_f32 v99, v213, v214
ds_bpermute_b32 v213, v217, v148
s_waitcnt lgkmcnt(0)
v_add_f32 v148, v148, v213
ds_bpermute_b32 v213, v216, v148
s_waitcnt lgkmcnt(0)
v_add_f32 v148, v148, v213
v_max_f32 v211, v16, v17
v_max3_f32 v211, v211, v18, v19
v_max3_f32 v211, v211, v20, v21
v_max3_f32 v211, v211, v22, v23
ds_bpermute_b32 v213, v217, v211
s_waitcnt lgkmcnt(0)
v_max_f32 v211, v211, v213
ds_bpermute_b32 v213, v216, v211
s_waitcnt lgkmcnt(0)
v_max_f32 v211, v211, v213
v_max_f32 v211, 0, v211
v_sub_f32 v212, 0, v211
v_exp_f32 v212, v212
s_nop 0
v_mul_f32 v207, v207, v212
v_accvgpr_read_b32 v213, a64
v_mul_f32 v213, v213, v212
v_accvgpr_write_b32 a64, v213
v_accvgpr_read_b32 v214, a65
v_mul_f32 v214, v214, v212
v_accvgpr_write_b32 a65, v214
v_accvgpr_read_b32 v213, a66
v_mul_f32 v213, v213, v212
v_accvgpr_write_b32 a66, v213
v_accvgpr_read_b32 v214, a67
v_mul_f32 v214, v214, v212
v_accvgpr_write_b32 a67, v214
v_accvgpr_read_b32 v213, a68
v_mul_f32 v213, v213, v212
v_accvgpr_write_b32 a68, v213
v_accvgpr_read_b32 v214, a69
v_mul_f32 v214, v214, v212
v_accvgpr_write_b32 a69, v214
v_accvgpr_read_b32 v213, a70
v_mul_f32 v213, v213, v212
v_accvgpr_write_b32 a70, v213
v_accvgpr_read_b32 v214, a71
v_mul_f32 v214, v214, v212
v_accvgpr_write_b32 a71, v214
v_accvgpr_read_b32 v213, a72
v_mul_f32 v213, v213, v212
v_accvgpr_write_b32 a72, v213
v_accvgpr_read_b32 v214, a73
v_mul_f32 v214, v214, v212
v_accvgpr_write_b32 a73, v214
v_accvgpr_read_b32 v213, a74
v_mul_f32 v213, v213, v212
v_accvgpr_write_b32 a74, v213
v_accvgpr_read_b32 v214, a75
v_mul_f32 v214, v214, v212
v_accvgpr_write_b32 a75, v214
v_accvgpr_read_b32 v213, a76
v_mul_f32 v213, v213, v212
v_accvgpr_write_b32 a76, v213
v_accvgpr_read_b32 v214, a77
v_mul_f32 v214, v214, v212
v_accvgpr_write_b32 a77, v214
v_accvgpr_read_b32 v213, a78
v_mul_f32 v213, v213, v212
v_accvgpr_write_b32 a78, v213
v_accvgpr_read_b32 v214, a79
v_mul_f32 v214, v214, v212
v_accvgpr_write_b32 a79, v214
v_accvgpr_read_b32 v213, a80
v_mul_f32 v213, v213, v212
v_accvgpr_write_b32 a80, v213
v_accvgpr_read_b32 v214, a81
v_mul_f32 v214, v214, v212
v_accvgpr_write_b32 a81, v214
v_accvgpr_read_b32 v213, a82
v_mul_f32 v213, v213, v212
v_accvgpr_write_b32 a82, v213
v_accvgpr_read_b32 v214, a83
v_mul_f32 v214, v214, v212
v_accvgpr_write_b32 a83, v214
v_accvgpr_read_b32 v213, a84
v_mul_f32 v213, v213, v212
v_accvgpr_write_b32 a84, v213
v_accvgpr_read_b32 v214, a85
v_mul_f32 v214, v214, v212
v_accvgpr_write_b32 a85, v214
v_accvgpr_read_b32 v213, a86
v_mul_f32 v213, v213, v212
v_accvgpr_write_b32 a86, v213
v_accvgpr_read_b32 v214, a87
v_mul_f32 v214, v214, v212
v_accvgpr_write_b32 a87, v214
v_accvgpr_read_b32 v213, a88
v_mul_f32 v213, v213, v212
v_accvgpr_write_b32 a88, v213
v_accvgpr_read_b32 v214, a89
v_mul_f32 v214, v214, v212
v_accvgpr_write_b32 a89, v214
v_accvgpr_read_b32 v213, a90
v_mul_f32 v213, v213, v212
v_accvgpr_write_b32 a90, v213
v_accvgpr_read_b32 v214, a91
v_mul_f32 v214, v214, v212
v_accvgpr_write_b32 a91, v214
v_accvgpr_read_b32 v213, a92
v_mul_f32 v213, v213, v212
v_accvgpr_write_b32 a92, v213
v_accvgpr_read_b32 v214, a93
v_mul_f32 v214, v214, v212
v_accvgpr_write_b32 a93, v214
v_accvgpr_read_b32 v213, a94
v_mul_f32 v213, v213, v212
v_accvgpr_write_b32 a94, v213
v_accvgpr_read_b32 v214, a95
v_mul_f32 v214, v214, v212
v_accvgpr_write_b32 a95, v214
v_sub_f32 v80, v80, v211
v_sub_f32 v81, v81, v211
v_sub_f32 v82, v82, v211
v_sub_f32 v83, v83, v211
v_sub_f32 v48, v48, v211
v_sub_f32 v16, v16, v211
v_sub_f32 v49, v49, v211
v_sub_f32 v17, v17, v211
v_sub_f32 v50, v50, v211
v_sub_f32 v18, v18, v211
v_sub_f32 v51, v51, v211
v_sub_f32 v19, v19, v211
v_sub_f32 v52, v52, v211
v_sub_f32 v20, v20, v211
v_sub_f32 v53, v53, v211
v_sub_f32 v21, v21, v211
v_sub_f32 v54, v54, v211
v_sub_f32 v22, v22, v211
v_sub_f32 v55, v55, v211
v_sub_f32 v23, v23, v211
v_exp_f32 v213, v16
v_exp_f32 v214, v17
s_nop 0
v_add_f32 v152, v213, v214
v_cvt_pk_bf16_f32 v100, v213, v214
v_exp_f32 v213, v18
v_exp_f32 v214, v19
s_nop 0
v_add_f32 v152, v152, v213
v_add_f32 v152, v152, v214
v_cvt_pk_bf16_f32 v101, v213, v214
v_exp_f32 v213, v20
v_exp_f32 v214, v21
s_nop 0
v_add_f32 v152, v152, v213
v_add_f32 v152, v152, v214
v_cvt_pk_bf16_f32 v102, v213, v214
v_exp_f32 v213, v22
v_exp_f32 v214, v23
s_nop 0
v_add_f32 v152, v152, v213
v_add_f32 v152, v152, v214
v_cvt_pk_bf16_f32 v103, v213, v214
ds_bpermute_b32 v213, v217, v152
s_waitcnt lgkmcnt(0)
v_add_f32 v152, v152, v213
ds_bpermute_b32 v213, v216, v152
s_waitcnt lgkmcnt(0)
v_add_f32 v152, v152, v213
v_max_f32 v211, v24, v25
v_max3_f32 v211, v211, v26, v27
v_max3_f32 v211, v211, v28, v29
v_max3_f32 v211, v211, v30, v31
ds_bpermute_b32 v213, v217, v211
s_waitcnt lgkmcnt(0)
v_max_f32 v211, v211, v213
ds_bpermute_b32 v213, v216, v211
s_waitcnt lgkmcnt(0)
v_max_f32 v211, v211, v213
v_max_f32 v211, 0, v211
v_sub_f32 v212, 0, v211
v_exp_f32 v212, v212
s_nop 0
v_mul_f32 v208, v208, v212
v_accvgpr_read_b32 v213, a96
v_mul_f32 v213, v213, v212
v_accvgpr_write_b32 a96, v213
v_accvgpr_read_b32 v214, a97
v_mul_f32 v214, v214, v212
v_accvgpr_write_b32 a97, v214
v_accvgpr_read_b32 v213, a98
v_mul_f32 v213, v213, v212
v_accvgpr_write_b32 a98, v213
v_accvgpr_read_b32 v214, a99
v_mul_f32 v214, v214, v212
v_accvgpr_write_b32 a99, v214
v_accvgpr_read_b32 v213, a100
v_mul_f32 v213, v213, v212
v_accvgpr_write_b32 a100, v213
v_accvgpr_read_b32 v214, a101
v_mul_f32 v214, v214, v212
v_accvgpr_write_b32 a101, v214
v_accvgpr_read_b32 v213, a102
v_mul_f32 v213, v213, v212
v_accvgpr_write_b32 a102, v213
v_accvgpr_read_b32 v214, a103
v_mul_f32 v214, v214, v212
v_accvgpr_write_b32 a103, v214
v_accvgpr_read_b32 v213, a104
v_mul_f32 v213, v213, v212
v_accvgpr_write_b32 a104, v213
v_accvgpr_read_b32 v214, a105
v_mul_f32 v214, v214, v212
v_accvgpr_write_b32 a105, v214
v_accvgpr_read_b32 v213, a106
v_mul_f32 v213, v213, v212
v_accvgpr_write_b32 a106, v213
v_accvgpr_read_b32 v214, a107
v_mul_f32 v214, v214, v212
v_accvgpr_write_b32 a107, v214
v_accvgpr_read_b32 v213, a108
v_mul_f32 v213, v213, v212
v_accvgpr_write_b32 a108, v213
v_accvgpr_read_b32 v214, a109
v_mul_f32 v214, v214, v212
v_accvgpr_write_b32 a109, v214
v_accvgpr_read_b32 v213, a110
v_mul_f32 v213, v213, v212
v_accvgpr_write_b32 a110, v213
v_accvgpr_read_b32 v214, a111
v_mul_f32 v214, v214, v212
v_accvgpr_write_b32 a111, v214
v_accvgpr_read_b32 v213, a112
v_mul_f32 v213, v213, v212
v_accvgpr_write_b32 a112, v213
v_accvgpr_read_b32 v214, a113
v_mul_f32 v214, v214, v212
v_accvgpr_write_b32 a113, v214
v_accvgpr_read_b32 v213, a114
v_mul_f32 v213, v213, v212
v_accvgpr_write_b32 a114, v213
v_accvgpr_read_b32 v214, a115
v_mul_f32 v214, v214, v212
v_accvgpr_write_b32 a115, v214
v_accvgpr_read_b32 v213, a116
v_mul_f32 v213, v213, v212
v_accvgpr_write_b32 a116, v213
v_accvgpr_read_b32 v214, a117
v_mul_f32 v214, v214, v212
v_accvgpr_write_b32 a117, v214
v_accvgpr_read_b32 v213, a118
v_mul_f32 v213, v213, v212
v_accvgpr_write_b32 a118, v213
v_accvgpr_read_b32 v214, a119
v_mul_f32 v214, v214, v212
v_accvgpr_write_b32 a119, v214
v_accvgpr_read_b32 v213, a120
v_mul_f32 v213, v213, v212
v_accvgpr_write_b32 a120, v213
v_accvgpr_read_b32 v214, a121
v_mul_f32 v214, v214, v212
v_accvgpr_write_b32 a121, v214
v_accvgpr_read_b32 v213, a122
v_mul_f32 v213, v213, v212
v_accvgpr_write_b32 a122, v213
v_accvgpr_read_b32 v214, a123
v_mul_f32 v214, v214, v212
v_accvgpr_write_b32 a123, v214
v_accvgpr_read_b32 v213, a124
v_mul_f32 v213, v213, v212
v_accvgpr_write_b32 a124, v213
v_accvgpr_read_b32 v214, a125
v_mul_f32 v214, v214, v212
v_accvgpr_write_b32 a125, v214
v_accvgpr_read_b32 v213, a126
v_mul_f32 v213, v213, v212
v_accvgpr_write_b32 a126, v213
v_accvgpr_read_b32 v214, a127
v_mul_f32 v214, v214, v212
v_accvgpr_write_b32 a127, v214
v_sub_f32 v84, v84, v211
v_sub_f32 v85, v85, v211
v_sub_f32 v86, v86, v211
v_sub_f32 v87, v87, v211
v_sub_f32 v56, v56, v211
v_sub_f32 v24, v24, v211
v_sub_f32 v57, v57, v211
v_sub_f32 v25, v25, v211
v_sub_f32 v58, v58, v211
v_sub_f32 v26, v26, v211
v_sub_f32 v59, v59, v211
v_sub_f32 v27, v27, v211
v_sub_f32 v60, v60, v211
v_sub_f32 v28, v28, v211
v_sub_f32 v61, v61, v211
v_sub_f32 v29, v29, v211
v_sub_f32 v62, v62, v211
v_sub_f32 v30, v30, v211
v_sub_f32 v63, v63, v211
v_sub_f32 v31, v31, v211
v_exp_f32 v213, v24
v_exp_f32 v214, v25
s_nop 0
v_add_f32 v156, v213, v214
v_cvt_pk_bf16_f32 v104, v213, v214
v_exp_f32 v213, v26
v_exp_f32 v214, v27
s_nop 0
v_add_f32 v156, v156, v213
v_add_f32 v156, v156, v214
v_cvt_pk_bf16_f32 v105, v213, v214
v_exp_f32 v213, v28
v_exp_f32 v214, v29
s_nop 0
v_add_f32 v156, v156, v213
v_add_f32 v156, v156, v214
v_cvt_pk_bf16_f32 v106, v213, v214
v_exp_f32 v213, v30
v_exp_f32 v214, v31
s_nop 0
v_add_f32 v156, v156, v213
v_add_f32 v156, v156, v214
v_cvt_pk_bf16_f32 v107, v213, v214
ds_bpermute_b32 v213, v217, v156
s_waitcnt lgkmcnt(0)
v_add_f32 v156, v156, v213
ds_bpermute_b32 v213, v216, v156
s_waitcnt lgkmcnt(0)
v_add_f32 v156, v156, v213
s_nop 3
s_cmp_eq_u32 s73, 2
s_cbranch_scc1 LB_ret_6
s_cmp_eq_u32 s73, 5
s_cbranch_scc1 LB_ret_12
s_branch LB_ret_19
LB_H1:
s_nop 15
s_nop 15
s_waitcnt lgkmcnt(0)
v_max_f32 v211, v32, v33
v_max3_f32 v211, v211, v34, v35
v_max3_f32 v211, v211, v36, v37
v_max3_f32 v211, v211, v38, v39
ds_bpermute_b32 v213, v217, v211
s_waitcnt lgkmcnt(0)
v_max_f32 v211, v211, v213
ds_bpermute_b32 v213, v216, v211
s_waitcnt lgkmcnt(0)
v_max_f32 v211, v211, v213
v_max_f32 v211, 0, v211
v_sub_f32 v212, 0, v211
v_exp_f32 v212, v212
s_nop 0
v_mul_f32 v205, v205, v212
v_accvgpr_read_b32 v213, a0
v_mul_f32 v213, v213, v212
v_accvgpr_write_b32 a0, v213
v_accvgpr_read_b32 v214, a1
v_mul_f32 v214, v214, v212
v_accvgpr_write_b32 a1, v214
v_accvgpr_read_b32 v213, a2
v_mul_f32 v213, v213, v212
v_accvgpr_write_b32 a2, v213
v_accvgpr_read_b32 v214, a3
v_mul_f32 v214, v214, v212
v_accvgpr_write_b32 a3, v214
v_accvgpr_read_b32 v213, a4
v_mul_f32 v213, v213, v212
v_accvgpr_write_b32 a4, v213
v_accvgpr_read_b32 v214, a5
v_mul_f32 v214, v214, v212
v_accvgpr_write_b32 a5, v214
v_accvgpr_read_b32 v213, a6
v_mul_f32 v213, v213, v212
v_accvgpr_write_b32 a6, v213
v_accvgpr_read_b32 v214, a7
v_mul_f32 v214, v214, v212
v_accvgpr_write_b32 a7, v214
v_accvgpr_read_b32 v213, a8
v_mul_f32 v213, v213, v212
v_accvgpr_write_b32 a8, v213
v_accvgpr_read_b32 v214, a9
v_mul_f32 v214, v214, v212
v_accvgpr_write_b32 a9, v214
v_accvgpr_read_b32 v213, a10
v_mul_f32 v213, v213, v212
v_accvgpr_write_b32 a10, v213
v_accvgpr_read_b32 v214, a11
v_mul_f32 v214, v214, v212
v_accvgpr_write_b32 a11, v214
v_accvgpr_read_b32 v213, a12
v_mul_f32 v213, v213, v212
v_accvgpr_write_b32 a12, v213
v_accvgpr_read_b32 v214, a13
v_mul_f32 v214, v214, v212
v_accvgpr_write_b32 a13, v214
v_accvgpr_read_b32 v213, a14
v_mul_f32 v213, v213, v212
v_accvgpr_write_b32 a14, v213
v_accvgpr_read_b32 v214, a15
v_mul_f32 v214, v214, v212
v_accvgpr_write_b32 a15, v214
v_accvgpr_read_b32 v213, a16
v_mul_f32 v213, v213, v212
v_accvgpr_write_b32 a16, v213
v_accvgpr_read_b32 v214, a17
v_mul_f32 v214, v214, v212
v_accvgpr_write_b32 a17, v214
v_accvgpr_read_b32 v213, a18
v_mul_f32 v213, v213, v212
v_accvgpr_write_b32 a18, v213
v_accvgpr_read_b32 v214, a19
v_mul_f32 v214, v214, v212
v_accvgpr_write_b32 a19, v214
v_accvgpr_read_b32 v213, a20
v_mul_f32 v213, v213, v212
v_accvgpr_write_b32 a20, v213
v_accvgpr_read_b32 v214, a21
v_mul_f32 v214, v214, v212
v_accvgpr_write_b32 a21, v214
v_accvgpr_read_b32 v213, a22
v_mul_f32 v213, v213, v212
v_accvgpr_write_b32 a22, v213
v_accvgpr_read_b32 v214, a23
v_mul_f32 v214, v214, v212
v_accvgpr_write_b32 a23, v214
v_accvgpr_read_b32 v213, a24
v_mul_f32 v213, v213, v212
v_accvgpr_write_b32 a24, v213
v_accvgpr_read_b32 v214, a25
v_mul_f32 v214, v214, v212
v_accvgpr_write_b32 a25, v214
v_accvgpr_read_b32 v213, a26
v_mul_f32 v213, v213, v212
v_accvgpr_write_b32 a26, v213
v_accvgpr_read_b32 v214, a27
v_mul_f32 v214, v214, v212
v_accvgpr_write_b32 a27, v214
v_accvgpr_read_b32 v213, a28
v_mul_f32 v213, v213, v212
v_accvgpr_write_b32 a28, v213
v_accvgpr_read_b32 v214, a29
v_mul_f32 v214, v214, v212
v_accvgpr_write_b32 a29, v214
v_accvgpr_read_b32 v213, a30
v_mul_f32 v213, v213, v212
v_accvgpr_write_b32 a30, v213
v_accvgpr_read_b32 v214, a31
v_mul_f32 v214, v214, v212
v_accvgpr_write_b32 a31, v214
v_sub_f32 v72, v72, v211
v_sub_f32 v73, v73, v211
v_sub_f32 v74, v74, v211
v_sub_f32 v75, v75, v211
v_sub_f32 v0, v0, v211
v_sub_f32 v32, v32, v211
v_sub_f32 v1, v1, v211
v_sub_f32 v33, v33, v211
v_sub_f32 v2, v2, v211
v_sub_f32 v34, v34, v211
v_sub_f32 v3, v3, v211
v_sub_f32 v35, v35, v211
v_sub_f32 v4, v4, v211
v_sub_f32 v36, v36, v211
v_sub_f32 v5, v5, v211
v_sub_f32 v37, v37, v211
v_sub_f32 v6, v6, v211
v_sub_f32 v38, v38, v211
v_sub_f32 v7, v7, v211
v_sub_f32 v39, v39, v211
v_exp_f32 v213, v32
v_exp_f32 v214, v33
s_nop 0
v_add_f32 v144, v213, v214
v_cvt_pk_bf16_f32 v108, v213, v214
v_exp_f32 v213, v34
v_exp_f32 v214, v35
s_nop 0
v_add_f32 v144, v144, v213
v_add_f32 v144, v144, v214
v_cvt_pk_bf16_f32 v109, v213, v214
v_exp_f32 v213, v36
v_exp_f32 v214, v37
s_nop 0
v_add_f32 v144, v144, v213
v_add_f32 v144, v144, v214
v_cvt_pk_bf16_f32 v110, v213, v214
v_exp_f32 v213, v38
v_exp_f32 v214, v39
s_nop 0
v_add_f32 v144, v144, v213
v_add_f32 v144, v144, v214
v_cvt_pk_bf16_f32 v111, v213, v214
ds_bpermute_b32 v213, v217, v144
s_waitcnt lgkmcnt(0)
v_add_f32 v144, v144, v213
ds_bpermute_b32 v213, v216, v144
s_waitcnt lgkmcnt(0)
v_add_f32 v144, v144, v213
v_max_f32 v211, v40, v41
v_max3_f32 v211, v211, v42, v43
v_max3_f32 v211, v211, v44, v45
v_max3_f32 v211, v211, v46, v47
ds_bpermute_b32 v213, v217, v211
s_waitcnt lgkmcnt(0)
v_max_f32 v211, v211, v213
ds_bpermute_b32 v213, v216, v211
s_waitcnt lgkmcnt(0)
v_max_f32 v211, v211, v213
v_max_f32 v211, 0, v211
v_sub_f32 v212, 0, v211
v_exp_f32 v212, v212
s_nop 0
v_mul_f32 v206, v206, v212
v_accvgpr_read_b32 v213, a32
v_mul_f32 v213, v213, v212
v_accvgpr_write_b32 a32, v213
v_accvgpr_read_b32 v214, a33
v_mul_f32 v214, v214, v212
v_accvgpr_write_b32 a33, v214
v_accvgpr_read_b32 v213, a34
v_mul_f32 v213, v213, v212
v_accvgpr_write_b32 a34, v213
v_accvgpr_read_b32 v214, a35
v_mul_f32 v214, v214, v212
v_accvgpr_write_b32 a35, v214
v_accvgpr_read_b32 v213, a36
v_mul_f32 v213, v213, v212
v_accvgpr_write_b32 a36, v213
v_accvgpr_read_b32 v214, a37
v_mul_f32 v214, v214, v212
v_accvgpr_write_b32 a37, v214
v_accvgpr_read_b32 v213, a38
v_mul_f32 v213, v213, v212
v_accvgpr_write_b32 a38, v213
v_accvgpr_read_b32 v214, a39
v_mul_f32 v214, v214, v212
v_accvgpr_write_b32 a39, v214
v_accvgpr_read_b32 v213, a40
v_mul_f32 v213, v213, v212
v_accvgpr_write_b32 a40, v213
v_accvgpr_read_b32 v214, a41
v_mul_f32 v214, v214, v212
v_accvgpr_write_b32 a41, v214
v_accvgpr_read_b32 v213, a42
v_mul_f32 v213, v213, v212
v_accvgpr_write_b32 a42, v213
v_accvgpr_read_b32 v214, a43
v_mul_f32 v214, v214, v212
v_accvgpr_write_b32 a43, v214
v_accvgpr_read_b32 v213, a44
v_mul_f32 v213, v213, v212
v_accvgpr_write_b32 a44, v213
v_accvgpr_read_b32 v214, a45
v_mul_f32 v214, v214, v212
v_accvgpr_write_b32 a45, v214
v_accvgpr_read_b32 v213, a46
v_mul_f32 v213, v213, v212
v_accvgpr_write_b32 a46, v213
v_accvgpr_read_b32 v214, a47
v_mul_f32 v214, v214, v212
v_accvgpr_write_b32 a47, v214
v_accvgpr_read_b32 v213, a48
v_mul_f32 v213, v213, v212
v_accvgpr_write_b32 a48, v213
v_accvgpr_read_b32 v214, a49
v_mul_f32 v214, v214, v212
v_accvgpr_write_b32 a49, v214
v_accvgpr_read_b32 v213, a50
v_mul_f32 v213, v213, v212
v_accvgpr_write_b32 a50, v213
v_accvgpr_read_b32 v214, a51
v_mul_f32 v214, v214, v212
v_accvgpr_write_b32 a51, v214
v_accvgpr_read_b32 v213, a52
v_mul_f32 v213, v213, v212
v_accvgpr_write_b32 a52, v213
v_accvgpr_read_b32 v214, a53
v_mul_f32 v214, v214, v212
v_accvgpr_write_b32 a53, v214
v_accvgpr_read_b32 v213, a54
v_mul_f32 v213, v213, v212
v_accvgpr_write_b32 a54, v213
v_accvgpr_read_b32 v214, a55
v_mul_f32 v214, v214, v212
v_accvgpr_write_b32 a55, v214
v_accvgpr_read_b32 v213, a56
v_mul_f32 v213, v213, v212
v_accvgpr_write_b32 a56, v213
v_accvgpr_read_b32 v214, a57
v_mul_f32 v214, v214, v212
v_accvgpr_write_b32 a57, v214
v_accvgpr_read_b32 v213, a58
v_mul_f32 v213, v213, v212
v_accvgpr_write_b32 a58, v213
v_accvgpr_read_b32 v214, a59
v_mul_f32 v214, v214, v212
v_accvgpr_write_b32 a59, v214
v_accvgpr_read_b32 v213, a60
v_mul_f32 v213, v213, v212
v_accvgpr_write_b32 a60, v213
v_accvgpr_read_b32 v214, a61
v_mul_f32 v214, v214, v212
v_accvgpr_write_b32 a61, v214
v_accvgpr_read_b32 v213, a62
v_mul_f32 v213, v213, v212
v_accvgpr_write_b32 a62, v213
v_accvgpr_read_b32 v214, a63
v_mul_f32 v214, v214, v212
v_accvgpr_write_b32 a63, v214
v_sub_f32 v76, v76, v211
v_sub_f32 v77, v77, v211
v_sub_f32 v78, v78, v211
v_sub_f32 v79, v79, v211
v_sub_f32 v8, v8, v211
v_sub_f32 v40, v40, v211
v_sub_f32 v9, v9, v211
v_sub_f32 v41, v41, v211
v_sub_f32 v10, v10, v211
v_sub_f32 v42, v42, v211
v_sub_f32 v11, v11, v211
v_sub_f32 v43, v43, v211
v_sub_f32 v12, v12, v211
v_sub_f32 v44, v44, v211
v_sub_f32 v13, v13, v211
v_sub_f32 v45, v45, v211
v_sub_f32 v14, v14, v211
v_sub_f32 v46, v46, v211
v_sub_f32 v15, v15, v211
v_sub_f32 v47, v47, v211
v_exp_f32 v213, v40
v_exp_f32 v214, v41
s_nop 0
v_add_f32 v148, v213, v214
v_cvt_pk_bf16_f32 v112, v213, v214
v_exp_f32 v213, v42
v_exp_f32 v214, v43
s_nop 0
v_add_f32 v148, v148, v213
v_add_f32 v148, v148, v214
v_cvt_pk_bf16_f32 v113, v213, v214
v_exp_f32 v213, v44
v_exp_f32 v214, v45
s_nop 0
v_add_f32 v148, v148, v213
v_add_f32 v148, v148, v214
v_cvt_pk_bf16_f32 v114, v213, v214
v_exp_f32 v213, v46
v_exp_f32 v214, v47
s_nop 0
v_add_f32 v148, v148, v213
v_add_f32 v148, v148, v214
v_cvt_pk_bf16_f32 v115, v213, v214
ds_bpermute_b32 v213, v217, v148
s_waitcnt lgkmcnt(0)
v_add_f32 v148, v148, v213
ds_bpermute_b32 v213, v216, v148
s_waitcnt lgkmcnt(0)
v_add_f32 v148, v148, v213
v_max_f32 v211, v48, v49
v_max3_f32 v211, v211, v50, v51
v_max3_f32 v211, v211, v52, v53
v_max3_f32 v211, v211, v54, v55
ds_bpermute_b32 v213, v217, v211
s_waitcnt lgkmcnt(0)
v_max_f32 v211, v211, v213
ds_bpermute_b32 v213, v216, v211
s_waitcnt lgkmcnt(0)
v_max_f32 v211, v211, v213
v_max_f32 v211, 0, v211
v_sub_f32 v212, 0, v211
v_exp_f32 v212, v212
s_nop 0
v_mul_f32 v207, v207, v212
v_accvgpr_read_b32 v213, a64
v_mul_f32 v213, v213, v212
v_accvgpr_write_b32 a64, v213
v_accvgpr_read_b32 v214, a65
v_mul_f32 v214, v214, v212
v_accvgpr_write_b32 a65, v214
v_accvgpr_read_b32 v213, a66
v_mul_f32 v213, v213, v212
v_accvgpr_write_b32 a66, v213
v_accvgpr_read_b32 v214, a67
v_mul_f32 v214, v214, v212
v_accvgpr_write_b32 a67, v214
v_accvgpr_read_b32 v213, a68
v_mul_f32 v213, v213, v212
v_accvgpr_write_b32 a68, v213
v_accvgpr_read_b32 v214, a69
v_mul_f32 v214, v214, v212
v_accvgpr_write_b32 a69, v214
v_accvgpr_read_b32 v213, a70
v_mul_f32 v213, v213, v212
v_accvgpr_write_b32 a70, v213
v_accvgpr_read_b32 v214, a71
v_mul_f32 v214, v214, v212
v_accvgpr_write_b32 a71, v214
v_accvgpr_read_b32 v213, a72
v_mul_f32 v213, v213, v212
v_accvgpr_write_b32 a72, v213
v_accvgpr_read_b32 v214, a73
v_mul_f32 v214, v214, v212
v_accvgpr_write_b32 a73, v214
v_accvgpr_read_b32 v213, a74
v_mul_f32 v213, v213, v212
v_accvgpr_write_b32 a74, v213
v_accvgpr_read_b32 v214, a75
v_mul_f32 v214, v214, v212
v_accvgpr_write_b32 a75, v214
v_accvgpr_read_b32 v213, a76
v_mul_f32 v213, v213, v212
v_accvgpr_write_b32 a76, v213
v_accvgpr_read_b32 v214, a77
v_mul_f32 v214, v214, v212
v_accvgpr_write_b32 a77, v214
v_accvgpr_read_b32 v213, a78
v_mul_f32 v213, v213, v212
v_accvgpr_write_b32 a78, v213
v_accvgpr_read_b32 v214, a79
v_mul_f32 v214, v214, v212
v_accvgpr_write_b32 a79, v214
v_accvgpr_read_b32 v213, a80
v_mul_f32 v213, v213, v212
v_accvgpr_write_b32 a80, v213
v_accvgpr_read_b32 v214, a81
v_mul_f32 v214, v214, v212
v_accvgpr_write_b32 a81, v214
v_accvgpr_read_b32 v213, a82
v_mul_f32 v213, v213, v212
v_accvgpr_write_b32 a82, v213
v_accvgpr_read_b32 v214, a83
v_mul_f32 v214, v214, v212
v_accvgpr_write_b32 a83, v214
v_accvgpr_read_b32 v213, a84
v_mul_f32 v213, v213, v212
v_accvgpr_write_b32 a84, v213
v_accvgpr_read_b32 v214, a85
v_mul_f32 v214, v214, v212
v_accvgpr_write_b32 a85, v214
v_accvgpr_read_b32 v213, a86
v_mul_f32 v213, v213, v212
v_accvgpr_write_b32 a86, v213
v_accvgpr_read_b32 v214, a87
v_mul_f32 v214, v214, v212
v_accvgpr_write_b32 a87, v214
v_accvgpr_read_b32 v213, a88
v_mul_f32 v213, v213, v212
v_accvgpr_write_b32 a88, v213
v_accvgpr_read_b32 v214, a89
v_mul_f32 v214, v214, v212
v_accvgpr_write_b32 a89, v214
v_accvgpr_read_b32 v213, a90
v_mul_f32 v213, v213, v212
v_accvgpr_write_b32 a90, v213
v_accvgpr_read_b32 v214, a91
v_mul_f32 v214, v214, v212
v_accvgpr_write_b32 a91, v214
v_accvgpr_read_b32 v213, a92
v_mul_f32 v213, v213, v212
v_accvgpr_write_b32 a92, v213
v_accvgpr_read_b32 v214, a93
v_mul_f32 v214, v214, v212
v_accvgpr_write_b32 a93, v214
v_accvgpr_read_b32 v213, a94
v_mul_f32 v213, v213, v212
v_accvgpr_write_b32 a94, v213
v_accvgpr_read_b32 v214, a95
v_mul_f32 v214, v214, v212
v_accvgpr_write_b32 a95, v214
v_sub_f32 v80, v80, v211
v_sub_f32 v81, v81, v211
v_sub_f32 v82, v82, v211
v_sub_f32 v83, v83, v211
v_sub_f32 v16, v16, v211
v_sub_f32 v48, v48, v211
v_sub_f32 v17, v17, v211
v_sub_f32 v49, v49, v211
v_sub_f32 v18, v18, v211
v_sub_f32 v50, v50, v211
v_sub_f32 v19, v19, v211
v_sub_f32 v51, v51, v211
v_sub_f32 v20, v20, v211
v_sub_f32 v52, v52, v211
v_sub_f32 v21, v21, v211
v_sub_f32 v53, v53, v211
v_sub_f32 v22, v22, v211
v_sub_f32 v54, v54, v211
v_sub_f32 v23, v23, v211
v_sub_f32 v55, v55, v211
v_exp_f32 v213, v48
v_exp_f32 v214, v49
s_nop 0
v_add_f32 v152, v213, v214
v_cvt_pk_bf16_f32 v116, v213, v214
v_exp_f32 v213, v50
v_exp_f32 v214, v51
s_nop 0
v_add_f32 v152, v152, v213
v_add_f32 v152, v152, v214
v_cvt_pk_bf16_f32 v117, v213, v214
v_exp_f32 v213, v52
v_exp_f32 v214, v53
s_nop 0
v_add_f32 v152, v152, v213
v_add_f32 v152, v152, v214
v_cvt_pk_bf16_f32 v118, v213, v214
v_exp_f32 v213, v54
v_exp_f32 v214, v55
s_nop 0
v_add_f32 v152, v152, v213
v_add_f32 v152, v152, v214
v_cvt_pk_bf16_f32 v119, v213, v214
ds_bpermute_b32 v213, v217, v152
s_waitcnt lgkmcnt(0)
v_add_f32 v152, v152, v213
ds_bpermute_b32 v213, v216, v152
s_waitcnt lgkmcnt(0)
v_add_f32 v152, v152, v213
v_max_f32 v211, v56, v57
v_max3_f32 v211, v211, v58, v59
v_max3_f32 v211, v211, v60, v61
v_max3_f32 v211, v211, v62, v63
ds_bpermute_b32 v213, v217, v211
s_waitcnt lgkmcnt(0)
v_max_f32 v211, v211, v213
ds_bpermute_b32 v213, v216, v211
s_waitcnt lgkmcnt(0)
v_max_f32 v211, v211, v213
v_max_f32 v211, 0, v211
v_sub_f32 v212, 0, v211
v_exp_f32 v212, v212
s_nop 0
v_mul_f32 v208, v208, v212
v_accvgpr_read_b32 v213, a96
v_mul_f32 v213, v213, v212
v_accvgpr_write_b32 a96, v213
v_accvgpr_read_b32 v214, a97
v_mul_f32 v214, v214, v212
v_accvgpr_write_b32 a97, v214
v_accvgpr_read_b32 v213, a98
v_mul_f32 v213, v213, v212
v_accvgpr_write_b32 a98, v213
v_accvgpr_read_b32 v214, a99
v_mul_f32 v214, v214, v212
v_accvgpr_write_b32 a99, v214
v_accvgpr_read_b32 v213, a100
v_mul_f32 v213, v213, v212
v_accvgpr_write_b32 a100, v213
v_accvgpr_read_b32 v214, a101
v_mul_f32 v214, v214, v212
v_accvgpr_write_b32 a101, v214
v_accvgpr_read_b32 v213, a102
v_mul_f32 v213, v213, v212
v_accvgpr_write_b32 a102, v213
v_accvgpr_read_b32 v214, a103
v_mul_f32 v214, v214, v212
v_accvgpr_write_b32 a103, v214
v_accvgpr_read_b32 v213, a104
v_mul_f32 v213, v213, v212
v_accvgpr_write_b32 a104, v213
v_accvgpr_read_b32 v214, a105
v_mul_f32 v214, v214, v212
v_accvgpr_write_b32 a105, v214
v_accvgpr_read_b32 v213, a106
v_mul_f32 v213, v213, v212
v_accvgpr_write_b32 a106, v213
v_accvgpr_read_b32 v214, a107
v_mul_f32 v214, v214, v212
v_accvgpr_write_b32 a107, v214
v_accvgpr_read_b32 v213, a108
v_mul_f32 v213, v213, v212
v_accvgpr_write_b32 a108, v213
v_accvgpr_read_b32 v214, a109
v_mul_f32 v214, v214, v212
v_accvgpr_write_b32 a109, v214
v_accvgpr_read_b32 v213, a110
v_mul_f32 v213, v213, v212
v_accvgpr_write_b32 a110, v213
v_accvgpr_read_b32 v214, a111
v_mul_f32 v214, v214, v212
v_accvgpr_write_b32 a111, v214
v_accvgpr_read_b32 v213, a112
v_mul_f32 v213, v213, v212
v_accvgpr_write_b32 a112, v213
v_accvgpr_read_b32 v214, a113
v_mul_f32 v214, v214, v212
v_accvgpr_write_b32 a113, v214
v_accvgpr_read_b32 v213, a114
v_mul_f32 v213, v213, v212
v_accvgpr_write_b32 a114, v213
v_accvgpr_read_b32 v214, a115
v_mul_f32 v214, v214, v212
v_accvgpr_write_b32 a115, v214
v_accvgpr_read_b32 v213, a116
v_mul_f32 v213, v213, v212
v_accvgpr_write_b32 a116, v213
v_accvgpr_read_b32 v214, a117
v_mul_f32 v214, v214, v212
v_accvgpr_write_b32 a117, v214
v_accvgpr_read_b32 v213, a118
v_mul_f32 v213, v213, v212
v_accvgpr_write_b32 a118, v213
v_accvgpr_read_b32 v214, a119
v_mul_f32 v214, v214, v212
v_accvgpr_write_b32 a119, v214
v_accvgpr_read_b32 v213, a120
v_mul_f32 v213, v213, v212
v_accvgpr_write_b32 a120, v213
v_accvgpr_read_b32 v214, a121
v_mul_f32 v214, v214, v212
v_accvgpr_write_b32 a121, v214
v_accvgpr_read_b32 v213, a122
v_mul_f32 v213, v213, v212
v_accvgpr_write_b32 a122, v213
v_accvgpr_read_b32 v214, a123
v_mul_f32 v214, v214, v212
v_accvgpr_write_b32 a123, v214
v_accvgpr_read_b32 v213, a124
v_mul_f32 v213, v213, v212
v_accvgpr_write_b32 a124, v213
v_accvgpr_read_b32 v214, a125
v_mul_f32 v214, v214, v212
v_accvgpr_write_b32 a125, v214
v_accvgpr_read_b32 v213, a126
v_mul_f32 v213, v213, v212
v_accvgpr_write_b32 a126, v213
v_accvgpr_read_b32 v214, a127
v_mul_f32 v214, v214, v212
v_accvgpr_write_b32 a127, v214
v_sub_f32 v84, v84, v211
v_sub_f32 v85, v85, v211
v_sub_f32 v86, v86, v211
v_sub_f32 v87, v87, v211
v_sub_f32 v24, v24, v211
v_sub_f32 v56, v56, v211
v_sub_f32 v25, v25, v211
v_sub_f32 v57, v57, v211
v_sub_f32 v26, v26, v211
v_sub_f32 v58, v58, v211
v_sub_f32 v27, v27, v211
v_sub_f32 v59, v59, v211
v_sub_f32 v28, v28, v211
v_sub_f32 v60, v60, v211
v_sub_f32 v29, v29, v211
v_sub_f32 v61, v61, v211
v_sub_f32 v30, v30, v211
v_sub_f32 v62, v62, v211
v_sub_f32 v31, v31, v211
v_sub_f32 v63, v63, v211
v_exp_f32 v213, v56
v_exp_f32 v214, v57
s_nop 0
v_add_f32 v156, v213, v214
v_cvt_pk_bf16_f32 v120, v213, v214
v_exp_f32 v213, v58
v_exp_f32 v214, v59
s_nop 0
v_add_f32 v156, v156, v213
v_add_f32 v156, v156, v214
v_cvt_pk_bf16_f32 v121, v213, v214
v_exp_f32 v213, v60
v_exp_f32 v214, v61
s_nop 0
v_add_f32 v156, v156, v213
v_add_f32 v156, v156, v214
v_cvt_pk_bf16_f32 v122, v213, v214
v_exp_f32 v213, v62
v_exp_f32 v214, v63
s_nop 0
v_add_f32 v156, v156, v213
v_add_f32 v156, v156, v214
v_cvt_pk_bf16_f32 v123, v213, v214
ds_bpermute_b32 v213, v217, v156
s_waitcnt lgkmcnt(0)
v_add_f32 v156, v156, v213
ds_bpermute_b32 v213, v216, v156
s_waitcnt lgkmcnt(0)
v_add_f32 v156, v156, v213
s_nop 3
s_cmp_eq_u32 s73, 1
s_cbranch_scc1 LB_ret_4
s_cmp_eq_u32 s73, 4
s_cbranch_scc1 LB_ret_10
s_cmp_eq_u32 s73, 7
s_cbranch_scc1 LB_ret_17
s_branch LB_ret_23
LB_H2:
s_nop 15
s_nop 15
s_waitcnt lgkmcnt(0)
v_max_f32 v211, v64, v65
v_max3_f32 v211, v211, v66, v67
v_max3_f32 v211, v211, v68, v69
v_max3_f32 v211, v211, v70, v71
ds_bpermute_b32 v213, v217, v211
s_waitcnt lgkmcnt(0)
v_max_f32 v211, v211, v213
ds_bpermute_b32 v213, v216, v211
s_waitcnt lgkmcnt(0)
v_max_f32 v211, v211, v213
v_max_f32 v211, 0, v211
v_sub_f32 v212, 0, v211
v_exp_f32 v212, v212
s_nop 0
v_mul_f32 v209, v209, v212
v_accvgpr_read_b32 v213, a128
v_mul_f32 v213, v213, v212
v_accvgpr_write_b32 a128, v213
v_accvgpr_read_b32 v214, a129
v_mul_f32 v214, v214, v212
v_accvgpr_write_b32 a129, v214
v_accvgpr_read_b32 v213, a130
v_mul_f32 v213, v213, v212
v_accvgpr_write_b32 a130, v213
v_accvgpr_read_b32 v214, a131
v_mul_f32 v214, v214, v212
v_accvgpr_write_b32 a131, v214
v_accvgpr_read_b32 v213, a132
v_mul_f32 v213, v213, v212
v_accvgpr_write_b32 a132, v213
v_accvgpr_read_b32 v214, a133
v_mul_f32 v214, v214, v212
v_accvgpr_write_b32 a133, v214
v_accvgpr_read_b32 v213, a134
v_mul_f32 v213, v213, v212
v_accvgpr_write_b32 a134, v213
v_accvgpr_read_b32 v214, a135
v_mul_f32 v214, v214, v212
v_accvgpr_write_b32 a135, v214
v_accvgpr_read_b32 v213, a136
v_mul_f32 v213, v213, v212
v_accvgpr_write_b32 a136, v213
v_accvgpr_read_b32 v214, a137
v_mul_f32 v214, v214, v212
v_accvgpr_write_b32 a137, v214
v_accvgpr_read_b32 v213, a138
v_mul_f32 v213, v213, v212
v_accvgpr_write_b32 a138, v213
v_accvgpr_read_b32 v214, a139
v_mul_f32 v214, v214, v212
v_accvgpr_write_b32 a139, v214
v_accvgpr_read_b32 v213, a140
v_mul_f32 v213, v213, v212
v_accvgpr_write_b32 a140, v213
v_accvgpr_read_b32 v214, a141
v_mul_f32 v214, v214, v212
v_accvgpr_write_b32 a141, v214
v_accvgpr_read_b32 v213, a142
v_mul_f32 v213, v213, v212
v_accvgpr_write_b32 a142, v213
v_accvgpr_read_b32 v214, a143
v_mul_f32 v214, v214, v212
v_accvgpr_write_b32 a143, v214
v_accvgpr_read_b32 v213, a144
v_mul_f32 v213, v213, v212
v_accvgpr_write_b32 a144, v213
v_accvgpr_read_b32 v214, a145
v_mul_f32 v214, v214, v212
v_accvgpr_write_b32 a145, v214
v_accvgpr_read_b32 v213, a146
v_mul_f32 v213, v213, v212
v_accvgpr_write_b32 a146, v213
v_accvgpr_read_b32 v214, a147
v_mul_f32 v214, v214, v212
v_accvgpr_write_b32 a147, v214
v_accvgpr_read_b32 v213, a148
v_mul_f32 v213, v213, v212
v_accvgpr_write_b32 a148, v213
v_accvgpr_read_b32 v214, a149
v_mul_f32 v214, v214, v212
v_accvgpr_write_b32 a149, v214
v_accvgpr_read_b32 v213, a150
v_mul_f32 v213, v213, v212
v_accvgpr_write_b32 a150, v213
v_accvgpr_read_b32 v214, a151
v_mul_f32 v214, v214, v212
v_accvgpr_write_b32 a151, v214
v_accvgpr_read_b32 v213, a152
v_mul_f32 v213, v213, v212
v_accvgpr_write_b32 a152, v213
v_accvgpr_read_b32 v214, a153
v_mul_f32 v214, v214, v212
v_accvgpr_write_b32 a153, v214
v_accvgpr_read_b32 v213, a154
v_mul_f32 v213, v213, v212
v_accvgpr_write_b32 a154, v213
v_accvgpr_read_b32 v214, a155
v_mul_f32 v214, v214, v212
v_accvgpr_write_b32 a155, v214
v_accvgpr_read_b32 v213, a156
v_mul_f32 v213, v213, v212
v_accvgpr_write_b32 a156, v213
v_accvgpr_read_b32 v214, a157
v_mul_f32 v214, v214, v212
v_accvgpr_write_b32 a157, v214
v_accvgpr_read_b32 v213, a158
v_mul_f32 v213, v213, v212
v_accvgpr_write_b32 a158, v213
v_accvgpr_read_b32 v214, a159
v_mul_f32 v214, v214, v212
v_accvgpr_write_b32 a159, v214
v_sub_f32 v88, v88, v211
v_sub_f32 v89, v89, v211
v_sub_f32 v90, v90, v211
v_sub_f32 v91, v91, v211
v_sub_f32 v64, v64, v211
v_sub_f32 v65, v65, v211
v_sub_f32 v66, v66, v211
v_sub_f32 v67, v67, v211
v_sub_f32 v68, v68, v211
v_sub_f32 v69, v69, v211
v_sub_f32 v70, v70, v211
v_sub_f32 v71, v71, v211
v_exp_f32 v213, v64
v_exp_f32 v214, v65
s_nop 0
v_add_f32 v240, v213, v214
v_cvt_pk_bf16_f32 v124, v213, v214
v_exp_f32 v213, v66
v_exp_f32 v214, v67
s_nop 0
v_add_f32 v240, v240, v213
v_add_f32 v240, v240, v214
v_cvt_pk_bf16_f32 v125, v213, v214
v_exp_f32 v213, v68
v_exp_f32 v214, v69
s_nop 0
v_add_f32 v240, v240, v213
v_add_f32 v240, v240, v214
v_cvt_pk_bf16_f32 v126, v213, v214
v_exp_f32 v213, v70
v_exp_f32 v214, v71
s_nop 0
v_add_f32 v240, v240, v213
v_add_f32 v240, v240, v214
v_cvt_pk_bf16_f32 v127, v213, v214
ds_bpermute_b32 v213, v217, v240
s_waitcnt lgkmcnt(0)
v_add_f32 v240, v240, v213
ds_bpermute_b32 v213, v216, v240
s_waitcnt lgkmcnt(0)
v_add_f32 v240, v240, v213
s_nop 3
s_cmp_eq_u32 s73, 0
s_cbranch_scc1 LB_ret_2
s_cmp_eq_u32 s73, 3
s_cbranch_scc1 LB_ret_8
s_cmp_eq_u32 s73, 6
s_cbranch_scc1 LB_ret_15
s_branch LB_ret_21
LB_stub_1:
s_mov_b32 s73, 0
s_branch LB_H2
LB_stub_3:
s_mov_b32 s73, 1
s_branch LB_H1
LB_stub_5:
s_mov_b32 s73, 2
s_branch LB_H0
LB_stub_7:
s_mov_b32 s73, 3
s_branch LB_H2
LB_stub_9:
s_mov_b32 s73, 4
s_branch LB_H1
LB_stub_11:
s_mov_b32 s73, 5
s_branch LB_H0
LB_stub_14:
s_mov_b32 s73, 6
s_branch LB_H2
LB_stub_16:
s_mov_b32 s73, 7
s_branch LB_H1
LB_stub_18:
s_mov_b32 s73, 8
s_branch LB_H0
LB_stub_20:
s_mov_b32 s73, 9
s_branch LB_H2
LB_stub_22:
s_mov_b32 s73, 10
s_branch LB_H1
.globl reduce_heads_kernel
.p2align 8
.type reduce_heads_kernel,@function
reduce_heads_kernel:
s_cmp_ge_u32 s2, 720
s_cbranch_scc1 L2_exit
s_load_dwordx2 s[4:5], s[0:1], 80
s_load_dwordx2 s[6:7], s[0:1], 96
v_lshrrev_b32 v1, 6, v0
v_and_b32 v2, 63, v0
v_readfirstlane_b32 s18, v1
s_waitcnt lgkmcnt(0)
s_mov_b32 s8, s6
s_and_b32 s9, s7, 0xffff
s_mov_b32 s10, 42467328
s_mov_b32 s11, 0x20000
s_mov_b32 s12, s4
s_and_b32 s13, s5, 0xffff
s_mov_b32 s14, 2654208
s_mov_b32 s15, 0x20000
v_and_b32 v4, 15, v2
v_mul_u32_u24 v4, 2304, v4
v_lshrrev_b32 v5, 4, v2
v_lshl_add_u32 v4, v5, 3, v4
s_cmp_ge_u32 s2, 576
s_cbranch_scc1 L2_extra
s_mul_hi_u32 s16, s2, 0x71c71c8
s_mul_i32 s17, s16, 36
s_sub_u32 s17, s2, s17
s_lshl_b32 s17, s17, 2
s_add_u32 s17, s17, s18
s_mul_i32 s19, s16, 2654208
s_lshl_b32 s20, s17, 14
s_add_u32 s19, s19, s20
v_lshlrev_b32 v3, 4, v2
buffer_load_dwordx4 v[16:19], v3, s[8:11], s19 offen
s_add_u32 s19, s19, 1024
buffer_load_dwordx4 v[20:23], v3, s[8:11], s19 offen
s_add_u32 s19, s19, 1024
buffer_load_dwordx4 v[24:27], v3, s[8:11], s19 offen
s_add_u32 s19, s19, 1024
buffer_load_dwordx4 v[28:31], v3, s[8:11], s19 offen
s_add_u32 s19, s19, 1024
buffer_load_dwordx4 v[32:35], v3, s[8:11], s19 offen
s_add_u32 s19, s19, 1024
buffer_load_dwordx4 v[36:39], v3, s[8:11], s19 offen
s_add_u32 s19, s19, 1024
buffer_load_dwordx4 v[40:43], v3, s[8:11], s19 offen
s_add_u32 s19, s19, 1024
buffer_load_dwordx4 v[44:47], v3, s[8:11], s19 offen
s_add_u32 s19, s19, 1024
buffer_load_dwordx4 v[48:51], v3, s[8:11], s19 offen
s_add_u32 s19, s19, 1024
buffer_load_dwordx4 v[52:55], v3, s[8:11], s19 offen
s_add_u32 s19, s19, 1024
buffer_load_dwordx4 v[56:59], v3, s[8:11], s19 offen
s_add_u32 s19, s19, 1024
buffer_load_dwordx4 v[60:63], v3, s[8:11], s19 offen
s_add_u32 s19, s19, 1024
buffer_load_dwordx4 v[64:67], v3, s[8:11], s19 offen
s_add_u32 s19, s19, 1024
buffer_load_dwordx4 v[68:71], v3, s[8:11], s19 offen
s_add_u32 s19, s19, 1024
buffer_load_dwordx4 v[72:75], v3, s[8:11], s19 offen
s_add_u32 s19, s19, 1024
buffer_load_dwordx4 v[76:79], v3, s[8:11], s19 offen
s_mul_hi_u32 s21, s17, 0x71c71c8
s_mul_i32 s22, s21, 36
s_sub_u32 s22, s17, s22
s_and_b32 s23, s16, 7
s_lshr_b32 s24, s16, 3
s_mul_i32 s23, s23, 144
s_lshl_b32 s21, s21, 5
s_add_u32 s23, s23, s21
s_mul_i32 s23, s23, 2304
s_mul_i32 s24, s24, 1152
s_add_u32 s23, s23, s24
s_lshl_b32 s22, s22, 5
s_add_u32 s23, s23, s22
s_add_u32 s25, s23, 36864
s_waitcnt vmcnt(15)
v_lshlrev_b32 v8, 16, v16
v_and_b32 v9, 4294901760, v16
v_lshlrev_b32 v10, 16, v17
v_and_b32 v11, 4294901760, v17
v_lshlrev_b32 v12, 16, v18
v_and_b32 v13, 4294901760, v18
v_lshlrev_b32 v14, 16, v19
v_and_b32 v15, 4294901760, v19
s_waitcnt vmcnt(14)
v_lshlrev_b32 v6, 16, v20
v_and_b32 v7, 4294901760, v20
v_add_f32 v8, v8, v6
v_add_f32 v9, v9, v7
v_lshlrev_b32 v6, 16, v21
v_and_b32 v7, 4294901760, v21
v_add_f32 v10, v10, v6
v_add_f32 v11, v11, v7
v_lshlrev_b32 v6, 16, v22
v_and_b32 v7, 4294901760, v22
v_add_f32 v12, v12, v6
v_add_f32 v13, v13, v7
v_lshlrev_b32 v6, 16, v23
v_and_b32 v7, 4294901760, v23
v_add_f32 v14, v14, v6
v_add_f32 v15, v15, v7
s_waitcnt vmcnt(13)
v_lshlrev_b32 v6, 16, v24
v_and_b32 v7, 4294901760, v24
v_add_f32 v8, v8, v6
v_add_f32 v9, v9, v7
v_lshlrev_b32 v6, 16, v25
v_and_b32 v7, 4294901760, v25
v_add_f32 v10, v10, v6
v_add_f32 v11, v11, v7
v_lshlrev_b32 v6, 16, v26
v_and_b32 v7, 4294901760, v26
v_add_f32 v12, v12, v6
v_add_f32 v13, v13, v7
v_lshlrev_b32 v6, 16, v27
v_and_b32 v7, 4294901760, v27
v_add_f32 v14, v14, v6
v_add_f32 v15, v15, v7
s_waitcnt vmcnt(12)
v_lshlrev_b32 v6, 16, v28
v_and_b32 v7, 4294901760, v28
v_add_f32 v8, v8, v6
v_add_f32 v9, v9, v7
v_lshlrev_b32 v6, 16, v29
v_and_b32 v7, 4294901760, v29
v_add_f32 v10, v10, v6
v_add_f32 v11, v11, v7
v_lshlrev_b32 v6, 16, v30
v_and_b32 v7, 4294901760, v30
v_add_f32 v12, v12, v6
v_add_f32 v13, v13, v7
v_lshlrev_b32 v6, 16, v31
v_and_b32 v7, 4294901760, v31
v_add_f32 v14, v14, v6
v_add_f32 v15, v15, v7
s_waitcnt vmcnt(11)
v_lshlrev_b32 v6, 16, v32
v_and_b32 v7, 4294901760, v32
v_add_f32 v8, v8, v6
v_add_f32 v9, v9, v7
v_lshlrev_b32 v6, 16, v33
v_and_b32 v7, 4294901760, v33
v_add_f32 v10, v10, v6
v_add_f32 v11, v11, v7
v_lshlrev_b32 v6, 16, v34
v_and_b32 v7, 4294901760, v34
v_add_f32 v12, v12, v6
v_add_f32 v13, v13, v7
v_lshlrev_b32 v6, 16, v35
v_and_b32 v7, 4294901760, v35
v_add_f32 v14, v14, v6
v_add_f32 v15, v15, v7
s_waitcnt vmcnt(10)
v_lshlrev_b32 v6, 16, v36
v_and_b32 v7, 4294901760, v36
v_add_f32 v8, v8, v6
v_add_f32 v9, v9, v7
v_lshlrev_b32 v6, 16, v37
v_and_b32 v7, 4294901760, v37
v_add_f32 v10, v10, v6
v_add_f32 v11, v11, v7
v_lshlrev_b32 v6, 16, v38
v_and_b32 v7, 4294901760, v38
v_add_f32 v12, v12, v6
v_add_f32 v13, v13, v7
v_lshlrev_b32 v6, 16, v39
v_and_b32 v7, 4294901760, v39
v_add_f32 v14, v14, v6
v_add_f32 v15, v15, v7
s_waitcnt vmcnt(9)
v_lshlrev_b32 v6, 16, v40
v_and_b32 v7, 4294901760, v40
v_add_f32 v8, v8, v6
v_add_f32 v9, v9, v7
v_lshlrev_b32 v6, 16, v41
v_and_b32 v7, 4294901760, v41
v_add_f32 v10, v10, v6
v_add_f32 v11, v11, v7
v_lshlrev_b32 v6, 16, v42
v_and_b32 v7, 4294901760, v42
v_add_f32 v12, v12, v6
v_add_f32 v13, v13, v7
v_lshlrev_b32 v6, 16, v43
v_and_b32 v7, 4294901760, v43
v_add_f32 v14, v14, v6
v_add_f32 v15, v15, v7
s_waitcnt vmcnt(8)
v_lshlrev_b32 v6, 16, v44
v_and_b32 v7, 4294901760, v44
v_add_f32 v8, v8, v6
v_add_f32 v9, v9, v7
v_lshlrev_b32 v6, 16, v45
v_and_b32 v7, 4294901760, v45
v_add_f32 v10, v10, v6
v_add_f32 v11, v11, v7
v_lshlrev_b32 v6, 16, v46
v_and_b32 v7, 4294901760, v46
v_add_f32 v12, v12, v6
v_add_f32 v13, v13, v7
v_lshlrev_b32 v6, 16, v47
v_and_b32 v7, 4294901760, v47
v_add_f32 v14, v14, v6
v_add_f32 v15, v15, v7
s_waitcnt vmcnt(7)
v_lshlrev_b32 v6, 16, v48
v_and_b32 v7, 4294901760, v48
v_add_f32 v8, v8, v6
v_add_f32 v9, v9, v7
v_lshlrev_b32 v6, 16, v49
v_and_b32 v7, 4294901760, v49
v_add_f32 v10, v10, v6
v_add_f32 v11, v11, v7
v_lshlrev_b32 v6, 16, v50
v_and_b32 v7, 4294901760, v50
v_add_f32 v12, v12, v6
v_add_f32 v13, v13, v7
v_lshlrev_b32 v6, 16, v51
v_and_b32 v7, 4294901760, v51
v_add_f32 v14, v14, v6
v_add_f32 v15, v15, v7
s_waitcnt vmcnt(6)
v_lshlrev_b32 v6, 16, v52
v_and_b32 v7, 4294901760, v52
v_add_f32 v8, v8, v6
v_add_f32 v9, v9, v7
v_lshlrev_b32 v6, 16, v53
v_and_b32 v7, 4294901760, v53
v_add_f32 v10, v10, v6
v_add_f32 v11, v11, v7
v_lshlrev_b32 v6, 16, v54
v_and_b32 v7, 4294901760, v54
v_add_f32 v12, v12, v6
v_add_f32 v13, v13, v7
v_lshlrev_b32 v6, 16, v55
v_and_b32 v7, 4294901760, v55
v_add_f32 v14, v14, v6
v_add_f32 v15, v15, v7
s_waitcnt vmcnt(5)
v_lshlrev_b32 v6, 16, v56
v_and_b32 v7, 4294901760, v56
v_add_f32 v8, v8, v6
v_add_f32 v9, v9, v7
v_lshlrev_b32 v6, 16, v57
v_and_b32 v7, 4294901760, v57
v_add_f32 v10, v10, v6
v_add_f32 v11, v11, v7
v_lshlrev_b32 v6, 16, v58
v_and_b32 v7, 4294901760, v58
v_add_f32 v12, v12, v6
v_add_f32 v13, v13, v7
v_lshlrev_b32 v6, 16, v59
v_and_b32 v7, 4294901760, v59
v_add_f32 v14, v14, v6
v_add_f32 v15, v15, v7
s_waitcnt vmcnt(4)
v_lshlrev_b32 v6, 16, v60
v_and_b32 v7, 4294901760, v60
v_add_f32 v8, v8, v6
v_add_f32 v9, v9, v7
v_lshlrev_b32 v6, 16, v61
v_and_b32 v7, 4294901760, v61
v_add_f32 v10, v10, v6
v_add_f32 v11, v11, v7
v_lshlrev_b32 v6, 16, v62
v_and_b32 v7, 4294901760, v62
v_add_f32 v12, v12, v6
v_add_f32 v13, v13, v7
v_lshlrev_b32 v6, 16, v63
v_and_b32 v7, 4294901760, v63
v_add_f32 v14, v14, v6
v_add_f32 v15, v15, v7
s_waitcnt vmcnt(3)
v_lshlrev_b32 v6, 16, v64
v_and_b32 v7, 4294901760, v64
v_add_f32 v8, v8, v6
v_add_f32 v9, v9, v7
v_lshlrev_b32 v6, 16, v65
v_and_b32 v7, 4294901760, v65
v_add_f32 v10, v10, v6
v_add_f32 v11, v11, v7
v_lshlrev_b32 v6, 16, v66
v_and_b32 v7, 4294901760, v66
v_add_f32 v12, v12, v6
v_add_f32 v13, v13, v7
v_lshlrev_b32 v6, 16, v67
v_and_b32 v7, 4294901760, v67
v_add_f32 v14, v14, v6
v_add_f32 v15, v15, v7
s_waitcnt vmcnt(2)
v_lshlrev_b32 v6, 16, v68
v_and_b32 v7, 4294901760, v68
v_add_f32 v8, v8, v6
v_add_f32 v9, v9, v7
v_lshlrev_b32 v6, 16, v69
v_and_b32 v7, 4294901760, v69
v_add_f32 v10, v10, v6
v_add_f32 v11, v11, v7
v_lshlrev_b32 v6, 16, v70
v_and_b32 v7, 4294901760, v70
v_add_f32 v12, v12, v6
v_add_f32 v13, v13, v7
v_lshlrev_b32 v6, 16, v71
v_and_b32 v7, 4294901760, v71
v_add_f32 v14, v14, v6
v_add_f32 v15, v15, v7
s_waitcnt vmcnt(1)
v_lshlrev_b32 v6, 16, v72
v_and_b32 v7, 4294901760, v72
v_add_f32 v8, v8, v6
v_add_f32 v9, v9, v7
v_lshlrev_b32 v6, 16, v73
v_and_b32 v7, 4294901760, v73
v_add_f32 v10, v10, v6
v_add_f32 v11, v11, v7
v_lshlrev_b32 v6, 16, v74
v_and_b32 v7, 4294901760, v74
v_add_f32 v12, v12, v6
v_add_f32 v13, v13, v7
v_lshlrev_b32 v6, 16, v75
v_and_b32 v7, 4294901760, v75
v_add_f32 v14, v14, v6
v_add_f32 v15, v15, v7
s_waitcnt vmcnt(0)
v_lshlrev_b32 v6, 16, v76
v_and_b32 v7, 4294901760, v76
v_add_f32 v8, v8, v6
v_add_f32 v9, v9, v7
v_lshlrev_b32 v6, 16, v77
v_and_b32 v7, 4294901760, v77
v_add_f32 v10, v10, v6
v_add_f32 v11, v11, v7
v_lshlrev_b32 v6, 16, v78
v_and_b32 v7, 4294901760, v78
v_add_f32 v12, v12, v6
v_add_f32 v13, v13, v7
v_lshlrev_b32 v6, 16, v79
v_and_b32 v7, 4294901760, v79
v_add_f32 v14, v14, v6
v_add_f32 v15, v15, v7
v_cvt_pk_bf16_f32 v16, v8, v9
v_cvt_pk_bf16_f32 v17, v10, v11
v_cvt_pk_bf16_f32 v18, v12, v13
v_cvt_pk_bf16_f32 v19, v14, v15
buffer_store_dwordx2 v[16:17], v4, s[12:15], s23 offen
buffer_store_dwordx2 v[18:19], v4, s[12:15], s25 offen
s_endpgm
L2_extra:
s_sub_u32 s25, s2, 576
s_mul_hi_u32 s16, s25, 0x1c71c71d
s_mul_i32 s17, s16, 9
s_sub_u32 s17, s25, s17
s_lshl_b32 s17, s17, 2
s_add_u32 s17, s17, s18
s_mul_i32 s19, s16, 2654208
s_lshl_b32 s20, s17, 13
s_add_u32 s19, s19, s20
s_add_u32 s19, s19, 2359296
v_lshlrev_b32 v3, 3, v2
buffer_load_dwordx2 v[16:17], v3, s[8:11], s19 offen
s_add_u32 s19, s19, 512
buffer_load_dwordx2 v[18:19], v3, s[8:11], s19 offen
s_add_u32 s19, s19, 512
buffer_load_dwordx2 v[20:21], v3, s[8:11], s19 offen
s_add_u32 s19, s19, 512
buffer_load_dwordx2 v[22:23], v3, s[8:11], s19 offen
s_add_u32 s19, s19, 512
buffer_load_dwordx2 v[24:25], v3, s[8:11], s19 offen
s_add_u32 s19, s19, 512
buffer_load_dwordx2 v[26:27], v3, s[8:11], s19 offen
s_add_u32 s19, s19, 512
buffer_load_dwordx2 v[28:29], v3, s[8:11], s19 offen
s_add_u32 s19, s19, 512
buffer_load_dwordx2 v[30:31], v3, s[8:11], s19 offen
s_add_u32 s19, s19, 512
buffer_load_dwordx2 v[32:33], v3, s[8:11], s19 offen
s_add_u32 s19, s19, 512
buffer_load_dwordx2 v[34:35], v3, s[8:11], s19 offen
s_add_u32 s19, s19, 512
buffer_load_dwordx2 v[36:37], v3, s[8:11], s19 offen
s_add_u32 s19, s19, 512
buffer_load_dwordx2 v[38:39], v3, s[8:11], s19 offen
s_add_u32 s19, s19, 512
buffer_load_dwordx2 v[40:41], v3, s[8:11], s19 offen
s_add_u32 s19, s19, 512
buffer_load_dwordx2 v[42:43], v3, s[8:11], s19 offen
s_add_u32 s19, s19, 512
buffer_load_dwordx2 v[44:45], v3, s[8:11], s19 offen
s_add_u32 s19, s19, 512
buffer_load_dwordx2 v[46:47], v3, s[8:11], s19 offen
s_and_b32 s23, s16, 7
s_lshr_b32 s24, s16, 3
s_mul_i32 s23, s23, 144
s_add_u32 s23, s23, 128
s_mul_i32 s23, s23, 2304
s_mul_i32 s24, s24, 1152
s_add_u32 s23, s23, s24
s_lshl_b32 s22, s17, 5
s_add_u32 s23, s23, s22
s_waitcnt vmcnt(15)
v_lshlrev_b32 v8, 16, v16
v_and_b32 v9, 4294901760, v16
v_lshlrev_b32 v10, 16, v17
v_and_b32 v11, 4294901760, v17
s_waitcnt vmcnt(14)
v_lshlrev_b32 v6, 16, v18
v_and_b32 v7, 4294901760, v18
v_add_f32 v8, v8, v6
v_add_f32 v9, v9, v7
v_lshlrev_b32 v6, 16, v19
v_and_b32 v7, 4294901760, v19
v_add_f32 v10, v10, v6
v_add_f32 v11, v11, v7
s_waitcnt vmcnt(13)
v_lshlrev_b32 v6, 16, v20
v_and_b32 v7, 4294901760, v20
v_add_f32 v8, v8, v6
v_add_f32 v9, v9, v7
v_lshlrev_b32 v6, 16, v21
v_and_b32 v7, 4294901760, v21
v_add_f32 v10, v10, v6
v_add_f32 v11, v11, v7
s_waitcnt vmcnt(12)
v_lshlrev_b32 v6, 16, v22
v_and_b32 v7, 4294901760, v22
v_add_f32 v8, v8, v6
v_add_f32 v9, v9, v7
v_lshlrev_b32 v6, 16, v23
v_and_b32 v7, 4294901760, v23
v_add_f32 v10, v10, v6
v_add_f32 v11, v11, v7
s_waitcnt vmcnt(11)
v_lshlrev_b32 v6, 16, v24
v_and_b32 v7, 4294901760, v24
v_add_f32 v8, v8, v6
v_add_f32 v9, v9, v7
v_lshlrev_b32 v6, 16, v25
v_and_b32 v7, 4294901760, v25
v_add_f32 v10, v10, v6
v_add_f32 v11, v11, v7
s_waitcnt vmcnt(10)
v_lshlrev_b32 v6, 16, v26
v_and_b32 v7, 4294901760, v26
v_add_f32 v8, v8, v6
v_add_f32 v9, v9, v7
v_lshlrev_b32 v6, 16, v27
v_and_b32 v7, 4294901760, v27
v_add_f32 v10, v10, v6
v_add_f32 v11, v11, v7
s_waitcnt vmcnt(9)
v_lshlrev_b32 v6, 16, v28
v_and_b32 v7, 4294901760, v28
v_add_f32 v8, v8, v6
v_add_f32 v9, v9, v7
v_lshlrev_b32 v6, 16, v29
v_and_b32 v7, 4294901760, v29
v_add_f32 v10, v10, v6
v_add_f32 v11, v11, v7
s_waitcnt vmcnt(8)
v_lshlrev_b32 v6, 16, v30
v_and_b32 v7, 4294901760, v30
v_add_f32 v8, v8, v6
v_add_f32 v9, v9, v7
v_lshlrev_b32 v6, 16, v31
v_and_b32 v7, 4294901760, v31
v_add_f32 v10, v10, v6
v_add_f32 v11, v11, v7
s_waitcnt vmcnt(7)
v_lshlrev_b32 v6, 16, v32
v_and_b32 v7, 4294901760, v32
v_add_f32 v8, v8, v6
v_add_f32 v9, v9, v7
v_lshlrev_b32 v6, 16, v33
v_and_b32 v7, 4294901760, v33
v_add_f32 v10, v10, v6
v_add_f32 v11, v11, v7
s_waitcnt vmcnt(6)
v_lshlrev_b32 v6, 16, v34
v_and_b32 v7, 4294901760, v34
v_add_f32 v8, v8, v6
v_add_f32 v9, v9, v7
v_lshlrev_b32 v6, 16, v35
v_and_b32 v7, 4294901760, v35
v_add_f32 v10, v10, v6
v_add_f32 v11, v11, v7
s_waitcnt vmcnt(5)
v_lshlrev_b32 v6, 16, v36
v_and_b32 v7, 4294901760, v36
v_add_f32 v8, v8, v6
v_add_f32 v9, v9, v7
v_lshlrev_b32 v6, 16, v37
v_and_b32 v7, 4294901760, v37
v_add_f32 v10, v10, v6
v_add_f32 v11, v11, v7
s_waitcnt vmcnt(4)
v_lshlrev_b32 v6, 16, v38
v_and_b32 v7, 4294901760, v38
v_add_f32 v8, v8, v6
v_add_f32 v9, v9, v7
v_lshlrev_b32 v6, 16, v39
v_and_b32 v7, 4294901760, v39
v_add_f32 v10, v10, v6
v_add_f32 v11, v11, v7
s_waitcnt vmcnt(3)
v_lshlrev_b32 v6, 16, v40
v_and_b32 v7, 4294901760, v40
v_add_f32 v8, v8, v6
v_add_f32 v9, v9, v7
v_lshlrev_b32 v6, 16, v41
v_and_b32 v7, 4294901760, v41
v_add_f32 v10, v10, v6
v_add_f32 v11, v11, v7
s_waitcnt vmcnt(2)
v_lshlrev_b32 v6, 16, v42
v_and_b32 v7, 4294901760, v42
v_add_f32 v8, v8, v6
v_add_f32 v9, v9, v7
v_lshlrev_b32 v6, 16, v43
v_and_b32 v7, 4294901760, v43
v_add_f32 v10, v10, v6
v_add_f32 v11, v11, v7
s_waitcnt vmcnt(1)
v_lshlrev_b32 v6, 16, v44
v_and_b32 v7, 4294901760, v44
v_add_f32 v8, v8, v6
v_add_f32 v9, v9, v7
v_lshlrev_b32 v6, 16, v45
v_and_b32 v7, 4294901760, v45
v_add_f32 v10, v10, v6
v_add_f32 v11, v11, v7
s_waitcnt vmcnt(0)
v_lshlrev_b32 v6, 16, v46
v_and_b32 v7, 4294901760, v46
v_add_f32 v8, v8, v6
v_add_f32 v9, v9, v7
v_lshlrev_b32 v6, 16, v47
v_and_b32 v7, 4294901760, v47
v_add_f32 v10, v10, v6
v_add_f32 v11, v11, v7
v_cvt_pk_bf16_f32 v16, v8, v9
v_cvt_pk_bf16_f32 v17, v10, v11
buffer_store_dwordx2 v[16:17], v4, s[12:15], s23 offen
L2_exit:
s_endpgm
.section .rodata,"a"
.p2align 6
.amdhsa_kernel concat_heads__gqa_block_cached__mha_block_cached__near_ridge_kernel
.amdhsa_next_free_vgpr 512
.amdhsa_next_free_sgpr 102
.amdhsa_accum_offset 256
.amdhsa_group_segment_fixed_size 0
.amdhsa_kernarg_size 104
.amdhsa_user_sgpr_count 2
.amdhsa_user_sgpr_kernarg_segment_ptr 1
.amdhsa_system_sgpr_workgroup_id_x 1
.end_amdhsa_kernel
.p2align 6
.amdhsa_kernel reduce_heads_kernel
.amdhsa_next_free_vgpr 80
.amdhsa_next_free_sgpr 32
.amdhsa_accum_offset 80
.amdhsa_group_segment_fixed_size 0
.amdhsa_kernarg_size 104
.amdhsa_user_sgpr_count 2
.amdhsa_user_sgpr_kernarg_segment_ptr 1
.amdhsa_system_sgpr_workgroup_id_x 1
.end_amdhsa_kernel
```
